```python
import torch

def _softmax(x, axis=-1):
    return torch.softmax(x, dim=axis)
def _gelu(x):
    return torch.nn.functional.gelu(x, approximate="tanh")
def _silu(x):
    return torch.nn.functional.silu(x)
def _sigmoid(x):
    return torch.sigmoid(x)
def _layernorm(x, axis=-1, eps=1e-5):
    m = x.mean(dim=axis, keepdim=True)
    v = x.var(dim=axis, keepdim=True, unbiased=False)
    return (x - m) / torch.sqrt(v + eps)
def _scatter_add(tgt, idx, src, axis=0):
    return tgt.clone().index_add_(axis, idx, src)
def _segment_sum(src, seg, n):
    out = torch.zeros((n,) + src.shape[1:], dtype=src.dtype)
    return out.index_add_(0, seg, src)
def _pad(x, pw):
    flat = tuple(v for pair in reversed(pw) for v in pair)
    return torch.nn.functional.pad(x, flat)

kernel_name = 'sequential_preLN__mha_block__geglu_ffn__prompt'

def setup_inputs():

    _w = (lambda a: (lambda t: t.to(torch.bfloat16) if t.is_floating_point() else t)(torch.as_tensor(a)))
    def _A_setup():
        B, S, D, H = 1, 2048, 512, 32
        return {
            "x": _w((lambda *s: torch.randn(*s, dtype=torch.bfloat16) * 0.05)(B, S, D)),
            "wqkv": _w((lambda *s: torch.randn(*s, dtype=torch.bfloat16) * 0.05)(D, 3 * D)),
            "wo": _w((lambda *s: torch.randn(*s, dtype=torch.bfloat16) * 0.05)(D, D)),
        }
    _A_in = _A_setup()

    def _B_setup():
        B, S, D, F = 1, 2048, 512, 1792
        return {
            "x": _w((lambda *s: torch.randn(*s, dtype=torch.bfloat16) * 0.05)(B, S, D)),
            "w_gate": _w((lambda *s: torch.randn(*s, dtype=torch.bfloat16) * 0.05)(D, F)),
            "w_up": _w((lambda *s: torch.randn(*s, dtype=torch.bfloat16) * 0.05)(D, F)),
            "w_down": _w((lambda *s: torch.randn(*s, dtype=torch.bfloat16) * 0.05)(F, D)),
        }
    _B_in = _B_setup()

    return {
        "A_x": _A_in["x"],
        "A_wqkv": _A_in["wqkv"],
        "A_wo": _A_in["wo"],
        "B_x": _B_in["x"],
        "B_w_gate": _B_in["w_gate"],
        "B_w_up": _B_in["w_up"],
        "B_w_down": _B_in["w_down"],
    }

def reference(A_x, A_wqkv, A_wo, B_x, B_w_gate, B_w_up, B_w_down):
    def _A_ref(x, wqkv, wo):
        B, S, D = x.shape
        H = 32
        Dh = D // H
        qkv = (lambda x, *d: x.permute(*d))((x @ wqkv).reshape(B, S, 3, H, Dh), 2, 0, 3, 1, 4)
        q, k, v = qkv[0], qkv[1], qkv[2]
        scores = torch.einsum("bhqd,bhkd->bhqk", q, k) * (Dh ** -0.5)
        p = _softmax(scores, axis=-1)
        o = torch.einsum("bhqk,bhkd->bhqd", p, v)
        return (lambda x, *d: x.permute(*d))(o, 0, 2, 1, 3).reshape(B, S, D) @ wo

    def _B_ref(x, w_gate, w_up, w_down):
        return (_gelu(x @ w_gate) * (x @ w_up)) @ w_down

    x = A_x
    h = x + _A_ref(_layernorm(x, axis=-1), A_wqkv, A_wo)
    h2 = h + _B_ref(_layernorm(h, axis=-1), B_w_gate, B_w_up, B_w_down)
    return h2
```

```asm
; @launch kernel=sequential_preLN__mha_block__geglu_ffn__prompt_kernel grid=(256,1,1) block=(512,1,1) lds=163840
.amdgcn_target "amdgcn-amd-amdhsa--gfx950"
.text
.globl sequential_preLN__mha_block__geglu_ffn__prompt_kernel
.p2align 8
.type sequential_preLN__mha_block__geglu_ffn__prompt_kernel,@function
sequential_preLN__mha_block__geglu_ffn__prompt_kernel:
    s_cmp_ge_u32 s2, 256
    s_cbranch_scc1 K2_END
    s_load_dwordx4 s[4:7], s[0:1], 0
    s_load_dwordx4 s[56:59], s[0:1], 64
    v_lshrrev_b32 v1, 6, v0
    v_and_b32 v0, 63, v0
    v_readfirstlane_b32 s35, v1
    s_and_b32 s23, s2, 3
    s_lshl_b32 s23, s23, 2
    s_bfe_u32 s29, s2, 0x20003
    s_add_u32 s23, s23, s29
    s_bfe_u32 s24, s2, 0x10002
    s_lshl_b32 s24, s24, 3
    s_lshr_b32 s29, s2, 5
    s_add_u32 s24, s24, s29
    s_and_b32 s22, s35, 3
    s_lshl_b32 s27, s22, 12
    s_lshl_b32 s40, s2, 1
    s_and_b32 s29, s2, 4
    s_add_u32 s40, s40, s29
    s_cmp_lt_u32 s35, 4
    s_cbranch_scc1 K1_MM
    s_lshl_b32 s25, s23, 17
    s_lshl_b32 s29, s22, 15
    s_add_u32 s25, s25, s29
    s_mul_i32 s26, s22, 49152
    s_lshl_b32 s29, s24, 6
    s_add_u32 s26, s26, s29
    s_lshl_b32 s28, s22, 10
    s_add_u32 s28, s28, 16384
    s_mov_b32 s30, 0x3f803f80
    v_lshrrev_b32 v5, 3, v0
    v_lshlrev_b32 v2, 10, v5
    v_and_b32 v6, 7, v0
    v_lshrrev_b32 v7, 4, v0
    v_xor_b32 v6, v6, v7
    v_lshl_add_u32 v2, v6, 4, v2
    v_xor_b32 v3, 64, v2
    v_add_u32 v3, 8192, v3
    v_lshrrev_b32 v5, 2, v0
    v_mul_u32_u24 v4, 3072, v5
    v_and_b32 v6, 3, v0
    v_lshl_add_u32 v4, v6, 4, v4
    s_waitcnt lgkmcnt(0)
    s_mov_b32 s8, s4
    s_mov_b32 s9, s5
    s_mov_b32 s10, 0x200000
    s_mov_b32 s11, 0x00020000
    s_mov_b32 s12, s6
    s_mov_b32 s13, s7
    s_mov_b32 s14, 0x180000
    s_mov_b32 s15, 0x00020000
    s_add_u32 s41, s40, 0
    s_and_b32 s41, s41, 7
    s_lshl_b32 s42, s41, 7
    s_add_u32 s42, s42, s25
    s_mul_i32 s41, s41, 196608
    s_add_u32 s41, s41, s26
    s_add_u32 m0, s28, 0
    s_add_u32 s29, s41, 0
    buffer_load_dwordx4 v4, s[12:15], s29 offen  lds
    s_add_u32 m0, s28, 4096
    s_add_u32 s29, s41, 1024
    buffer_load_dwordx4 v4, s[12:15], s29 offen  lds
    s_add_u32 m0, s28, 8192
    s_add_u32 s29, s41, 2048
    buffer_load_dwordx4 v4, s[12:15], s29 offen  lds
    s_add_u32 m0, s27, 0
    s_add_u32 s29, s42, 0
    buffer_load_dwordx4 v2, s[8:11], s29 offen  lds
    s_add_u32 m0, s27, 1024
    s_add_u32 s29, s42, 0
    buffer_load_dwordx4 v3, s[8:11], s29 offen  lds
    s_add_u32 m0, s27, 2048
    s_add_u32 s29, s42, 16384
    buffer_load_dwordx4 v2, s[8:11], s29 offen  lds
    s_add_u32 m0, s27, 3072
    s_add_u32 s29, s42, 16384
    buffer_load_dwordx4 v3, s[8:11], s29 offen  lds
    s_add_u32 s41, s40, 1
    s_and_b32 s41, s41, 7
    s_lshl_b32 s42, s41, 7
    s_add_u32 s42, s42, s25
    s_mul_i32 s41, s41, 196608
    s_add_u32 s41, s41, s26
    s_add_u32 m0, s28, 28672
    s_add_u32 s29, s41, 0
    buffer_load_dwordx4 v4, s[12:15], s29 offen  lds
    s_add_u32 m0, s28, 32768
    s_add_u32 s29, s41, 1024
    buffer_load_dwordx4 v4, s[12:15], s29 offen  lds
    s_add_u32 m0, s28, 36864
    s_add_u32 s29, s41, 2048
    buffer_load_dwordx4 v4, s[12:15], s29 offen  lds
    s_add_u32 m0, s27, 28672
    s_add_u32 s29, s42, 0
    buffer_load_dwordx4 v2, s[8:11], s29 offen  lds
    s_add_u32 m0, s27, 29696
    s_add_u32 s29, s42, 0
    buffer_load_dwordx4 v3, s[8:11], s29 offen  lds
    s_add_u32 m0, s27, 30720
    s_add_u32 s29, s42, 16384
    buffer_load_dwordx4 v2, s[8:11], s29 offen  lds
    s_add_u32 m0, s27, 31744
    s_add_u32 s29, s42, 16384
    buffer_load_dwordx4 v3, s[8:11], s29 offen  lds
    v_and_b32 v5, 31, v0
    v_lshrrev_b32 v6, 5, v0
    v_bfe_u32 v7, v0, 1, 3
    v_xor_b32 v7, v7, v6
    v_lshlrev_b32 v5, 7, v5
    v_add_u32 v5, s27, v5
    v_xor_b32 v1, 0, v7
    v_lshl_add_u32 v8, v1, 4, v5
    v_add_u32 v12, 57344, v8
    v_add_u32 v16, 114688, v8
    v_xor_b32 v1, 2, v7
    v_lshl_add_u32 v9, v1, 4, v5
    v_add_u32 v13, 57344, v9
    v_add_u32 v17, 114688, v9
    v_xor_b32 v1, 4, v7
    v_lshl_add_u32 v10, v1, 4, v5
    v_add_u32 v14, 57344, v10
    v_add_u32 v18, 114688, v10
    v_xor_b32 v1, 6, v7
    v_lshl_add_u32 v11, v1, 4, v5
    v_add_u32 v15, 57344, v11
    v_add_u32 v19, 114688, v11
    v_bfe_u32 v1, v0, 2, 2
    v_lshl_add_u32 v1, v6, 3, v1
    v_lshlrev_b32 v20, 6, v1
    v_bfe_u32 v1, v0, 4, 1
    v_lshl_add_u32 v20, v1, 5, v20
    v_and_b32 v1, 3, v0
    v_lshl_add_u32 v20, v1, 3, v20
    s_lshl_b32 s29, s22, 10
    v_add_u32 v20, s29, v20
    v_add_u32 v21, 57344, v20
    v_add_u32 v22, 114688, v20
    v_mov_b32 v28, 0
    v_mov_b32 v29, 0
    v_mov_b32 v30, 0
    s_waitcnt vmcnt(7)
    s_barrier
    ds_read_b64_tr_b16 v[48:49], v20 offset:16384
    ds_read_b64_tr_b16 v[50:51], v20 offset:16640
    ds_read_b64_tr_b16 v[52:53], v20 offset:20480
    ds_read_b64_tr_b16 v[54:55], v20 offset:20736
    ds_read_b64_tr_b16 v[56:57], v20 offset:24576
    ds_read_b64_tr_b16 v[58:59], v20 offset:24832
    s_add_u32 s41, s40, 2
    s_and_b32 s41, s41, 7
    s_lshl_b32 s42, s41, 7
    s_add_u32 s42, s42, s25
    s_mul_i32 s41, s41, 196608
    s_add_u32 s41, s41, s26
    s_add_u32 m0, s28, 57344
    s_add_u32 s29, s41, 0
    buffer_load_dwordx4 v4, s[12:15], s29 offen  lds
    s_add_u32 m0, s28, 61440
    s_add_u32 s29, s41, 1024
    buffer_load_dwordx4 v4, s[12:15], s29 offen  lds
    s_add_u32 m0, s28, 65536
    s_add_u32 s29, s41, 2048
    buffer_load_dwordx4 v4, s[12:15], s29 offen  lds
    s_add_u32 m0, s27, 57344
    s_add_u32 s29, s42, 0
    buffer_load_dwordx4 v2, s[8:11], s29 offen  lds
    s_add_u32 m0, s27, 58368
    s_add_u32 s29, s42, 0
    buffer_load_dwordx4 v3, s[8:11], s29 offen  lds
    s_add_u32 m0, s27, 59392
    s_add_u32 s29, s42, 16384
    buffer_load_dwordx4 v2, s[8:11], s29 offen  lds
    s_add_u32 m0, s27, 60416
    s_add_u32 s29, s42, 16384
    buffer_load_dwordx4 v3, s[8:11], s29 offen  lds
    s_waitcnt lgkmcnt(0)
    v_dot2c_f32_bf16 v28, s30, v48
    v_dot2c_f32_bf16 v29, s30, v52
    v_dot2c_f32_bf16 v30, s30, v56
    v_dot2c_f32_bf16 v28, s30, v49
    v_dot2c_f32_bf16 v29, s30, v53
    v_dot2c_f32_bf16 v30, s30, v57
    v_dot2c_f32_bf16 v28, s30, v50
    v_dot2c_f32_bf16 v29, s30, v54
    v_dot2c_f32_bf16 v30, s30, v58
    v_dot2c_f32_bf16 v28, s30, v51
    v_dot2c_f32_bf16 v29, s30, v55
    v_dot2c_f32_bf16 v30, s30, v59
    s_waitcnt vmcnt(7)
    s_barrier
    ds_read_b64_tr_b16 v[48:49], v20 offset:45056
    ds_read_b64_tr_b16 v[50:51], v20 offset:45312
    ds_read_b64_tr_b16 v[52:53], v20 offset:49152
    ds_read_b64_tr_b16 v[54:55], v20 offset:49408
    ds_read_b64_tr_b16 v[56:57], v20 offset:53248
    ds_read_b64_tr_b16 v[58:59], v20 offset:53504
    s_add_u32 s41, s40, 3
    s_and_b32 s41, s41, 7
    s_lshl_b32 s42, s41, 7
    s_add_u32 s42, s42, s25
    s_mul_i32 s41, s41, 196608
    s_add_u32 s41, s41, s26
    s_add_u32 m0, s28, 86016
    s_add_u32 s29, s41, 0
    buffer_load_dwordx4 v4, s[12:15], s29 offen  lds
    s_add_u32 m0, s28, 90112
    s_add_u32 s29, s41, 1024
    buffer_load_dwordx4 v4, s[12:15], s29 offen  lds
    s_add_u32 m0, s28, 94208
    s_add_u32 s29, s41, 2048
    buffer_load_dwordx4 v4, s[12:15], s29 offen  lds
    s_add_u32 m0, s27, 86016
    s_add_u32 s29, s42, 0
    buffer_load_dwordx4 v2, s[8:11], s29 offen  lds
    s_add_u32 m0, s27, 87040
    s_add_u32 s29, s42, 0
    buffer_load_dwordx4 v3, s[8:11], s29 offen  lds
    s_add_u32 m0, s27, 88064
    s_add_u32 s29, s42, 16384
    buffer_load_dwordx4 v2, s[8:11], s29 offen  lds
    s_add_u32 m0, s27, 89088
    s_add_u32 s29, s42, 16384
    buffer_load_dwordx4 v3, s[8:11], s29 offen  lds
    s_waitcnt lgkmcnt(0)
    v_dot2c_f32_bf16 v28, s30, v48
    v_dot2c_f32_bf16 v29, s30, v52
    v_dot2c_f32_bf16 v30, s30, v56
    v_dot2c_f32_bf16 v28, s30, v49
    v_dot2c_f32_bf16 v29, s30, v53
    v_dot2c_f32_bf16 v30, s30, v57
    v_dot2c_f32_bf16 v28, s30, v50
    v_dot2c_f32_bf16 v29, s30, v54
    v_dot2c_f32_bf16 v30, s30, v58
    v_dot2c_f32_bf16 v28, s30, v51
    v_dot2c_f32_bf16 v29, s30, v55
    v_dot2c_f32_bf16 v30, s30, v59
    s_waitcnt vmcnt(7)
    s_barrier
    ds_read_b64_tr_b16 v[48:49], v21 offset:16384
    ds_read_b64_tr_b16 v[50:51], v21 offset:16640
    ds_read_b64_tr_b16 v[52:53], v21 offset:20480
    ds_read_b64_tr_b16 v[54:55], v21 offset:20736
    ds_read_b64_tr_b16 v[56:57], v21 offset:24576
    ds_read_b64_tr_b16 v[58:59], v21 offset:24832
    s_add_u32 s41, s40, 4
    s_and_b32 s41, s41, 7
    s_lshl_b32 s42, s41, 7
    s_add_u32 s42, s42, s25
    s_mul_i32 s41, s41, 196608
    s_add_u32 s41, s41, s26
    s_add_u32 m0, s28, 114688
    s_add_u32 s29, s41, 0
    buffer_load_dwordx4 v4, s[12:15], s29 offen  lds
    s_add_u32 m0, s28, 118784
    s_add_u32 s29, s41, 1024
    buffer_load_dwordx4 v4, s[12:15], s29 offen  lds
    s_add_u32 m0, s28, 122880
    s_add_u32 s29, s41, 2048
    buffer_load_dwordx4 v4, s[12:15], s29 offen  lds
    s_add_u32 m0, s27, 114688
    s_add_u32 s29, s42, 0
    buffer_load_dwordx4 v2, s[8:11], s29 offen  lds
    s_add_u32 m0, s27, 115712
    s_add_u32 s29, s42, 0
    buffer_load_dwordx4 v3, s[8:11], s29 offen  lds
    s_add_u32 m0, s27, 116736
    s_add_u32 s29, s42, 16384
    buffer_load_dwordx4 v2, s[8:11], s29 offen  lds
    s_add_u32 m0, s27, 117760
    s_add_u32 s29, s42, 16384
    buffer_load_dwordx4 v3, s[8:11], s29 offen  lds
    s_waitcnt lgkmcnt(0)
    v_dot2c_f32_bf16 v28, s30, v48
    v_dot2c_f32_bf16 v29, s30, v52
    v_dot2c_f32_bf16 v30, s30, v56
    v_dot2c_f32_bf16 v28, s30, v49
    v_dot2c_f32_bf16 v29, s30, v53
    v_dot2c_f32_bf16 v30, s30, v57
    v_dot2c_f32_bf16 v28, s30, v50
    v_dot2c_f32_bf16 v29, s30, v54
    v_dot2c_f32_bf16 v30, s30, v58
    v_dot2c_f32_bf16 v28, s30, v51
    v_dot2c_f32_bf16 v29, s30, v55
    v_dot2c_f32_bf16 v30, s30, v59
    s_waitcnt vmcnt(7)
    s_barrier
    ds_read_b64_tr_b16 v[48:49], v21 offset:45056
    ds_read_b64_tr_b16 v[50:51], v21 offset:45312
    ds_read_b64_tr_b16 v[52:53], v21 offset:49152
    ds_read_b64_tr_b16 v[54:55], v21 offset:49408
    ds_read_b64_tr_b16 v[56:57], v21 offset:53248
    ds_read_b64_tr_b16 v[58:59], v21 offset:53504
    s_add_u32 s41, s40, 5
    s_and_b32 s41, s41, 7
    s_lshl_b32 s42, s41, 7
    s_add_u32 s42, s42, s25
    s_mul_i32 s41, s41, 196608
    s_add_u32 s41, s41, s26
    s_add_u32 m0, s28, 0
    s_add_u32 s29, s41, 0
    buffer_load_dwordx4 v4, s[12:15], s29 offen  lds
    s_add_u32 m0, s28, 4096
    s_add_u32 s29, s41, 1024
    buffer_load_dwordx4 v4, s[12:15], s29 offen  lds
    s_add_u32 m0, s28, 8192
    s_add_u32 s29, s41, 2048
    buffer_load_dwordx4 v4, s[12:15], s29 offen  lds
    s_add_u32 m0, s27, 0
    s_add_u32 s29, s42, 0
    buffer_load_dwordx4 v2, s[8:11], s29 offen  lds
    s_add_u32 m0, s27, 1024
    s_add_u32 s29, s42, 0
    buffer_load_dwordx4 v3, s[8:11], s29 offen  lds
    s_add_u32 m0, s27, 2048
    s_add_u32 s29, s42, 16384
    buffer_load_dwordx4 v2, s[8:11], s29 offen  lds
    s_add_u32 m0, s27, 3072
    s_add_u32 s29, s42, 16384
    buffer_load_dwordx4 v3, s[8:11], s29 offen  lds
    s_waitcnt lgkmcnt(0)
    v_dot2c_f32_bf16 v28, s30, v48
    v_dot2c_f32_bf16 v29, s30, v52
    v_dot2c_f32_bf16 v30, s30, v56
    v_dot2c_f32_bf16 v28, s30, v49
    v_dot2c_f32_bf16 v29, s30, v53
    v_dot2c_f32_bf16 v30, s30, v57
    v_dot2c_f32_bf16 v28, s30, v50
    v_dot2c_f32_bf16 v29, s30, v54
    v_dot2c_f32_bf16 v30, s30, v58
    v_dot2c_f32_bf16 v28, s30, v51
    v_dot2c_f32_bf16 v29, s30, v55
    v_dot2c_f32_bf16 v30, s30, v59
    s_waitcnt vmcnt(7)
    s_barrier
    ds_read_b64_tr_b16 v[48:49], v22 offset:16384
    ds_read_b64_tr_b16 v[50:51], v22 offset:16640
    ds_read_b64_tr_b16 v[52:53], v22 offset:20480
    ds_read_b64_tr_b16 v[54:55], v22 offset:20736
    ds_read_b64_tr_b16 v[56:57], v22 offset:24576
    ds_read_b64_tr_b16 v[58:59], v22 offset:24832
    s_add_u32 s41, s40, 6
    s_and_b32 s41, s41, 7
    s_lshl_b32 s42, s41, 7
    s_add_u32 s42, s42, s25
    s_mul_i32 s41, s41, 196608
    s_add_u32 s41, s41, s26
    s_add_u32 m0, s28, 28672
    s_add_u32 s29, s41, 0
    buffer_load_dwordx4 v4, s[12:15], s29 offen  lds
    s_add_u32 m0, s28, 32768
    s_add_u32 s29, s41, 1024
    buffer_load_dwordx4 v4, s[12:15], s29 offen  lds
    s_add_u32 m0, s28, 36864
    s_add_u32 s29, s41, 2048
    buffer_load_dwordx4 v4, s[12:15], s29 offen  lds
    s_add_u32 m0, s27, 28672
    s_add_u32 s29, s42, 0
    buffer_load_dwordx4 v2, s[8:11], s29 offen  lds
    s_add_u32 m0, s27, 29696
    s_add_u32 s29, s42, 0
    buffer_load_dwordx4 v3, s[8:11], s29 offen  lds
    s_add_u32 m0, s27, 30720
    s_add_u32 s29, s42, 16384
    buffer_load_dwordx4 v2, s[8:11], s29 offen  lds
    s_add_u32 m0, s27, 31744
    s_add_u32 s29, s42, 16384
    buffer_load_dwordx4 v3, s[8:11], s29 offen  lds
    s_waitcnt lgkmcnt(0)
    v_dot2c_f32_bf16 v28, s30, v48
    v_dot2c_f32_bf16 v29, s30, v52
    v_dot2c_f32_bf16 v30, s30, v56
    v_dot2c_f32_bf16 v28, s30, v49
    v_dot2c_f32_bf16 v29, s30, v53
    v_dot2c_f32_bf16 v30, s30, v57
    v_dot2c_f32_bf16 v28, s30, v50
    v_dot2c_f32_bf16 v29, s30, v54
    v_dot2c_f32_bf16 v30, s30, v58
    v_dot2c_f32_bf16 v28, s30, v51
    v_dot2c_f32_bf16 v29, s30, v55
    v_dot2c_f32_bf16 v30, s30, v59
    s_waitcnt vmcnt(7)
    s_barrier
    ds_read_b64_tr_b16 v[48:49], v20 offset:16384
    ds_read_b64_tr_b16 v[50:51], v20 offset:16640
    ds_read_b64_tr_b16 v[52:53], v20 offset:20480
    ds_read_b64_tr_b16 v[54:55], v20 offset:20736
    ds_read_b64_tr_b16 v[56:57], v20 offset:24576
    ds_read_b64_tr_b16 v[58:59], v20 offset:24832
    s_add_u32 s41, s40, 7
    s_and_b32 s41, s41, 7
    s_lshl_b32 s42, s41, 7
    s_add_u32 s42, s42, s25
    s_mul_i32 s41, s41, 196608
    s_add_u32 s41, s41, s26
    s_add_u32 m0, s28, 57344
    s_add_u32 s29, s41, 0
    buffer_load_dwordx4 v4, s[12:15], s29 offen  lds
    s_add_u32 m0, s28, 61440
    s_add_u32 s29, s41, 1024
    buffer_load_dwordx4 v4, s[12:15], s29 offen  lds
    s_add_u32 m0, s28, 65536
    s_add_u32 s29, s41, 2048
    buffer_load_dwordx4 v4, s[12:15], s29 offen  lds
    s_add_u32 m0, s27, 57344
    s_add_u32 s29, s42, 0
    buffer_load_dwordx4 v2, s[8:11], s29 offen  lds
    s_add_u32 m0, s27, 58368
    s_add_u32 s29, s42, 0
    buffer_load_dwordx4 v3, s[8:11], s29 offen  lds
    s_add_u32 m0, s27, 59392
    s_add_u32 s29, s42, 16384
    buffer_load_dwordx4 v2, s[8:11], s29 offen  lds
    s_add_u32 m0, s27, 60416
    s_add_u32 s29, s42, 16384
    buffer_load_dwordx4 v3, s[8:11], s29 offen  lds
    s_waitcnt lgkmcnt(0)
    v_dot2c_f32_bf16 v28, s30, v48
    v_dot2c_f32_bf16 v29, s30, v52
    v_dot2c_f32_bf16 v30, s30, v56
    v_dot2c_f32_bf16 v28, s30, v49
    v_dot2c_f32_bf16 v29, s30, v53
    v_dot2c_f32_bf16 v30, s30, v57
    v_dot2c_f32_bf16 v28, s30, v50
    v_dot2c_f32_bf16 v29, s30, v54
    v_dot2c_f32_bf16 v30, s30, v58
    v_dot2c_f32_bf16 v28, s30, v51
    v_dot2c_f32_bf16 v29, s30, v55
    v_dot2c_f32_bf16 v30, s30, v59
    s_waitcnt vmcnt(7)
    s_barrier
    ds_read_b64_tr_b16 v[48:49], v20 offset:45056
    ds_read_b64_tr_b16 v[50:51], v20 offset:45312
    ds_read_b64_tr_b16 v[52:53], v20 offset:49152
    ds_read_b64_tr_b16 v[54:55], v20 offset:49408
    ds_read_b64_tr_b16 v[56:57], v20 offset:53248
    ds_read_b64_tr_b16 v[58:59], v20 offset:53504
    s_waitcnt lgkmcnt(0)
    v_dot2c_f32_bf16 v28, s30, v48
    v_dot2c_f32_bf16 v29, s30, v52
    v_dot2c_f32_bf16 v30, s30, v56
    v_dot2c_f32_bf16 v28, s30, v49
    v_dot2c_f32_bf16 v29, s30, v53
    v_dot2c_f32_bf16 v30, s30, v57
    v_dot2c_f32_bf16 v28, s30, v50
    v_dot2c_f32_bf16 v29, s30, v54
    v_dot2c_f32_bf16 v30, s30, v58
    v_dot2c_f32_bf16 v28, s30, v51
    v_dot2c_f32_bf16 v29, s30, v55
    v_dot2c_f32_bf16 v30, s30, v59
    s_waitcnt vmcnt(0)
    s_barrier
    ds_read_b64_tr_b16 v[48:49], v21 offset:16384
    ds_read_b64_tr_b16 v[50:51], v21 offset:16640
    ds_read_b64_tr_b16 v[52:53], v21 offset:20480
    ds_read_b64_tr_b16 v[54:55], v21 offset:20736
    ds_read_b64_tr_b16 v[56:57], v21 offset:24576
    ds_read_b64_tr_b16 v[58:59], v21 offset:24832
    s_waitcnt lgkmcnt(0)
    v_dot2c_f32_bf16 v28, s30, v48
    v_dot2c_f32_bf16 v29, s30, v52
    v_dot2c_f32_bf16 v30, s30, v56
    v_dot2c_f32_bf16 v28, s30, v49
    v_dot2c_f32_bf16 v29, s30, v53
    v_dot2c_f32_bf16 v30, s30, v57
    v_dot2c_f32_bf16 v28, s30, v50
    v_dot2c_f32_bf16 v29, s30, v54
    v_dot2c_f32_bf16 v30, s30, v58
    v_dot2c_f32_bf16 v28, s30, v51
    v_dot2c_f32_bf16 v29, s30, v55
    v_dot2c_f32_bf16 v30, s30, v59
    v_and_b32 v5, 31, v0
    v_lshlrev_b32 v6, 4, v5
    s_lshl_b32 s29, s22, 2
    s_add_u32 s29, s29, 143360
    v_add_u32 v7, s29, v6
    v_mov_b32 v1, v28
    s_nop 1
    v_permlane32_swap_b32 v28, v1
    v_add_f32 v28, v28, v1
    ds_write_b32 v7, v28 offset:0
    v_mov_b32 v1, v29
    s_nop 1
    v_permlane32_swap_b32 v29, v1
    v_add_f32 v29, v29, v1
    ds_write_b32 v7, v29 offset:512
    v_mov_b32 v1, v30
    s_nop 1
    v_permlane32_swap_b32 v30, v1
    v_add_f32 v30, v30, v1
    ds_write_b32 v7, v30 offset:1024
    s_min_u32 s29, s22, 2
    s_lshl_b32 s31, s29, 9
    s_add_u32 s31, s31, 143360
    v_add_u32 v6, s31, v6
    s_lshl_b32 s31, s29, 8
    s_add_u32 s31, s31, 145408
    v_lshlrev_b32 v7, 3, v5
    v_add_u32 v7, s31, v7
    s_waitcnt lgkmcnt(0)
    s_barrier
    ds_read_b128 v[32:35], v6
    s_waitcnt lgkmcnt(0)
    v_add_f32 v32, v32, v33
    v_add_f32 v34, v34, v35
    v_add_f32 v34, v32, v34
    v_cvt_pk_bf16_f32 v32, v34, v34
    v_lshlrev_b32 v33, 16, v32
    v_sub_f32 v33, v34, v33
    v_cvt_pk_bf16_f32 v33, v33, v33
    ds_write_b64 v7, v[32:33]
    s_waitcnt lgkmcnt(0)
    s_barrier
    s_cmp_eq_u32 s35, 7
    s_cbranch_scc0 K1_JOIN
    s_mov_b32 s16, s56
    s_mov_b32 s17, s57
    s_mov_b32 s18, 0x100
    s_mov_b32 s19, 0x00020000
    v_mov_b32 v12, 0
    s_mov_b32 s33, 0
K1_PZ:
    buffer_load_dword v15, v12, s[16:19], 0 offen sc1
    s_add_u32 s33, s33, 1
    s_waitcnt vmcnt(0)
    v_cmp_eq_u32 vcc, 1, v15
    s_cmp_gt_u32 s33, 0x40000
    s_cbranch_scc1 K1_JOIN
    s_cbranch_vccz K1_PZ
    s_branch K1_JOIN
K1_MM:
    v_and_b32 v5, 31, v0
    v_lshrrev_b32 v6, 5, v0
    v_bfe_u32 v7, v0, 1, 3
    v_xor_b32 v7, v7, v6
    v_lshlrev_b32 v5, 7, v5
    v_add_u32 v5, s27, v5
    v_xor_b32 v1, 0, v7
    v_lshl_add_u32 v8, v1, 4, v5
    v_add_u32 v12, 57344, v8
    v_add_u32 v16, 114688, v8
    v_xor_b32 v1, 2, v7
    v_lshl_add_u32 v9, v1, 4, v5
    v_add_u32 v13, 57344, v9
    v_add_u32 v17, 114688, v9
    v_xor_b32 v1, 4, v7
    v_lshl_add_u32 v10, v1, 4, v5
    v_add_u32 v14, 57344, v10
    v_add_u32 v18, 114688, v10
    v_xor_b32 v1, 6, v7
    v_lshl_add_u32 v11, v1, 4, v5
    v_add_u32 v15, 57344, v11
    v_add_u32 v19, 114688, v11
    v_bfe_u32 v1, v0, 2, 2
    v_lshl_add_u32 v1, v6, 3, v1
    v_lshlrev_b32 v20, 6, v1
    v_bfe_u32 v1, v0, 4, 1
    v_lshl_add_u32 v20, v1, 5, v20
    v_and_b32 v1, 3, v0
    v_lshl_add_u32 v20, v1, 3, v20
    v_add_u32 v21, 57344, v20
    v_add_u32 v22, 114688, v20
    s_mov_b32 s30, 0x3f803f80
    v_mov_b32 v24, 0
    v_mov_b32 v25, 0
    v_mov_b32 v26, 0
    v_mov_b32 v27, 0
    v_and_b32 v5, 31, v0
    v_lshlrev_b32 v6, 3, v5
    v_add_u32 v6, 145408, v6
    v_mov_b32 v154, 0
    v_mov_b32 v155, 0
    v_mov_b32 v158, 0
    v_mov_b32 v159, 0
    v_mov_b32 v162, 0
    v_mov_b32 v163, 0
    v_mov_b32 v150, 0
    v_mov_b32 v151, 0
    s_lshl_b32 s29, s22, 7
    s_add_u32 s29, s29, 144896
    v_lshlrev_b32 v7, 2, v5
    v_add_u32 v7, s29, v7
    v_lshrrev_b32 v1, 5, v0
    v_lshlrev_b32 v1, 4, v1
    v_add_u32 v1, s29, v1
    s_lshl_b32 s29, s23, 2
    s_add_u32 s29, s29, s22
    s_lshl_b32 s29, s29, 10
    s_lshl_b32 s31, s24, 17
    s_add_u32 s29, s29, s31
    s_add_u32 s31, s29, 65536
    s_add_u32 s32, s29, 2097152
    s_add_u32 s33, s29, 2162688
    s_add_u32 s34, s29, 4194304
    v_lshlrev_b32 v2, 4, v0
    v_bfe_u32 v3, v0, 4, 1
    v_lshlrev_b32 v3, 16, v3
    v_lshrrev_b32 v4, 5, v0
    v_lshl_add_u32 v3, v4, 8, v3
    v_and_b32 v4, 15, v0
    v_lshl_add_u32 v3, v4, 4, v3
    s_waitcnt lgkmcnt(0)
    s_mov_b32 s16, s58
    s_mov_b32 s17, s59
    s_mov_b32 s18, 0x10000000
    s_mov_b32 s19, 0x00020000
    s_lshl_b32 s36, s2, 2
    s_add_u32 s36, s36, s22
    s_cmp_lg_u32 s36, 3
    s_cbranch_scc1 K1_NZ
    s_mov_b32 s36, 11534336
    v_lshlrev_b32 v28, 7, v0
    buffer_store_dwordx2 v[24:25], v28, s[16:19], s36 offen sc1
    s_add_u32 s36, s36, 8192
    buffer_store_dwordx2 v[24:25], v28, s[16:19], s36 offen sc1
    s_add_u32 s36, s36, 8192
    s_mov_b32 s8, s56
    s_mov_b32 s9, s57
    s_mov_b32 s10, 0x100
    s_mov_b32 s11, 0x00020000
    v_mov_b32 v28, 1
    s_waitcnt vmcnt(0)
    buffer_store_dword v28, v24, s[8:11], 0 offen sc1
K1_NZ:
    s_mov_b32 s8, s4
    s_mov_b32 s9, s5
    s_mov_b32 s10, 0x200000
    s_mov_b32 s11, 0x00020000
    s_lshr_b32 s37, s2, 3
    v_and_b32 v28, 3, v0
    s_mov_b32 s39, 256
    s_and_b32 s36, s2, 3
    s_lshl_b32 s36, s36, 19
    s_lshl_b32 s38, s37, 14
    s_add_u32 s36, s36, s38
    v_bfe_u32 v23, v0, 1, 4
    v_lshlrev_b32 v23, 10, v23
    v_and_b32 v29, 1, v0
    v_lshl_add_u32 v23, v29, 7, v23
    s_cmp_lg_u32 s22, 0
    s_cbranch_scc1 K1_TD
    s_mov_b32 s8, s6
    s_mov_b32 s9, s7
    s_mov_b32 s10, 0x180000
    s_mov_b32 s11, 0x00020000
    s_mov_b32 s39, 393216
    s_mul_i32 s36, s37, 12288
    s_bfe_u32 s38, s2, 0x10002
    s_lshl_b32 s38, s38, 9
    s_add_u32 s36, s36, s38
    v_lshrrev_b32 v23, 4, v0
    v_mul_u32_u24 v23, 3072, v23
    v_bfe_u32 v30, v0, 2, 2
    v_min_u32 v30, 2, v30
    v_lshl_add_u32 v23, v30, 10, v23
    v_lshl_add_u32 v23, v28, 7, v23
K1_TD:
    s_cmp_ge_u32 s22, 2
    s_cbranch_scc1 K1_TS0
    s_lshr_b32 s38, s40, 1
    s_add_u32 s38, s38, 1
    s_and_b32 s38, s38, 3
    s_mul_i32 s38, s38, s39
    s_add_u32 s38, s38, s36
    buffer_load_dword v31, v23, s[8:11], s38 offen
    K1_TS0:
    s_barrier
    ds_read_b128 v[80:83], v8 offset:0
    ds_read_b64_tr_b16 v[112:113], v20 offset:16384
    ds_read_b64_tr_b16 v[114:115], v20 offset:16640
    ds_read_b64_tr_b16 v[116:117], v20 offset:20480
    ds_read_b64_tr_b16 v[118:119], v20 offset:20736
    ds_read_b64_tr_b16 v[120:121], v20 offset:24576
    ds_read_b64_tr_b16 v[122:123], v20 offset:24832
    ds_read_b128 v[84:87], v9 offset:0
    ds_read_b64_tr_b16 v[124:125], v20 offset:17408
    ds_read_b64_tr_b16 v[126:127], v20 offset:17664
    ds_read_b64_tr_b16 v[128:129], v20 offset:21504
    ds_read_b64_tr_b16 v[130:131], v20 offset:21760
    ds_read_b64_tr_b16 v[132:133], v20 offset:25600
    ds_read_b64_tr_b16 v[134:135], v20 offset:25856
    s_cmp_ge_u32 s22, 2
    s_cbranch_scc1 K1_TS1
    s_lshr_b32 s38, s40, 1
    s_add_u32 s38, s38, 2
    s_and_b32 s38, s38, 3
    s_mul_i32 s38, s38, s39
    s_add_u32 s38, s38, s36
    buffer_load_dword v31, v23, s[8:11], s38 offen
    K1_TS1:
    s_waitcnt lgkmcnt(7)
    v_mfma_f32_32x32x16_bf16 v[32:47], v[112:115], v[80:83], 0
    ds_read_b128 v[88:91], v10 offset:0
    ds_read_b64_tr_b16 v[136:137], v20 offset:18432
    ds_read_b64_tr_b16 v[138:139], v20 offset:18688
    v_mfma_f32_32x32x16_bf16 v[48:63], v[116:119], v[80:83], 0
    ds_read_b64_tr_b16 v[140:141], v20 offset:22528
    ds_read_b64_tr_b16 v[142:143], v20 offset:22784
    ds_read_b64_tr_b16 v[144:145], v20 offset:26624
    v_mfma_f32_32x32x16_bf16 v[64:79], v[80:83], v[120:123], 0
    ds_read_b64_tr_b16 v[146:147], v20 offset:26880
    s_waitcnt lgkmcnt(7)
    v_mfma_f32_32x32x16_bf16 v[32:47], v[124:127], v[84:87], v[32:47]
    ds_read_b128 v[92:95], v11 offset:0
    ds_read_b64_tr_b16 v[112:113], v20 offset:19456
    ds_read_b64_tr_b16 v[114:115], v20 offset:19712
    v_mfma_f32_32x32x16_bf16 v[48:63], v[128:131], v[84:87], v[48:63]
    ds_read_b64_tr_b16 v[116:117], v20 offset:23552
    ds_read_b64_tr_b16 v[118:119], v20 offset:23808
    ds_read_b64_tr_b16 v[120:121], v20 offset:27648
    v_mfma_f32_32x32x16_bf16 v[64:79], v[84:87], v[132:135], v[64:79]
    ds_read_b64_tr_b16 v[122:123], v20 offset:27904
    v_dot2c_f32_bf16 v24, s30, v80
    v_dot2c_f32_bf16 v26, v80, v80
    v_dot2c_f32_bf16 v25, s30, v81
    v_dot2c_f32_bf16 v27, v81, v81
    v_dot2c_f32_bf16 v24, s30, v82
    v_dot2c_f32_bf16 v26, v82, v82
    v_dot2c_f32_bf16 v25, s30, v83
    v_dot2c_f32_bf16 v27, v83, v83
    v_dot2c_f32_bf16 v24, s30, v84
    v_dot2c_f32_bf16 v26, v84, v84
    v_dot2c_f32_bf16 v25, s30, v85
    v_dot2c_f32_bf16 v27, v85, v85
    v_dot2c_f32_bf16 v24, s30, v86
    v_dot2c_f32_bf16 v26, v86, v86
    v_dot2c_f32_bf16 v25, s30, v87
    v_dot2c_f32_bf16 v27, v87, v87
    s_waitcnt lgkmcnt(0)
    v_dot2c_f32_bf16 v24, s30, v88
    v_dot2c_f32_bf16 v26, v88, v88
    v_dot2c_f32_bf16 v25, s30, v89
    v_dot2c_f32_bf16 v27, v89, v89
    v_dot2c_f32_bf16 v24, s30, v90
    v_dot2c_f32_bf16 v26, v90, v90
    v_dot2c_f32_bf16 v25, s30, v91
    v_dot2c_f32_bf16 v27, v91, v91
    v_mfma_f32_32x32x16_bf16 v[32:47], v[136:139], v[88:91], v[32:47]
    s_barrier
    s_cmp_ge_u32 s22, 2
    s_cbranch_scc1 K1_TS2
    s_lshr_b32 s38, s40, 1
    s_add_u32 s38, s38, 3
    s_and_b32 s38, s38, 3
    s_mul_i32 s38, s38, s39
    s_add_u32 s38, s38, s36
    buffer_load_dword v31, v23, s[8:11], s38 offen
    K1_TS2:
    ds_read_b128 v[96:99], v8 offset:28672
    ds_read_b64_tr_b16 v[124:125], v20 offset:45056
    ds_read_b64_tr_b16 v[126:127], v20 offset:45312
    v_mfma_f32_32x32x16_bf16 v[48:63], v[140:143], v[88:91], v[48:63]
    ds_read_b64_tr_b16 v[128:129], v20 offset:49152
    ds_read_b64_tr_b16 v[130:131], v20 offset:49408
    ds_read_b64_tr_b16 v[132:133], v20 offset:53248
    v_mfma_f32_32x32x16_bf16 v[64:79], v[88:91], v[144:147], v[64:79]
    ds_read_b64_tr_b16 v[134:135], v20 offset:53504
    s_waitcnt lgkmcnt(7)
    v_mfma_f32_32x32x16_bf16 v[32:47], v[112:115], v[92:95], v[32:47]
    ds_read_b128 v[100:103], v9 offset:28672
    ds_read_b64_tr_b16 v[136:137], v20 offset:46080
    ds_read_b64_tr_b16 v[138:139], v20 offset:46336
    v_mfma_f32_32x32x16_bf16 v[48:63], v[116:119], v[92:95], v[48:63]
    ds_read_b64_tr_b16 v[140:141], v20 offset:50176
    ds_read_b64_tr_b16 v[142:143], v20 offset:50432
    ds_read_b64_tr_b16 v[144:145], v20 offset:54272
    v_mfma_f32_32x32x16_bf16 v[64:79], v[92:95], v[120:123], v[64:79]
    ds_read_b64_tr_b16 v[146:147], v20 offset:54528
    s_waitcnt lgkmcnt(7)
    v_mfma_f32_32x32x16_bf16 v[32:47], v[124:127], v[96:99], v[32:47]
    ds_read_b128 v[104:107], v10 offset:28672
    ds_read_b64_tr_b16 v[112:113], v20 offset:47104
    ds_read_b64_tr_b16 v[114:115], v20 offset:47360
    v_mfma_f32_32x32x16_bf16 v[48:63], v[128:131], v[96:99], v[48:63]
    ds_read_b64_tr_b16 v[116:117], v20 offset:51200
    ds_read_b64_tr_b16 v[118:119], v20 offset:51456
    ds_read_b64_tr_b16 v[120:121], v20 offset:55296
    v_mfma_f32_32x32x16_bf16 v[64:79], v[96:99], v[132:135], v[64:79]
    ds_read_b64_tr_b16 v[122:123], v20 offset:55552
    s_waitcnt lgkmcnt(7)
    v_mfma_f32_32x32x16_bf16 v[32:47], v[136:139], v[100:103], v[32:47]
    ds_read_b128 v[108:111], v11 offset:28672
    ds_read_b64_tr_b16 v[124:125], v20 offset:48128
    ds_read_b64_tr_b16 v[126:127], v20 offset:48384
    v_mfma_f32_32x32x16_bf16 v[48:63], v[140:143], v[100:103], v[48:63]
    ds_read_b64_tr_b16 v[128:129], v20 offset:52224
    ds_read_b64_tr_b16 v[130:131], v20 offset:52480
    ds_read_b64_tr_b16 v[132:133], v20 offset:56320
    v_mfma_f32_32x32x16_bf16 v[64:79], v[100:103], v[144:147], v[64:79]
    ds_read_b64_tr_b16 v[134:135], v20 offset:56576
    v_dot2c_f32_bf16 v24, s30, v92
    v_dot2c_f32_bf16 v26, v92, v92
    v_dot2c_f32_bf16 v25, s30, v93
    v_dot2c_f32_bf16 v27, v93, v93
    v_dot2c_f32_bf16 v24, s30, v94
    v_dot2c_f32_bf16 v26, v94, v94
    v_dot2c_f32_bf16 v25, s30, v95
    v_dot2c_f32_bf16 v27, v95, v95
    v_dot2c_f32_bf16 v24, s30, v96
    v_dot2c_f32_bf16 v26, v96, v96
    v_dot2c_f32_bf16 v25, s30, v97
    v_dot2c_f32_bf16 v27, v97, v97
    v_dot2c_f32_bf16 v24, s30, v98
    v_dot2c_f32_bf16 v26, v98, v98
    v_dot2c_f32_bf16 v25, s30, v99
    v_dot2c_f32_bf16 v27, v99, v99
    v_dot2c_f32_bf16 v24, s30, v100
    v_dot2c_f32_bf16 v26, v100, v100
    v_dot2c_f32_bf16 v25, s30, v101
    v_dot2c_f32_bf16 v27, v101, v101
    v_dot2c_f32_bf16 v24, s30, v102
    v_dot2c_f32_bf16 v26, v102, v102
    v_dot2c_f32_bf16 v25, s30, v103
    v_dot2c_f32_bf16 v27, v103, v103
    s_waitcnt lgkmcnt(0)
    v_dot2c_f32_bf16 v24, s30, v104
    v_dot2c_f32_bf16 v26, v104, v104
    v_dot2c_f32_bf16 v25, s30, v105
    v_dot2c_f32_bf16 v27, v105, v105
    v_dot2c_f32_bf16 v24, s30, v106
    v_dot2c_f32_bf16 v26, v106, v106
    v_dot2c_f32_bf16 v25, s30, v107
    v_dot2c_f32_bf16 v27, v107, v107
    v_mfma_f32_32x32x16_bf16 v[32:47], v[112:115], v[104:107], v[32:47]
    s_barrier
    ds_read_b128 v[80:83], v12 offset:0
    ds_read_b64_tr_b16 v[136:137], v21 offset:16384
    ds_read_b64_tr_b16 v[138:139], v21 offset:16640
    v_mfma_f32_32x32x16_bf16 v[48:63], v[116:119], v[104:107], v[48:63]
    ds_read_b64_tr_b16 v[140:141], v21 offset:20480
    ds_read_b64_tr_b16 v[142:143], v21 offset:20736
    ds_read_b64_tr_b16 v[144:145], v21 offset:24576
    v_mfma_f32_32x32x16_bf16 v[64:79], v[104:107], v[120:123], v[64:79]
    ds_read_b64_tr_b16 v[146:147], v21 offset:24832
    s_waitcnt lgkmcnt(7)
    v_mfma_f32_32x32x16_bf16 v[32:47], v[124:127], v[108:111], v[32:47]
    ds_read_b128 v[84:87], v13 offset:0
    ds_read_b64_tr_b16 v[112:113], v21 offset:17408
    ds_read_b64_tr_b16 v[114:115], v21 offset:17664
    v_mfma_f32_32x32x16_bf16 v[48:63], v[128:131], v[108:111], v[48:63]
    ds_read_b64_tr_b16 v[116:117], v21 offset:21504
    ds_read_b64_tr_b16 v[118:119], v21 offset:21760
    ds_read_b64_tr_b16 v[120:121], v21 offset:25600
    v_mfma_f32_32x32x16_bf16 v[64:79], v[108:111], v[132:135], v[64:79]
    ds_read_b64_tr_b16 v[122:123], v21 offset:25856
    s_waitcnt lgkmcnt(7)
    v_mfma_f32_32x32x16_bf16 v[32:47], v[136:139], v[80:83], v[32:47]
    ds_read_b128 v[88:91], v14 offset:0
    ds_read_b64_tr_b16 v[124:125], v21 offset:18432
    ds_read_b64_tr_b16 v[126:127], v21 offset:18688
    v_mfma_f32_32x32x16_bf16 v[48:63], v[140:143], v[80:83], v[48:63]
    ds_read_b64_tr_b16 v[128:129], v21 offset:22528
    ds_read_b64_tr_b16 v[130:131], v21 offset:22784
    ds_read_b64_tr_b16 v[132:133], v21 offset:26624
    v_mfma_f32_32x32x16_bf16 v[64:79], v[80:83], v[144:147], v[64:79]
    ds_read_b64_tr_b16 v[134:135], v21 offset:26880
    s_waitcnt lgkmcnt(7)
    v_mfma_f32_32x32x16_bf16 v[32:47], v[112:115], v[84:87], v[32:47]
    ds_read_b128 v[92:95], v15 offset:0
    ds_read_b64_tr_b16 v[136:137], v21 offset:19456
    ds_read_b64_tr_b16 v[138:139], v21 offset:19712
    v_mfma_f32_32x32x16_bf16 v[48:63], v[116:119], v[84:87], v[48:63]
    ds_read_b64_tr_b16 v[140:141], v21 offset:23552
    ds_read_b64_tr_b16 v[142:143], v21 offset:23808
    ds_read_b64_tr_b16 v[144:145], v21 offset:27648
    v_mfma_f32_32x32x16_bf16 v[64:79], v[84:87], v[120:123], v[64:79]
    ds_read_b64_tr_b16 v[146:147], v21 offset:27904
    v_dot2c_f32_bf16 v24, s30, v108
    v_dot2c_f32_bf16 v26, v108, v108
    v_dot2c_f32_bf16 v25, s30, v109
    v_dot2c_f32_bf16 v27, v109, v109
    v_dot2c_f32_bf16 v24, s30, v110
    v_dot2c_f32_bf16 v26, v110, v110
    v_dot2c_f32_bf16 v25, s30, v111
    v_dot2c_f32_bf16 v27, v111, v111
    v_dot2c_f32_bf16 v24, s30, v80
    v_dot2c_f32_bf16 v26, v80, v80
    v_dot2c_f32_bf16 v25, s30, v81
    v_dot2c_f32_bf16 v27, v81, v81
    v_dot2c_f32_bf16 v24, s30, v82
    v_dot2c_f32_bf16 v26, v82, v82
    v_dot2c_f32_bf16 v25, s30, v83
    v_dot2c_f32_bf16 v27, v83, v83
    v_dot2c_f32_bf16 v24, s30, v84
    v_dot2c_f32_bf16 v26, v84, v84
    v_dot2c_f32_bf16 v25, s30, v85
    v_dot2c_f32_bf16 v27, v85, v85
    v_dot2c_f32_bf16 v24, s30, v86
    v_dot2c_f32_bf16 v26, v86, v86
    v_dot2c_f32_bf16 v25, s30, v87
    v_dot2c_f32_bf16 v27, v87, v87
    s_waitcnt lgkmcnt(0)
    v_dot2c_f32_bf16 v24, s30, v88
    v_dot2c_f32_bf16 v26, v88, v88
    v_dot2c_f32_bf16 v25, s30, v89
    v_dot2c_f32_bf16 v27, v89, v89
    v_dot2c_f32_bf16 v24, s30, v90
    v_dot2c_f32_bf16 v26, v90, v90
    v_dot2c_f32_bf16 v25, s30, v91
    v_dot2c_f32_bf16 v27, v91, v91
    v_mfma_f32_32x32x16_bf16 v[32:47], v[124:127], v[88:91], v[32:47]
    s_barrier
    ds_read_b128 v[96:99], v12 offset:28672
    ds_read_b64_tr_b16 v[112:113], v21 offset:45056
    ds_read_b64_tr_b16 v[114:115], v21 offset:45312
    v_mfma_f32_32x32x16_bf16 v[48:63], v[128:131], v[88:91], v[48:63]
    ds_read_b64_tr_b16 v[116:117], v21 offset:49152
    ds_read_b64_tr_b16 v[118:119], v21 offset:49408
    ds_read_b64_tr_b16 v[120:121], v21 offset:53248
    v_mfma_f32_32x32x16_bf16 v[64:79], v[88:91], v[132:135], v[64:79]
    ds_read_b64_tr_b16 v[122:123], v21 offset:53504
    s_waitcnt lgkmcnt(7)
    v_mfma_f32_32x32x16_bf16 v[32:47], v[136:139], v[92:95], v[32:47]
    ds_read_b128 v[100:103], v13 offset:28672
    ds_read_b64_tr_b16 v[124:125], v21 offset:46080
    ds_read_b64_tr_b16 v[126:127], v21 offset:46336
    v_mfma_f32_32x32x16_bf16 v[48:63], v[140:143], v[92:95], v[48:63]
    ds_read_b64_tr_b16 v[128:129], v21 offset:50176
    ds_read_b64_tr_b16 v[130:131], v21 offset:50432
    ds_read_b64_tr_b16 v[132:133], v21 offset:54272
    v_mfma_f32_32x32x16_bf16 v[64:79], v[92:95], v[144:147], v[64:79]
    ds_read_b64_tr_b16 v[134:135], v21 offset:54528
    s_waitcnt lgkmcnt(7)
    v_mfma_f32_32x32x16_bf16 v[32:47], v[112:115], v[96:99], v[32:47]
    ds_read_b128 v[104:107], v14 offset:28672
    ds_read_b64_tr_b16 v[136:137], v21 offset:47104
    ds_read_b64_tr_b16 v[138:139], v21 offset:47360
    v_mfma_f32_32x32x16_bf16 v[48:63], v[116:119], v[96:99], v[48:63]
    ds_read_b64_tr_b16 v[140:141], v21 offset:51200
    ds_read_b64_tr_b16 v[142:143], v21 offset:51456
    ds_read_b64_tr_b16 v[144:145], v21 offset:55296
    v_mfma_f32_32x32x16_bf16 v[64:79], v[96:99], v[120:123], v[64:79]
    ds_read_b64_tr_b16 v[146:147], v21 offset:55552
    s_waitcnt lgkmcnt(7)
    v_mfma_f32_32x32x16_bf16 v[32:47], v[124:127], v[100:103], v[32:47]
    ds_read_b128 v[108:111], v15 offset:28672
    ds_read_b64_tr_b16 v[112:113], v21 offset:48128
    ds_read_b64_tr_b16 v[114:115], v21 offset:48384
    v_mfma_f32_32x32x16_bf16 v[48:63], v[128:131], v[100:103], v[48:63]
    ds_read_b64_tr_b16 v[116:117], v21 offset:52224
    ds_read_b64_tr_b16 v[118:119], v21 offset:52480
    ds_read_b64_tr_b16 v[120:121], v21 offset:56320
    v_mfma_f32_32x32x16_bf16 v[64:79], v[100:103], v[132:135], v[64:79]
    ds_read_b64_tr_b16 v[122:123], v21 offset:56576
    v_dot2c_f32_bf16 v24, s30, v92
    v_dot2c_f32_bf16 v26, v92, v92
    v_dot2c_f32_bf16 v25, s30, v93
    v_dot2c_f32_bf16 v27, v93, v93
    v_dot2c_f32_bf16 v24, s30, v94
    v_dot2c_f32_bf16 v26, v94, v94
    v_dot2c_f32_bf16 v25, s30, v95
    v_dot2c_f32_bf16 v27, v95, v95
    v_dot2c_f32_bf16 v24, s30, v96
    v_dot2c_f32_bf16 v26, v96, v96
    v_dot2c_f32_bf16 v25, s30, v97
    v_dot2c_f32_bf16 v27, v97, v97
    v_dot2c_f32_bf16 v24, s30, v98
    v_dot2c_f32_bf16 v26, v98, v98
    v_dot2c_f32_bf16 v25, s30, v99
    v_dot2c_f32_bf16 v27, v99, v99
    v_dot2c_f32_bf16 v24, s30, v100
    v_dot2c_f32_bf16 v26, v100, v100
    v_dot2c_f32_bf16 v25, s30, v101
    v_dot2c_f32_bf16 v27, v101, v101
    v_dot2c_f32_bf16 v24, s30, v102
    v_dot2c_f32_bf16 v26, v102, v102
    v_dot2c_f32_bf16 v25, s30, v103
    v_dot2c_f32_bf16 v27, v103, v103
    s_waitcnt lgkmcnt(0)
    v_dot2c_f32_bf16 v24, s30, v104
    v_dot2c_f32_bf16 v26, v104, v104
    v_dot2c_f32_bf16 v25, s30, v105
    v_dot2c_f32_bf16 v27, v105, v105
    v_dot2c_f32_bf16 v24, s30, v106
    v_dot2c_f32_bf16 v26, v106, v106
    v_dot2c_f32_bf16 v25, s30, v107
    v_dot2c_f32_bf16 v27, v107, v107
    v_mfma_f32_32x32x16_bf16 v[32:47], v[136:139], v[104:107], v[32:47]
    s_barrier
    ds_read_b128 v[80:83], v16 offset:0
    ds_read_b64_tr_b16 v[124:125], v22 offset:16384
    ds_read_b64_tr_b16 v[126:127], v22 offset:16640
    v_mfma_f32_32x32x16_bf16 v[48:63], v[140:143], v[104:107], v[48:63]
    ds_read_b64_tr_b16 v[128:129], v22 offset:20480
    ds_read_b64_tr_b16 v[130:131], v22 offset:20736
    ds_read_b64_tr_b16 v[132:133], v22 offset:24576
    v_mfma_f32_32x32x16_bf16 v[64:79], v[104:107], v[144:147], v[64:79]
    ds_read_b64_tr_b16 v[134:135], v22 offset:24832
    s_waitcnt lgkmcnt(7)
    v_mfma_f32_32x32x16_bf16 v[32:47], v[112:115], v[108:111], v[32:47]
    ds_read_b128 v[84:87], v17 offset:0
    ds_read_b64_tr_b16 v[136:137], v22 offset:17408
    ds_read_b64_tr_b16 v[138:139], v22 offset:17664
    v_mfma_f32_32x32x16_bf16 v[48:63], v[116:119], v[108:111], v[48:63]
    ds_read_b64_tr_b16 v[140:141], v22 offset:21504
    ds_read_b64_tr_b16 v[142:143], v22 offset:21760
    ds_read_b64_tr_b16 v[144:145], v22 offset:25600
    v_mfma_f32_32x32x16_bf16 v[64:79], v[108:111], v[120:123], v[64:79]
    ds_read_b64_tr_b16 v[146:147], v22 offset:25856
    s_waitcnt lgkmcnt(7)
    v_mfma_f32_32x32x16_bf16 v[32:47], v[124:127], v[80:83], v[32:47]
    ds_read_b128 v[88:91], v18 offset:0
    ds_read_b64_tr_b16 v[112:113], v22 offset:18432
    ds_read_b64_tr_b16 v[114:115], v22 offset:18688
    v_mfma_f32_32x32x16_bf16 v[48:63], v[128:131], v[80:83], v[48:63]
    ds_read_b64_tr_b16 v[116:117], v22 offset:22528
    ds_read_b64_tr_b16 v[118:119], v22 offset:22784
    ds_read_b64_tr_b16 v[120:121], v22 offset:26624
    v_mfma_f32_32x32x16_bf16 v[64:79], v[80:83], v[132:135], v[64:79]
    ds_read_b64_tr_b16 v[122:123], v22 offset:26880
    s_waitcnt lgkmcnt(7)
    v_mfma_f32_32x32x16_bf16 v[32:47], v[136:139], v[84:87], v[32:47]
    ds_read_b128 v[92:95], v19 offset:0
    ds_read_b64_tr_b16 v[124:125], v22 offset:19456
    ds_read_b64_tr_b16 v[126:127], v22 offset:19712
    v_mfma_f32_32x32x16_bf16 v[48:63], v[140:143], v[84:87], v[48:63]
    ds_read_b64_tr_b16 v[128:129], v22 offset:23552
    ds_read_b64_tr_b16 v[130:131], v22 offset:23808
    ds_read_b64_tr_b16 v[132:133], v22 offset:27648
    v_mfma_f32_32x32x16_bf16 v[64:79], v[84:87], v[144:147], v[64:79]
    ds_read_b64_tr_b16 v[134:135], v22 offset:27904
    v_dot2c_f32_bf16 v24, s30, v108
    v_dot2c_f32_bf16 v26, v108, v108
    v_dot2c_f32_bf16 v25, s30, v109
    v_dot2c_f32_bf16 v27, v109, v109
    v_dot2c_f32_bf16 v24, s30, v110
    v_dot2c_f32_bf16 v26, v110, v110
    v_dot2c_f32_bf16 v25, s30, v111
    v_dot2c_f32_bf16 v27, v111, v111
    v_dot2c_f32_bf16 v24, s30, v80
    v_dot2c_f32_bf16 v26, v80, v80
    v_dot2c_f32_bf16 v25, s30, v81
    v_dot2c_f32_bf16 v27, v81, v81
    v_dot2c_f32_bf16 v24, s30, v82
    v_dot2c_f32_bf16 v26, v82, v82
    v_dot2c_f32_bf16 v25, s30, v83
    v_dot2c_f32_bf16 v27, v83, v83
    v_dot2c_f32_bf16 v24, s30, v84
    v_dot2c_f32_bf16 v26, v84, v84
    v_dot2c_f32_bf16 v25, s30, v85
    v_dot2c_f32_bf16 v27, v85, v85
    v_dot2c_f32_bf16 v24, s30, v86
    v_dot2c_f32_bf16 v26, v86, v86
    v_dot2c_f32_bf16 v25, s30, v87
    v_dot2c_f32_bf16 v27, v87, v87
    s_waitcnt lgkmcnt(0)
    v_dot2c_f32_bf16 v24, s30, v88
    v_dot2c_f32_bf16 v26, v88, v88
    v_dot2c_f32_bf16 v25, s30, v89
    v_dot2c_f32_bf16 v27, v89, v89
    v_dot2c_f32_bf16 v24, s30, v90
    v_dot2c_f32_bf16 v26, v90, v90
    v_dot2c_f32_bf16 v25, s30, v91
    v_dot2c_f32_bf16 v27, v91, v91
    v_mfma_f32_32x32x16_bf16 v[32:47], v[112:115], v[88:91], v[32:47]
    s_barrier
    ds_read_b128 v[96:99], v8 offset:0
    ds_read_b64_tr_b16 v[136:137], v20 offset:16384
    ds_read_b64_tr_b16 v[138:139], v20 offset:16640
    v_mfma_f32_32x32x16_bf16 v[48:63], v[116:119], v[88:91], v[48:63]
    ds_read_b64_tr_b16 v[140:141], v20 offset:20480
    ds_read_b64_tr_b16 v[142:143], v20 offset:20736
    ds_read_b64_tr_b16 v[144:145], v20 offset:24576
    v_mfma_f32_32x32x16_bf16 v[64:79], v[88:91], v[120:123], v[64:79]
    ds_read_b64_tr_b16 v[146:147], v20 offset:24832
    s_waitcnt lgkmcnt(7)
    v_mfma_f32_32x32x16_bf16 v[32:47], v[124:127], v[92:95], v[32:47]
    ds_read_b128 v[100:103], v9 offset:0
    ds_read_b64_tr_b16 v[112:113], v20 offset:17408
    ds_read_b64_tr_b16 v[114:115], v20 offset:17664
    v_mfma_f32_32x32x16_bf16 v[48:63], v[128:131], v[92:95], v[48:63]
    ds_read_b64_tr_b16 v[116:117], v20 offset:21504
    ds_read_b64_tr_b16 v[118:119], v20 offset:21760
    ds_read_b64_tr_b16 v[120:121], v20 offset:25600
    v_mfma_f32_32x32x16_bf16 v[64:79], v[92:95], v[132:135], v[64:79]
    ds_read_b64_tr_b16 v[122:123], v20 offset:25856
    s_waitcnt lgkmcnt(7)
    v_mfma_f32_32x32x16_bf16 v[32:47], v[136:139], v[96:99], v[32:47]
    ds_read_b128 v[104:107], v10 offset:0
    ds_read_b64_tr_b16 v[124:125], v20 offset:18432
    ds_read_b64_tr_b16 v[126:127], v20 offset:18688
    v_mfma_f32_32x32x16_bf16 v[48:63], v[140:143], v[96:99], v[48:63]
    ds_read_b64_tr_b16 v[128:129], v20 offset:22528
    ds_read_b64_tr_b16 v[130:131], v20 offset:22784
    ds_read_b64_tr_b16 v[132:133], v20 offset:26624
    v_mfma_f32_32x32x16_bf16 v[64:79], v[96:99], v[144:147], v[64:79]
    ds_read_b64_tr_b16 v[134:135], v20 offset:26880
    s_waitcnt lgkmcnt(7)
    v_mfma_f32_32x32x16_bf16 v[32:47], v[112:115], v[100:103], v[32:47]
    ds_read_b128 v[108:111], v11 offset:0
    ds_read_b64_tr_b16 v[136:137], v20 offset:19456
    ds_read_b64_tr_b16 v[138:139], v20 offset:19712
    v_mfma_f32_32x32x16_bf16 v[48:63], v[116:119], v[100:103], v[48:63]
    ds_read_b64_tr_b16 v[140:141], v20 offset:23552
    ds_read_b64_tr_b16 v[142:143], v20 offset:23808
    ds_read_b64_tr_b16 v[144:145], v20 offset:27648
    v_mfma_f32_32x32x16_bf16 v[64:79], v[100:103], v[120:123], v[64:79]
    ds_read_b64_tr_b16 v[146:147], v20 offset:27904
    v_dot2c_f32_bf16 v24, s30, v92
    v_dot2c_f32_bf16 v26, v92, v92
    v_dot2c_f32_bf16 v25, s30, v93
    v_dot2c_f32_bf16 v27, v93, v93
    v_dot2c_f32_bf16 v24, s30, v94
    v_dot2c_f32_bf16 v26, v94, v94
    v_dot2c_f32_bf16 v25, s30, v95
    v_dot2c_f32_bf16 v27, v95, v95
    v_dot2c_f32_bf16 v24, s30, v96
    v_dot2c_f32_bf16 v26, v96, v96
    v_dot2c_f32_bf16 v25, s30, v97
    v_dot2c_f32_bf16 v27, v97, v97
    v_dot2c_f32_bf16 v24, s30, v98
    v_dot2c_f32_bf16 v26, v98, v98
    v_dot2c_f32_bf16 v25, s30, v99
    v_dot2c_f32_bf16 v27, v99, v99
    v_dot2c_f32_bf16 v24, s30, v100
    v_dot2c_f32_bf16 v26, v100, v100
    v_dot2c_f32_bf16 v25, s30, v101
    v_dot2c_f32_bf16 v27, v101, v101
    v_dot2c_f32_bf16 v24, s30, v102
    v_dot2c_f32_bf16 v26, v102, v102
    v_dot2c_f32_bf16 v25, s30, v103
    v_dot2c_f32_bf16 v27, v103, v103
    s_waitcnt lgkmcnt(0)
    v_dot2c_f32_bf16 v24, s30, v104
    v_dot2c_f32_bf16 v26, v104, v104
    v_dot2c_f32_bf16 v25, s30, v105
    v_dot2c_f32_bf16 v27, v105, v105
    v_dot2c_f32_bf16 v24, s30, v106
    v_dot2c_f32_bf16 v26, v106, v106
    v_dot2c_f32_bf16 v25, s30, v107
    v_dot2c_f32_bf16 v27, v107, v107
    v_mfma_f32_32x32x16_bf16 v[32:47], v[124:127], v[104:107], v[32:47]
    s_barrier
    ds_read_b128 v[80:83], v8 offset:28672
    ds_read_b64_tr_b16 v[112:113], v20 offset:45056
    ds_read_b64_tr_b16 v[114:115], v20 offset:45312
    v_mfma_f32_32x32x16_bf16 v[48:63], v[128:131], v[104:107], v[48:63]
    ds_read_b64_tr_b16 v[116:117], v20 offset:49152
    ds_read_b64_tr_b16 v[118:119], v20 offset:49408
    ds_read_b64_tr_b16 v[120:121], v20 offset:53248
    v_mfma_f32_32x32x16_bf16 v[64:79], v[104:107], v[132:135], v[64:79]
    ds_read_b64_tr_b16 v[122:123], v20 offset:53504
    s_waitcnt lgkmcnt(7)
    v_mfma_f32_32x32x16_bf16 v[32:47], v[136:139], v[108:111], v[32:47]
    ds_read_b128 v[84:87], v9 offset:28672
    ds_read_b64_tr_b16 v[124:125], v20 offset:46080
    ds_read_b64_tr_b16 v[126:127], v20 offset:46336
    v_mfma_f32_32x32x16_bf16 v[48:63], v[140:143], v[108:111], v[48:63]
    ds_read_b64_tr_b16 v[128:129], v20 offset:50176
    ds_read_b64_tr_b16 v[130:131], v20 offset:50432
    ds_read_b64_tr_b16 v[132:133], v20 offset:54272
    v_mfma_f32_32x32x16_bf16 v[64:79], v[108:111], v[144:147], v[64:79]
    ds_read_b64_tr_b16 v[134:135], v20 offset:54528
    s_waitcnt lgkmcnt(7)
    v_mfma_f32_32x32x16_bf16 v[32:47], v[112:115], v[80:83], v[32:47]
    ds_read_b128 v[88:91], v10 offset:28672
    ds_read_b64_tr_b16 v[136:137], v20 offset:47104
    ds_read_b64_tr_b16 v[138:139], v20 offset:47360
    v_mfma_f32_32x32x16_bf16 v[48:63], v[116:119], v[80:83], v[48:63]
    ds_read_b64_tr_b16 v[140:141], v20 offset:51200
    ds_read_b64_tr_b16 v[142:143], v20 offset:51456
    ds_read_b64_tr_b16 v[144:145], v20 offset:55296
    v_mfma_f32_32x32x16_bf16 v[64:79], v[80:83], v[120:123], v[64:79]
    ds_read_b64_tr_b16 v[146:147], v20 offset:55552
    s_waitcnt lgkmcnt(7)
    v_mfma_f32_32x32x16_bf16 v[32:47], v[124:127], v[84:87], v[32:47]
    ds_read_b128 v[92:95], v11 offset:28672
    ds_read_b64_tr_b16 v[112:113], v20 offset:48128
    ds_read_b64_tr_b16 v[114:115], v20 offset:48384
    v_mfma_f32_32x32x16_bf16 v[48:63], v[128:131], v[84:87], v[48:63]
    ds_read_b64_tr_b16 v[116:117], v20 offset:52224
    ds_read_b64_tr_b16 v[118:119], v20 offset:52480
    ds_read_b64_tr_b16 v[120:121], v20 offset:56320
    v_mfma_f32_32x32x16_bf16 v[64:79], v[84:87], v[132:135], v[64:79]
    ds_read_b64_tr_b16 v[122:123], v20 offset:56576
    v_dot2c_f32_bf16 v24, s30, v108
    v_dot2c_f32_bf16 v26, v108, v108
    v_dot2c_f32_bf16 v25, s30, v109
    v_dot2c_f32_bf16 v27, v109, v109
    v_dot2c_f32_bf16 v24, s30, v110
    v_dot2c_f32_bf16 v26, v110, v110
    v_dot2c_f32_bf16 v25, s30, v111
    v_dot2c_f32_bf16 v27, v111, v111
    v_dot2c_f32_bf16 v24, s30, v80
    v_dot2c_f32_bf16 v26, v80, v80
    v_dot2c_f32_bf16 v25, s30, v81
    v_dot2c_f32_bf16 v27, v81, v81
    v_dot2c_f32_bf16 v24, s30, v82
    v_dot2c_f32_bf16 v26, v82, v82
    v_dot2c_f32_bf16 v25, s30, v83
    v_dot2c_f32_bf16 v27, v83, v83
    v_dot2c_f32_bf16 v24, s30, v84
    v_dot2c_f32_bf16 v26, v84, v84
    v_dot2c_f32_bf16 v25, s30, v85
    v_dot2c_f32_bf16 v27, v85, v85
    v_dot2c_f32_bf16 v24, s30, v86
    v_dot2c_f32_bf16 v26, v86, v86
    v_dot2c_f32_bf16 v25, s30, v87
    v_dot2c_f32_bf16 v27, v87, v87
    s_waitcnt lgkmcnt(0)
    v_dot2c_f32_bf16 v24, s30, v88
    v_dot2c_f32_bf16 v26, v88, v88
    v_dot2c_f32_bf16 v25, s30, v89
    v_dot2c_f32_bf16 v27, v89, v89
    v_dot2c_f32_bf16 v24, s30, v90
    v_dot2c_f32_bf16 v26, v90, v90
    v_dot2c_f32_bf16 v25, s30, v91
    v_dot2c_f32_bf16 v27, v91, v91
    v_mfma_f32_32x32x16_bf16 v[32:47], v[136:139], v[88:91], v[32:47]
    s_barrier
    ds_read_b128 v[96:99], v12 offset:0
    ds_read_b64_tr_b16 v[124:125], v21 offset:16384
    ds_read_b64_tr_b16 v[126:127], v21 offset:16640
    v_mfma_f32_32x32x16_bf16 v[48:63], v[140:143], v[88:91], v[48:63]
    ds_read_b64_tr_b16 v[128:129], v21 offset:20480
    ds_read_b64_tr_b16 v[130:131], v21 offset:20736
    ds_read_b64_tr_b16 v[132:133], v21 offset:24576
    v_mfma_f32_32x32x16_bf16 v[64:79], v[88:91], v[144:147], v[64:79]
    ds_read_b64_tr_b16 v[134:135], v21 offset:24832
    s_waitcnt lgkmcnt(7)
    v_mfma_f32_32x32x16_bf16 v[32:47], v[112:115], v[92:95], v[32:47]
    ds_read_b128 v[100:103], v13 offset:0
    ds_read_b64_tr_b16 v[136:137], v21 offset:17408
    ds_read_b64_tr_b16 v[138:139], v21 offset:17664
    v_mfma_f32_32x32x16_bf16 v[48:63], v[116:119], v[92:95], v[48:63]
    ds_read_b64_tr_b16 v[140:141], v21 offset:21504
    ds_read_b64_tr_b16 v[142:143], v21 offset:21760
    ds_read_b64_tr_b16 v[144:145], v21 offset:25600
    v_mfma_f32_32x32x16_bf16 v[64:79], v[92:95], v[120:123], v[64:79]
    ds_read_b64_tr_b16 v[146:147], v21 offset:25856
    s_waitcnt lgkmcnt(7)
    v_mfma_f32_32x32x16_bf16 v[32:47], v[124:127], v[96:99], v[32:47]
    ds_read_b128 v[104:107], v14 offset:0
    ds_read_b64_tr_b16 v[112:113], v21 offset:18432
    ds_read_b64_tr_b16 v[114:115], v21 offset:18688
    v_mfma_f32_32x32x16_bf16 v[48:63], v[128:131], v[96:99], v[48:63]
    ds_read_b64_tr_b16 v[116:117], v21 offset:22528
    ds_read_b64_tr_b16 v[118:119], v21 offset:22784
    ds_read_b64_tr_b16 v[120:121], v21 offset:26624
    v_mfma_f32_32x32x16_bf16 v[64:79], v[96:99], v[132:135], v[64:79]
    ds_read_b64_tr_b16 v[122:123], v21 offset:26880
    s_waitcnt lgkmcnt(7)
    v_mfma_f32_32x32x16_bf16 v[32:47], v[136:139], v[100:103], v[32:47]
    s_barrier
    ds_read_b128 v[108:111], v15 offset:0
    ds_read_b64_tr_b16 v[124:125], v21 offset:19456
    ds_read_b64_tr_b16 v[126:127], v21 offset:19712
    v_mfma_f32_32x32x16_bf16 v[48:63], v[140:143], v[100:103], v[48:63]
    ds_read_b64_tr_b16 v[128:129], v21 offset:23552
    ds_read_b64_tr_b16 v[130:131], v21 offset:23808
    ds_read_b64_tr_b16 v[132:133], v21 offset:27648
    v_mfma_f32_32x32x16_bf16 v[64:79], v[100:103], v[144:147], v[64:79]
    ds_read_b64_tr_b16 v[134:135], v21 offset:27904
    v_dot2c_f32_bf16 v24, s30, v92
    v_dot2c_f32_bf16 v26, v92, v92
    v_dot2c_f32_bf16 v25, s30, v93
    v_dot2c_f32_bf16 v27, v93, v93
    v_dot2c_f32_bf16 v24, s30, v94
    v_dot2c_f32_bf16 v26, v94, v94
    v_dot2c_f32_bf16 v25, s30, v95
    v_dot2c_f32_bf16 v27, v95, v95
    v_dot2c_f32_bf16 v24, s30, v96
    v_dot2c_f32_bf16 v26, v96, v96
    v_dot2c_f32_bf16 v25, s30, v97
    v_dot2c_f32_bf16 v27, v97, v97
    v_dot2c_f32_bf16 v24, s30, v98
    v_dot2c_f32_bf16 v26, v98, v98
    v_dot2c_f32_bf16 v25, s30, v99
    v_dot2c_f32_bf16 v27, v99, v99
    v_dot2c_f32_bf16 v24, s30, v100
    v_dot2c_f32_bf16 v26, v100, v100
    v_dot2c_f32_bf16 v25, s30, v101
    v_dot2c_f32_bf16 v27, v101, v101
    v_dot2c_f32_bf16 v24, s30, v102
    v_dot2c_f32_bf16 v26, v102, v102
    v_dot2c_f32_bf16 v25, s30, v103
    v_dot2c_f32_bf16 v27, v103, v103
    s_waitcnt lgkmcnt(0)
    v_dot2c_f32_bf16 v24, s30, v104
    v_dot2c_f32_bf16 v26, v104, v104
    v_dot2c_f32_bf16 v25, s30, v105
    v_dot2c_f32_bf16 v27, v105, v105
    v_dot2c_f32_bf16 v24, s30, v106
    v_dot2c_f32_bf16 v26, v106, v106
    v_dot2c_f32_bf16 v25, s30, v107
    v_dot2c_f32_bf16 v27, v107, v107
    v_dot2c_f32_bf16 v24, s30, v108
    v_dot2c_f32_bf16 v26, v108, v108
    v_dot2c_f32_bf16 v25, s30, v109
    v_dot2c_f32_bf16 v27, v109, v109
    v_dot2c_f32_bf16 v24, s30, v110
    v_dot2c_f32_bf16 v26, v110, v110
    v_dot2c_f32_bf16 v25, s30, v111
    v_dot2c_f32_bf16 v27, v111, v111
    v_mfma_f32_32x32x16_bf16 v[32:47], v[112:115], v[104:107], v[32:47]
    s_nop 1
    v_add_f32 v24, v24, v25
    v_add_f32 v26, v26, v27
    v_mov_b32 v25, v24
    v_mov_b32 v27, v26
    s_nop 0
    v_mfma_f32_32x32x16_bf16 v[48:63], v[116:119], v[104:107], v[48:63]
    v_permlane32_swap_b32 v24, v25
    v_permlane32_swap_b32 v26, v27
    v_add_f32 v24, v24, v25
    v_add_f32 v26, v26, v27
    v_mul_f32 v24, 0x3b000000, v24
    v_mul_f32 v26, 0x3b000000, v26
    v_mfma_f32_32x32x16_bf16 v[64:79], v[104:107], v[120:123], v[64:79]
    v_fma_f32 v26, -v24, v24, v26
    v_max_f32 v26, 0, v26
    v_add_f32 v26, 0x3727c5ac, v26
    v_rsq_f32 v26, v26
    v_mul_f32 v24, -0.5, v24
    ds_write_b32 v7, v26
    s_waitcnt lgkmcnt(0)
    v_mfma_f32_32x32x16_bf16 v[32:47], v[124:127], v[108:111], v[32:47]
    s_barrier
    ds_read_b64 v[152:153], v6 offset:0
    ds_read_b64 v[156:157], v6 offset:256
    ds_read_b64 v[160:161], v6 offset:512
    ds_read_b128 v[164:167], v1 offset:0
    ds_read_b128 v[168:171], v1 offset:32
    v_mfma_f32_32x32x16_bf16 v[48:63], v[128:131], v[108:111], v[48:63]
    ds_read_b128 v[172:175], v1 offset:64
    ds_read_b128 v[176:179], v1 offset:96
    v_cvt_pk_bf16_f32 v25, v24, v24
    v_lshlrev_b32 v25, 16, v25
    v_sub_f32 v27, v24, v25
    v_mfma_f32_32x32x16_bf16 v[64:79], v[108:111], v[132:135], v[64:79]
    v_cvt_pk_bf16_f32 v148, v25, v27
    v_mov_b32 v149, v148
    v_mul_f32 v28, 0x3eb8aa3b, v26
    v_mov_b32 v27, v26
    v_mov_b32 v29, v28
    s_waitcnt lgkmcnt(4)
    v_mfma_f32_32x32x16_bf16 v[48:63], v[156:159], v[148:151], v[48:63]
    v_mfma_f32_32x32x16_bf16 v[64:79], v[148:151], v[160:163], v[64:79]
    v_mfma_f32_32x32x16_bf16 v[32:47], v[152:155], v[148:151], v[32:47]
    s_waitcnt lgkmcnt(0)
    s_nop 8
    v_mul_f32 v48, v26, v48
    v_mul_f32 v49, v26, v49
    v_mul_f32 v50, v26, v50
    v_mul_f32 v51, v26, v51
    v_mul_f32 v52, v26, v52
    v_mul_f32 v53, v26, v53
    v_mul_f32 v54, v26, v54
    v_mul_f32 v55, v26, v55
    v_mul_f32 v56, v26, v56
    v_mul_f32 v57, v26, v57
    v_mul_f32 v58, v26, v58
    v_mul_f32 v59, v26, v59
    v_mul_f32 v60, v26, v60
    v_mul_f32 v61, v26, v61
    v_mul_f32 v62, v26, v62
    v_mul_f32 v63, v26, v63
    v_cvt_pk_bf16_f32 v120, v48, v49
    v_cvt_pk_bf16_f32 v121, v50, v51
    v_cvt_pk_bf16_f32 v122, v52, v53
    v_cvt_pk_bf16_f32 v123, v54, v55
    v_cvt_pk_bf16_f32 v124, v56, v57
    v_cvt_pk_bf16_f32 v125, v58, v59
    v_cvt_pk_bf16_f32 v126, v60, v61
    v_cvt_pk_bf16_f32 v127, v62, v63
    buffer_store_dwordx4 v[120:123], v2, s[16:19], s32 offen sc1
    buffer_store_dwordx4 v[124:127], v2, s[16:19], s33 offen sc1
    v_pk_mul_f32 v[64:65], v[164:165], v[64:65]
    v_pk_mul_f32 v[66:67], v[166:167], v[66:67]
    v_pk_mul_f32 v[68:69], v[168:169], v[68:69]
    v_pk_mul_f32 v[70:71], v[170:171], v[70:71]
    v_pk_mul_f32 v[72:73], v[172:173], v[72:73]
    v_pk_mul_f32 v[74:75], v[174:175], v[74:75]
    v_pk_mul_f32 v[76:77], v[176:177], v[76:77]
    v_pk_mul_f32 v[78:79], v[178:179], v[78:79]
    v_cvt_pk_bf16_f32 v128, v64, v65
    v_cvt_pk_bf16_f32 v129, v66, v67
    v_cvt_pk_bf16_f32 v130, v68, v69
    v_cvt_pk_bf16_f32 v131, v70, v71
    v_cvt_pk_bf16_f32 v132, v72, v73
    v_cvt_pk_bf16_f32 v133, v74, v75
    v_cvt_pk_bf16_f32 v134, v76, v77
    v_cvt_pk_bf16_f32 v135, v78, v79
    buffer_store_dwordx4 v[128:131], v3, s[16:19], s34 offen sc1
    buffer_store_dwordx4 v[132:135], v3, s[16:19], s34 offen offset:512 sc1
    v_pk_mul_f32 v[32:33], v[28:29], v[32:33]
    v_pk_mul_f32 v[34:35], v[28:29], v[34:35]
    v_pk_mul_f32 v[36:37], v[28:29], v[36:37]
    v_pk_mul_f32 v[38:39], v[28:29], v[38:39]
    v_pk_mul_f32 v[40:41], v[28:29], v[40:41]
    v_pk_mul_f32 v[42:43], v[28:29], v[42:43]
    v_pk_mul_f32 v[44:45], v[28:29], v[44:45]
    v_pk_mul_f32 v[46:47], v[28:29], v[46:47]
    v_cvt_pk_bf16_f32 v112, v32, v33
    v_cvt_pk_bf16_f32 v113, v34, v35
    v_cvt_pk_bf16_f32 v114, v36, v37
    v_cvt_pk_bf16_f32 v115, v38, v39
    v_cvt_pk_bf16_f32 v116, v40, v41
    v_cvt_pk_bf16_f32 v117, v42, v43
    v_cvt_pk_bf16_f32 v118, v44, v45
    v_cvt_pk_bf16_f32 v119, v46, v47
    buffer_store_dwordx4 v[112:115], v2, s[16:19], s29 offen sc1
    buffer_store_dwordx4 v[116:119], v2, s[16:19], s31 offen sc1
K1_JOIN:
    s_load_dwordx4 s[40:43], s[0:1], 32
    s_load_dwordx2 s[44:45], s[0:1], 16
    s_load_dwordx2 s[46:47], s[0:1], 0
    s_load_dwordx2 s[48:49], s[0:1], 48
    s_load_dwordx2 s[62:63], s[0:1], 56
    s_lshl_b32 s31, s24, 8
    s_lshl_b32 s30, s23, 2
    s_add_u32 s31, s31, s30
    s_add_u32 s31, s31, 11544576
    s_mov_b32 s22, s35
    s_and_b32 s23, s2, 7
    s_lshl_b32 s23, s23, 2
    s_bfe_u32 s29, s2, 0x20003
    s_add_u32 s23, s23, s29
    s_lshr_b32 s24, s2, 5
    s_lshl_b32 s25, s23, 16
    v_lshlrev_b32 v2, 4, v0
    s_lshl_b32 s26, s22, 10
    s_add_u32 s27, s25, s26
    s_lshl_b32 s28, s24, 13
    s_add_u32 s28, s28, s27
    s_add_u32 s27, s27, 2097152
    s_add_u32 s30, s27, 2097152
    s_mov_b32 s8, s58
    s_mov_b32 s9, s59
    s_mov_b32 s10, 0x10000000
    s_mov_b32 s11, 0x00020000
    v_mov_b32 v12, 0
    v_mov_b32 v13, 1
    s_waitcnt vmcnt(0) lgkmcnt(0)
    s_barrier
    s_cmp_eq_u32 s22, 7
    s_cbranch_scc0 K2_S1
    v_lshlrev_b32 v12, 14, v0
    s_mov_b64 exec, 1
    s_and_b32 s31, s31, 0xffffff80
    buffer_atomic_add v13, v12, s[8:11], s31 offen sc1
    s_mov_b64 exec, -1
K2_S1:
    s_and_b32 s36, s2, 3
    s_lshl_b32 s36, s36, 2
    s_bfe_u32 s29, s2, 0x20003
    s_add_u32 s36, s36, s29
    s_bfe_u32 s37, s2, 0x10002
    s_lshl_b32 s37, s37, 3
    s_add_u32 s37, s37, s24
    s_min_u32 s38, s22, 6
    s_mul_i32 s39, s37, 7
    s_add_u32 s39, s39, s38
    s_lshl_b32 s54, s39, 5
    s_mov_b32 s12, s40
    s_mov_b32 s13, s41
    s_mov_b32 s14, 0x1c0000
    s_mov_b32 s15, 0x00020000
    s_mov_b32 s16, s42
    s_mov_b32 s17, s43
    s_mov_b32 s18, 0x1c0000
    s_mov_b32 s19, 0x00020000
    s_lshl_b32 s55, s22, 12
    s_add_u32 s55, s55, 131072
    v_lshrrev_b32 v8, 1, v0
    v_mul_u32_u24 v8, 3584, v8
    v_and_b32 v1, 1, v0
    v_lshl_add_u32 v8, v1, 4, v8
    v_lshrrev_b32 v11, 5, v0
    v_bfe_u32 v1, v0, 2, 2
    v_lshl_add_u32 v10, v11, 2, v1
    v_lshlrev_b32 v9, 5, v10
    v_and_b32 v1, 3, v0
    v_lshl_add_u32 v9, v1, 3, v9
    v_bfe_u32 v1, v0, 4, 1
    v_lshl_add_u32 v9, v1, 10, v9
    v_add_u32 v9, s55, v9
    v_and_b32 v12, 15, v0
    v_lshl_add_u32 v12, v11, 4, v12
    v_lshlrev_b32 v12, 4, v12
    v_add_u32 v3, 65536, v12
    s_mov_b32 s34, 0x0000ffff
    s_mov_b32 s35, 0x0000ffff
    s_mov_b32 s50, 0x5d800000
    v_and_b32 v1, 27, v0
    v_cmp_eq_u32 vcc, 16, v1
    v_mov_b32 v1, 0x3f803f80
    s_nop 0
    v_cndmask_b32 v100, 0, v1, vcc
    v_mov_b32 v101, v100
    v_mov_b32 v102, v100
    v_mov_b32 v103, v100
    v_mov_b32 v104, v100
    v_mov_b32 v105, v100
    v_mov_b32 v106, v100
    v_mov_b32 v107, v100
    v_mov_b32 v108, v100
    v_mov_b32 v109, v100
    v_mov_b32 v110, v100
    v_mov_b32 v111, v100
    v_mov_b32 v112, v100
    v_mov_b32 v113, v100
    v_mov_b32 v114, v100
    v_mov_b32 v115, v100
    v_mov_b32 v116, v100
    v_mov_b32 v117, v100
    v_mov_b32 v118, v100
    v_mov_b32 v119, v100
    v_mov_b32 v120, v100
    v_mov_b32 v121, v100
    v_mov_b32 v122, v100
    v_mov_b32 v123, v100
    v_mov_b32 v64, 0
    v_mov_b32 v65, 0
    v_mov_b32 v66, 0
    v_mov_b32 v67, 0
    v_mov_b32 v68, 0
    v_mov_b32 v69, 0
    v_mov_b32 v70, 0
    v_mov_b32 v71, 0
    v_mov_b32 v72, 0
    v_mov_b32 v73, 0
    v_mov_b32 v74, 0
    v_mov_b32 v75, 0
    v_mov_b32 v76, 0
    v_mov_b32 v77, 0
    v_mov_b32 v78, 0
    v_mov_b32 v79, 0
    v_mov_b32 v56, 0
    v_mov_b32 v57, 0
    v_mov_b32 v58, 0
    v_mov_b32 v59, 0
    v_mov_b32 v60, 0
    v_mov_b32 v61, 0
    v_mov_b32 v62, 0
    v_mov_b32 v63, 0
    v_and_b32 v1, 0x33, v0
    v_bfe_u32 v14, v0, 2, 1
    v_lshl_add_u32 v1, v14, 3, v1
    v_bfe_u32 v14, v0, 3, 1
    v_lshl_add_u32 v1, v14, 2, v1
    v_lshlrev_b32 v126, 4, v1
    v_mov_b32 v127, 0xdddddddd
    s_cmp_eq_u32 s22, 7
    s_cbranch_scc0 K2_B1
    s_lshr_b32 s29, s23, 1
    s_lshl_b32 s29, s29, 8
    s_add_u32 s29, s29, 11544576
    s_lshr_b32 s33, s2, 5
    s_and_b32 s33, s33, 0
    s_lshl_b32 s33, s33, 14
    v_mov_b32 v1, s33
    s_mov_b32 s33, 0
    s_mov_b64 exec, 1
K2_P1:
    v_mov_b32 v15, 0
    buffer_atomic_add v15, v1, s[8:11], s29 offen sc0 sc1
    s_add_u32 s33, s33, 1
    s_waitcnt vmcnt(0)
    v_cmp_eq_u32 vcc, 16, v15
    s_nop 0
    s_cbranch_vccnz K2_P1_X
    s_cmp_lt_u32 s33, 0x40000
    s_cbranch_scc1 K2_P1
K2_P1_X:
    s_mov_b64 exec, -1
K2_B1:
    s_mov_b32 m0, s26
    s_barrier
    buffer_load_dwordx4 v2, s[8:11], s27 offen sc1 lds
    buffer_load_dwordx4 v[4:7], v2, s[8:11], s28 offen sc1
    s_add_u32 m0, s26, 65536
    s_nop 0
    buffer_load_dwordx4 v2, s[8:11], s30 offen sc1 lds
    s_add_u32 m0, s26, 8192
    s_add_u32 s29, s27, 8192
    buffer_load_dwordx4 v2, s[8:11], s29 offen sc1 lds
    s_add_u32 m0, s26, 73728
    s_add_u32 s29, s27, 2105344
    buffer_load_dwordx4 v2, s[8:11], s29 offen sc1 lds
    v_add_u32 v1, s26, v2
    s_waitcnt vmcnt(3)
    ds_read_b128 v[88:91], v1
    s_waitcnt lgkmcnt(0)
    v_mfma_f32_32x32x16_bf16 v[32:47], v[88:91], v[4:7], 0
    s_waitcnt vmcnt(2)
    s_barrier
    ds_read_b128 v[88:91], v126 offset:0
    ds_read_b128 v[92:95], v126 offset:1024
    s_mov_b64 exec, s[34:35]
    ds_read_b128 v[100:103], v3 offset:0
    ds_read_b128 v[104:107], v3 offset:512
    s_mov_b64 exec, -1
    ds_read_b128 v[96:99], v126 offset:2048
    s_mov_b64 exec, s[34:35]
    ds_read_b128 v[108:111], v3 offset:1024
    ds_read_b128 v[112:115], v3 offset:1536
    s_mov_b64 exec, -1
    v_max3_f32 v16, v32, v33, v34
    v_max3_f32 v17, v35, v36, v37
    v_max3_f32 v18, v38, v39, v40
    v_max3_f32 v19, v41, v42, v43
    v_max3_f32 v20, v44, v45, v46
    v_max3_f32 v14, v16, v17, v47
    v_max3_f32 v15, v18, v19, v20
    v_max_f32 v14, v14, v15
    v_mov_b32 v15, v14
    s_nop 1
    v_permlane32_swap_b32 v14, v15
    v_max_f32 v14, v14, v15
    v_sub_f32 v16, 0, v14
    v_sub_f32 v17, 0, v14
    v_sub_f32 v18, 0, v14
    v_sub_f32 v19, 0, v14
    v_sub_f32 v20, 0, v14
    v_sub_f32 v21, 0, v14
    v_sub_f32 v22, 0, v14
    v_sub_f32 v23, 0, v14
    v_sub_f32 v24, 0, v14
    v_sub_f32 v25, 0, v14
    v_sub_f32 v26, 0, v14
    v_sub_f32 v27, 0, v14
    v_sub_f32 v28, 0, v14
    v_sub_f32 v29, 0, v14
    v_sub_f32 v30, 0, v14
    v_sub_f32 v31, 0, v14
    s_nop 1
    s_waitcnt lgkmcnt(6)
    v_mfma_f32_32x32x16_bf16 v[32:47], v[88:91], v[4:7], v[16:31]
    s_nop 9
    s_cmp_eq_u32 s22, 7
    s_cselect_b32 s14, 0, s14
    s_cselect_b32 s18, 0, s18
    s_setprio 0
    s_waitcnt lgkmcnt(3)
    v_exp_f32 v32, v32
    v_exp_f32 v33, v33
    v_smfmac_f32_32x32x32_bf16 v[64:79], v[120:123], v[56:63], v127
    v_exp_f32 v34, v34
    v_exp_f32 v35, v35
    s_setprio 1
    v_exp_f32 v36, v36
    v_exp_f32 v37, v37
    v_exp_f32 v38, v38
    v_mfma_f32_32x32x16_bf16 v[48:63], v[92:95], v[4:7], v[16:31]
    ds_read_b128 v[88:91], v126 offset:3072
    s_mov_b64 exec, s[34:35]
    ds_read_b128 v[116:119], v3 offset:2048
    ds_read_b128 v[120:123], v3 offset:2560
    s_mov_b64 exec, -1
    v_exp_f32 v39, v39
    v_exp_f32 v40, v40
    v_exp_f32 v41, v41
    v_exp_f32 v42, v42
    v_exp_f32 v43, v43
    v_smfmac_f32_32x32x32_bf16 v[64:79], v[100:103], v[32:39], v127
    s_add_u32 m0, s26, 16384
    s_add_u32 s29, s27, 16384
    buffer_load_dwordx4 v2, s[8:11], s29 offen sc1 lds
    v_exp_f32 v44, v44
    v_exp_f32 v45, v45
    v_exp_f32 v46, v46
    v_exp_f32 v47, v47
    s_waitcnt lgkmcnt(3)
    v_exp_f32 v48, v48
    v_exp_f32 v49, v49
    v_smfmac_f32_32x32x32_bf16 v[64:79], v[104:107], v[40:47], v127
    v_exp_f32 v50, v50
    s_setprio 2
    v_exp_f32 v51, v51
    v_exp_f32 v52, v52
    v_exp_f32 v53, v53
    v_exp_f32 v54, v54
    v_mfma_f32_32x32x16_bf16 v[32:47], v[96:99], v[4:7], v[16:31]
    ds_read_b128 v[92:95], v126 offset:4096
    s_mov_b64 exec, s[34:35]
    ds_read_b128 v[100:103], v3 offset:3072
    ds_read_b128 v[104:107], v3 offset:3584
    s_mov_b64 exec, -1
    v_exp_f32 v55, v55
    v_exp_f32 v56, v56
    v_exp_f32 v57, v57
    v_exp_f32 v58, v58
    v_exp_f32 v59, v59
    v_smfmac_f32_32x32x32_bf16 v[64:79], v[108:111], v[48:55], v127
    s_add_u32 m0, s26, 81920
    s_add_u32 s29, s27, 2113536
    buffer_load_dwordx4 v2, s[8:11], s29 offen sc1 lds
    v_exp_f32 v60, v60
    v_exp_f32 v61, v61
    v_exp_f32 v62, v62
    v_exp_f32 v63, v63
    s_waitcnt lgkmcnt(3)
    v_exp_f32 v32, v32
    v_exp_f32 v33, v33
    v_smfmac_f32_32x32x32_bf16 v[64:79], v[112:115], v[56:63], v127
    v_exp_f32 v34, v34
    v_exp_f32 v35, v35
    v_exp_f32 v36, v36
    v_exp_f32 v37, v37
    v_exp_f32 v38, v38
    v_mfma_f32_32x32x16_bf16 v[48:63], v[88:91], v[4:7], v[16:31]
    ds_read_b128 v[96:99], v126 offset:5120
    s_mov_b64 exec, s[34:35]
    ds_read_b128 v[108:111], v3 offset:4096
    ds_read_b128 v[112:115], v3 offset:4608
    s_mov_b64 exec, -1
    v_exp_f32 v39, v39
    v_exp_f32 v40, v40
    v_exp_f32 v41, v41
    v_exp_f32 v42, v42
    v_exp_f32 v43, v43
    v_smfmac_f32_32x32x32_bf16 v[64:79], v[116:119], v[32:39], v127
    s_add_u32 m0, s26, 24576
    s_add_u32 s29, s27, 24576
    buffer_load_dwordx4 v2, s[8:11], s29 offen sc1 lds
    v_exp_f32 v44, v44
    v_exp_f32 v45, v45
    v_exp_f32 v46, v46
    v_exp_f32 v47, v47
    s_waitcnt lgkmcnt(3)
    v_exp_f32 v48, v48
    v_exp_f32 v49, v49
    v_smfmac_f32_32x32x32_bf16 v[64:79], v[120:123], v[40:47], v127
    v_exp_f32 v50, v50
    v_exp_f32 v51, v51
    v_exp_f32 v52, v52
    v_exp_f32 v53, v53
    v_exp_f32 v54, v54
    v_mfma_f32_32x32x16_bf16 v[32:47], v[92:95], v[4:7], v[16:31]
    ds_read_b128 v[88:91], v126 offset:6144
    s_mov_b64 exec, s[34:35]
    ds_read_b128 v[116:119], v3 offset:5120
    ds_read_b128 v[120:123], v3 offset:5632
    s_mov_b64 exec, -1
    v_exp_f32 v55, v55
    v_exp_f32 v56, v56
    v_exp_f32 v57, v57
    v_exp_f32 v58, v58
    v_exp_f32 v59, v59
    v_smfmac_f32_32x32x32_bf16 v[64:79], v[100:103], v[48:55], v127
    s_add_u32 m0, s26, 90112
    s_add_u32 s29, s27, 2121728
    buffer_load_dwordx4 v2, s[8:11], s29 offen sc1 lds
    v_exp_f32 v60, v60
    v_exp_f32 v61, v61
    v_exp_f32 v62, v62
    v_exp_f32 v63, v63
    s_setprio 0
    s_waitcnt lgkmcnt(3)
    v_exp_f32 v32, v32
    v_exp_f32 v33, v33
    v_smfmac_f32_32x32x32_bf16 v[64:79], v[104:107], v[56:63], v127
    v_exp_f32 v34, v34
    v_exp_f32 v35, v35
    s_setprio 1
    v_exp_f32 v36, v36
    v_exp_f32 v37, v37
    v_exp_f32 v38, v38
    v_mfma_f32_32x32x16_bf16 v[48:63], v[96:99], v[4:7], v[16:31]
    ds_read_b128 v[92:95], v126 offset:7168
    s_mov_b64 exec, s[34:35]
    ds_read_b128 v[100:103], v3 offset:6144
    ds_read_b128 v[104:107], v3 offset:6656
    s_mov_b64 exec, -1
    v_exp_f32 v39, v39
    v_exp_f32 v40, v40
    v_exp_f32 v41, v41
    v_exp_f32 v42, v42
    v_exp_f32 v43, v43
    v_smfmac_f32_32x32x32_bf16 v[64:79], v[108:111], v[32:39], v127
    s_add_u32 m0, s26, 32768
    s_add_u32 s29, s27, 32768
    buffer_load_dwordx4 v2, s[8:11], s29 offen sc1 lds
    v_exp_f32 v44, v44
    v_exp_f32 v45, v45
    v_exp_f32 v46, v46
    v_exp_f32 v47, v47
    s_waitcnt vmcnt(5)
    s_barrier
    s_waitcnt lgkmcnt(3)
    v_exp_f32 v48, v48
    v_exp_f32 v49, v49
    v_smfmac_f32_32x32x32_bf16 v[64:79], v[112:115], v[40:47], v127
    v_exp_f32 v50, v50
    s_setprio 2
    v_exp_f32 v51, v51
    v_exp_f32 v52, v52
    v_exp_f32 v53, v53
    v_exp_f32 v54, v54
    v_mfma_f32_32x32x16_bf16 v[32:47], v[88:91], v[4:7], v[16:31]
    ds_read_b128 v[96:99], v126 offset:8192
    s_mov_b64 exec, s[34:35]
    ds_read_b128 v[108:111], v3 offset:7168
    ds_read_b128 v[112:115], v3 offset:7680
    s_mov_b64 exec, -1
    v_exp_f32 v55, v55
    v_exp_f32 v56, v56
    v_exp_f32 v57, v57
    v_exp_f32 v58, v58
    v_exp_f32 v59, v59
    v_smfmac_f32_32x32x32_bf16 v[64:79], v[116:119], v[48:55], v127
    s_add_u32 m0, s26, 98304
    s_add_u32 s29, s27, 2129920
    buffer_load_dwordx4 v2, s[8:11], s29 offen sc1 lds
    v_exp_f32 v60, v60
    v_exp_f32 v61, v61
    v_exp_f32 v62, v62
    v_exp_f32 v63, v63
    s_waitcnt lgkmcnt(3)
    v_exp_f32 v32, v32
    v_exp_f32 v33, v33
    v_smfmac_f32_32x32x32_bf16 v[64:79], v[120:123], v[56:63], v127
    v_exp_f32 v34, v34
    v_exp_f32 v35, v35
    v_exp_f32 v36, v36
    v_exp_f32 v37, v37
    v_exp_f32 v38, v38
    v_mfma_f32_32x32x16_bf16 v[48:63], v[92:95], v[4:7], v[16:31]
    ds_read_b128 v[88:91], v126 offset:9216
    s_mov_b64 exec, s[34:35]
    ds_read_b128 v[116:119], v3 offset:8192
    ds_read_b128 v[120:123], v3 offset:8704
    s_mov_b64 exec, -1
    v_exp_f32 v39, v39
    v_exp_f32 v40, v40
    v_exp_f32 v41, v41
    v_exp_f32 v42, v42
    v_exp_f32 v43, v43
    v_smfmac_f32_32x32x32_bf16 v[64:79], v[100:103], v[32:39], v127
    s_add_u32 m0, s26, 40960
    s_add_u32 s29, s27, 40960
    buffer_load_dwordx4 v2, s[8:11], s29 offen sc1 lds
    v_exp_f32 v44, v44
    v_exp_f32 v45, v45
    v_exp_f32 v46, v46
    v_exp_f32 v47, v47
    s_waitcnt lgkmcnt(3)
    v_exp_f32 v48, v48
    v_exp_f32 v49, v49
    v_smfmac_f32_32x32x32_bf16 v[64:79], v[104:107], v[40:47], v127
    v_exp_f32 v50, v50
    v_exp_f32 v51, v51
    v_exp_f32 v52, v52
    v_exp_f32 v53, v53
    v_exp_f32 v54, v54
    v_mfma_f32_32x32x16_bf16 v[32:47], v[96:99], v[4:7], v[16:31]
    ds_read_b128 v[92:95], v126 offset:10240
    s_mov_b64 exec, s[34:35]
    ds_read_b128 v[100:103], v3 offset:9216
    ds_read_b128 v[104:107], v3 offset:9728
    s_mov_b64 exec, -1
    v_exp_f32 v55, v55
    v_exp_f32 v56, v56
    v_exp_f32 v57, v57
    v_exp_f32 v58, v58
    v_exp_f32 v59, v59
    v_smfmac_f32_32x32x32_bf16 v[64:79], v[108:111], v[48:55], v127
    s_add_u32 m0, s26, 106496
    s_add_u32 s29, s27, 2138112
    buffer_load_dwordx4 v2, s[8:11], s29 offen sc1 lds
    v_exp_f32 v60, v60
    v_exp_f32 v61, v61
    v_exp_f32 v62, v62
    v_exp_f32 v63, v63
    s_setprio 0
    s_waitcnt lgkmcnt(3)
    v_exp_f32 v32, v32
    v_exp_f32 v33, v33
    v_smfmac_f32_32x32x32_bf16 v[64:79], v[112:115], v[56:63], v127
    v_exp_f32 v34, v34
    v_exp_f32 v35, v35
    s_setprio 1
    v_exp_f32 v36, v36
    v_exp_f32 v37, v37
    v_exp_f32 v38, v38
    v_mfma_f32_32x32x16_bf16 v[48:63], v[88:91], v[4:7], v[16:31]
    ds_read_b128 v[96:99], v126 offset:11264
    s_mov_b64 exec, s[34:35]
    ds_read_b128 v[108:111], v3 offset:10240
    ds_read_b128 v[112:115], v3 offset:10752
    s_mov_b64 exec, -1
    v_exp_f32 v39, v39
    v_exp_f32 v40, v40
    v_exp_f32 v41, v41
    v_exp_f32 v42, v42
    v_exp_f32 v43, v43
    v_smfmac_f32_32x32x32_bf16 v[64:79], v[116:119], v[32:39], v127
    s_add_u32 m0, s26, 49152
    s_add_u32 s29, s27, 49152
    buffer_load_dwordx4 v2, s[8:11], s29 offen sc1 lds
    v_exp_f32 v44, v44
    v_exp_f32 v45, v45
    v_exp_f32 v46, v46
    v_exp_f32 v47, v47
    s_waitcnt lgkmcnt(3)
    v_exp_f32 v48, v48
    v_exp_f32 v49, v49
    v_smfmac_f32_32x32x32_bf16 v[64:79], v[120:123], v[40:47], v127
    v_exp_f32 v50, v50
    s_setprio 2
    v_exp_f32 v51, v51
    v_exp_f32 v52, v52
    v_exp_f32 v53, v53
    v_exp_f32 v54, v54
    v_mfma_f32_32x32x16_bf16 v[32:47], v[92:95], v[4:7], v[16:31]
    ds_read_b128 v[88:91], v126 offset:12288
    s_mov_b64 exec, s[34:35]
    ds_read_b128 v[116:119], v3 offset:11264
    ds_read_b128 v[120:123], v3 offset:11776
    s_mov_b64 exec, -1
    v_exp_f32 v55, v55
    v_exp_f32 v56, v56
    v_exp_f32 v57, v57
    v_exp_f32 v58, v58
    v_exp_f32 v59, v59
    v_smfmac_f32_32x32x32_bf16 v[64:79], v[100:103], v[48:55], v127
    s_add_u32 m0, s26, 114688
    s_add_u32 s29, s27, 2146304
    buffer_load_dwordx4 v2, s[8:11], s29 offen sc1 lds
    v_exp_f32 v60, v60
    v_exp_f32 v61, v61
    v_exp_f32 v62, v62
    v_exp_f32 v63, v63
    s_waitcnt lgkmcnt(3)
    v_exp_f32 v32, v32
    v_exp_f32 v33, v33
    v_smfmac_f32_32x32x32_bf16 v[64:79], v[104:107], v[56:63], v127
    v_exp_f32 v34, v34
    v_exp_f32 v35, v35
    v_exp_f32 v36, v36
    v_exp_f32 v37, v37
    v_exp_f32 v38, v38
    v_mfma_f32_32x32x16_bf16 v[48:63], v[96:99], v[4:7], v[16:31]
    ds_read_b128 v[92:95], v126 offset:13312
    s_mov_b64 exec, s[34:35]
    ds_read_b128 v[100:103], v3 offset:12288
    ds_read_b128 v[104:107], v3 offset:12800
    s_mov_b64 exec, -1
    v_exp_f32 v39, v39
    v_exp_f32 v40, v40
    v_exp_f32 v41, v41
    v_exp_f32 v42, v42
    v_exp_f32 v43, v43
    v_smfmac_f32_32x32x32_bf16 v[64:79], v[108:111], v[32:39], v127
    s_add_u32 m0, s26, 57344
    s_add_u32 s29, s27, 57344
    buffer_load_dwordx4 v2, s[8:11], s29 offen sc1 lds
    v_exp_f32 v44, v44
    v_exp_f32 v45, v45
    v_exp_f32 v46, v46
    v_exp_f32 v47, v47
    s_waitcnt lgkmcnt(3)
    v_exp_f32 v48, v48
    v_exp_f32 v49, v49
    v_smfmac_f32_32x32x32_bf16 v[64:79], v[112:115], v[40:47], v127
    v_exp_f32 v50, v50
    v_exp_f32 v51, v51
    v_exp_f32 v52, v52
    v_exp_f32 v53, v53
    v_exp_f32 v54, v54
    v_mfma_f32_32x32x16_bf16 v[32:47], v[88:91], v[4:7], v[16:31]
    ds_read_b128 v[96:99], v126 offset:14336
    s_mov_b64 exec, s[34:35]
    ds_read_b128 v[108:111], v3 offset:13312
    ds_read_b128 v[112:115], v3 offset:13824
    s_mov_b64 exec, -1
    v_exp_f32 v55, v55
    v_exp_f32 v56, v56
    v_exp_f32 v57, v57
    v_exp_f32 v58, v58
    v_exp_f32 v59, v59
    v_smfmac_f32_32x32x32_bf16 v[64:79], v[116:119], v[48:55], v127
    s_add_u32 m0, s26, 122880
    s_add_u32 s29, s27, 2154496
    buffer_load_dwordx4 v2, s[8:11], s29 offen sc1 lds
    v_exp_f32 v60, v60
    v_exp_f32 v61, v61
    v_exp_f32 v62, v62
    v_exp_f32 v63, v63
    s_setprio 0
    s_waitcnt lgkmcnt(3)
    v_exp_f32 v32, v32
    v_exp_f32 v33, v33
    v_smfmac_f32_32x32x32_bf16 v[64:79], v[120:123], v[56:63], v127
    v_exp_f32 v34, v34
    v_exp_f32 v35, v35
    s_setprio 1
    v_exp_f32 v36, v36
    v_exp_f32 v37, v37
    v_exp_f32 v38, v38
    v_mfma_f32_32x32x16_bf16 v[48:63], v[92:95], v[4:7], v[16:31]
    ds_read_b128 v[88:91], v126 offset:15360
    s_mov_b64 exec, s[34:35]
    ds_read_b128 v[116:119], v3 offset:14336
    ds_read_b128 v[120:123], v3 offset:14848
    s_mov_b64 exec, -1
    v_exp_f32 v39, v39
    v_exp_f32 v40, v40
    v_exp_f32 v41, v41
    v_exp_f32 v42, v42
    v_exp_f32 v43, v43
    v_smfmac_f32_32x32x32_bf16 v[64:79], v[100:103], v[32:39], v127
    s_add_u32 m0, s55, 0
    s_add_u32 s29, s54, 0
    buffer_load_dwordx4 v8, s[12:15], s29 offen  lds
    s_add_u32 m0, s55, 1024
    s_nop 0
    buffer_load_dwordx4 v8, s[16:19], s29 offen  lds
    v_exp_f32 v44, v44
    v_exp_f32 v45, v45
    v_exp_f32 v46, v46
    v_exp_f32 v47, v47
    s_waitcnt vmcnt(6)
    s_barrier
    s_waitcnt lgkmcnt(3)
    v_exp_f32 v48, v48
    v_exp_f32 v49, v49
    v_smfmac_f32_32x32x32_bf16 v[64:79], v[104:107], v[40:47], v127
    v_exp_f32 v50, v50
    s_setprio 2
    v_exp_f32 v51, v51
    v_exp_f32 v52, v52
    v_exp_f32 v53, v53
    v_exp_f32 v54, v54
    v_mfma_f32_32x32x16_bf16 v[32:47], v[96:99], v[4:7], v[16:31]
    ds_read_b128 v[92:95], v126 offset:16384
    s_mov_b64 exec, s[34:35]
    ds_read_b128 v[100:103], v3 offset:15360
    ds_read_b128 v[104:107], v3 offset:15872
    s_mov_b64 exec, -1
    v_exp_f32 v55, v55
    v_exp_f32 v56, v56
    v_exp_f32 v57, v57
    v_exp_f32 v58, v58
    v_exp_f32 v59, v59
    v_smfmac_f32_32x32x32_bf16 v[64:79], v[108:111], v[48:55], v127
    v_exp_f32 v60, v60
    v_exp_f32 v61, v61
    v_exp_f32 v62, v62
    v_exp_f32 v63, v63
    s_waitcnt lgkmcnt(3)
    v_exp_f32 v32, v32
    v_exp_f32 v33, v33
    v_smfmac_f32_32x32x32_bf16 v[64:79], v[112:115], v[56:63], v127
    v_exp_f32 v34, v34
    v_exp_f32 v35, v35
    v_exp_f32 v36, v36
    v_exp_f32 v37, v37
    v_exp_f32 v38, v38
    v_mfma_f32_32x32x16_bf16 v[48:63], v[88:91], v[4:7], v[16:31]
    ds_read_b128 v[96:99], v126 offset:17408
    s_mov_b64 exec, s[34:35]
    ds_read_b128 v[108:111], v3 offset:16384
    ds_read_b128 v[112:115], v3 offset:16896
    s_mov_b64 exec, -1
    v_exp_f32 v39, v39
    v_exp_f32 v40, v40
    v_exp_f32 v41, v41
    v_exp_f32 v42, v42
    v_exp_f32 v43, v43
    v_smfmac_f32_32x32x32_bf16 v[64:79], v[116:119], v[32:39], v127
    v_exp_f32 v44, v44
    v_exp_f32 v45, v45
    v_exp_f32 v46, v46
    v_exp_f32 v47, v47
    s_waitcnt lgkmcnt(3)
    v_exp_f32 v48, v48
    v_exp_f32 v49, v49
    v_smfmac_f32_32x32x32_bf16 v[64:79], v[120:123], v[40:47], v127
    v_exp_f32 v50, v50
    v_exp_f32 v51, v51
    v_exp_f32 v52, v52
    v_exp_f32 v53, v53
    v_exp_f32 v54, v54
    v_mfma_f32_32x32x16_bf16 v[32:47], v[92:95], v[4:7], v[16:31]
    ds_read_b128 v[88:91], v126 offset:18432
    s_mov_b64 exec, s[34:35]
    ds_read_b128 v[116:119], v3 offset:17408
    ds_read_b128 v[120:123], v3 offset:17920
    s_mov_b64 exec, -1
    v_exp_f32 v55, v55
    v_exp_f32 v56, v56
    v_exp_f32 v57, v57
    v_exp_f32 v58, v58
    v_exp_f32 v59, v59
    v_smfmac_f32_32x32x32_bf16 v[64:79], v[100:103], v[48:55], v127
    s_add_u32 m0, s55, 2048
    s_add_u32 s29, s54, 114688
    buffer_load_dwordx4 v8, s[12:15], s29 offen  lds
    s_add_u32 m0, s55, 3072
    s_nop 0
    buffer_load_dwordx4 v8, s[16:19], s29 offen  lds
    v_exp_f32 v60, v60
    v_exp_f32 v61, v61
    v_exp_f32 v62, v62
    v_exp_f32 v63, v63
    s_setprio 0
    s_waitcnt lgkmcnt(3)
    v_exp_f32 v32, v32
    v_exp_f32 v33, v33
    v_smfmac_f32_32x32x32_bf16 v[64:79], v[104:107], v[56:63], v127
    v_exp_f32 v34, v34
    v_exp_f32 v35, v35
    s_setprio 1
    v_exp_f32 v36, v36
    v_exp_f32 v37, v37
    v_exp_f32 v38, v38
    v_mfma_f32_32x32x16_bf16 v[48:63], v[96:99], v[4:7], v[16:31]
    ds_read_b128 v[92:95], v126 offset:19456
    s_mov_b64 exec, s[34:35]
    ds_read_b128 v[100:103], v3 offset:18432
    ds_read_b128 v[104:107], v3 offset:18944
    s_mov_b64 exec, -1
    v_exp_f32 v39, v39
    v_exp_f32 v40, v40
    v_exp_f32 v41, v41
    v_exp_f32 v42, v42
    v_exp_f32 v43, v43
    v_smfmac_f32_32x32x32_bf16 v[64:79], v[108:111], v[32:39], v127
    v_exp_f32 v44, v44
    v_exp_f32 v45, v45
    v_exp_f32 v46, v46
    v_exp_f32 v47, v47
    s_waitcnt lgkmcnt(3)
    v_exp_f32 v48, v48
    v_exp_f32 v49, v49
    v_smfmac_f32_32x32x32_bf16 v[64:79], v[112:115], v[40:47], v127
    v_exp_f32 v50, v50
    s_setprio 2
    v_exp_f32 v51, v51
    v_exp_f32 v52, v52
    v_exp_f32 v53, v53
    v_exp_f32 v54, v54
    v_mfma_f32_32x32x16_bf16 v[32:47], v[88:91], v[4:7], v[16:31]
    s_waitcnt vmcnt(2)
    ds_read_b64_tr_b16 v[128:129], v9 offset:0
    ds_read_b64_tr_b16 v[130:131], v9 offset:256
    ds_read_b64_tr_b16 v[132:133], v9 offset:512
    ds_read_b64_tr_b16 v[134:135], v9 offset:768
    ds_read_b128 v[96:99], v126 offset:20480
    s_mov_b64 exec, s[34:35]
    ds_read_b128 v[108:111], v3 offset:19456
    ds_read_b128 v[112:115], v3 offset:19968
    s_mov_b64 exec, -1
    v_exp_f32 v55, v55
    v_exp_f32 v56, v56
    v_exp_f32 v57, v57
    v_exp_f32 v58, v58
    v_exp_f32 v59, v59
    v_smfmac_f32_32x32x32_bf16 v[64:79], v[116:119], v[48:55], v127
    v_exp_f32 v60, v60
    v_exp_f32 v61, v61
    v_exp_f32 v62, v62
    v_exp_f32 v63, v63
    s_waitcnt lgkmcnt(3)
    v_exp_f32 v32, v32
    v_exp_f32 v33, v33
    v_smfmac_f32_32x32x32_bf16 v[64:79], v[120:123], v[56:63], v127
    v_exp_f32 v34, v34
    v_exp_f32 v35, v35
    v_exp_f32 v36, v36
    v_exp_f32 v37, v37
    v_exp_f32 v38, v38
    v_mfma_f32_32x32x16_bf16 v[48:63], v[92:95], v[4:7], v[16:31]
    ds_read_b128 v[88:91], v126 offset:21504
    s_mov_b64 exec, s[34:35]
    ds_read_b128 v[116:119], v3 offset:20480
    ds_read_b128 v[120:123], v3 offset:20992
    s_mov_b64 exec, -1
    v_exp_f32 v39, v39
    v_exp_f32 v40, v40
    v_exp_f32 v41, v41
    v_exp_f32 v42, v42
    v_exp_f32 v43, v43
    v_smfmac_f32_32x32x32_bf16 v[64:79], v[100:103], v[32:39], v127
    s_add_u32 m0, s55, 0
    s_add_u32 s29, s54, 229376
    buffer_load_dwordx4 v8, s[12:15], s29 offen  lds
    s_add_u32 m0, s55, 1024
    s_nop 0
    buffer_load_dwordx4 v8, s[16:19], s29 offen  lds
    v_exp_f32 v44, v44
    v_exp_f32 v45, v45
    v_exp_f32 v46, v46
    v_exp_f32 v47, v47
    s_waitcnt lgkmcnt(3)
    v_exp_f32 v48, v48
    v_exp_f32 v49, v49
    v_smfmac_f32_32x32x32_bf16 v[64:79], v[104:107], v[40:47], v127
    v_exp_f32 v50, v50
    v_exp_f32 v51, v51
    v_exp_f32 v52, v52
    v_exp_f32 v53, v53
    v_exp_f32 v54, v54
    v_mfma_f32_32x32x16_bf16 v[32:47], v[96:99], v[4:7], v[16:31]
    ds_read_b128 v[92:95], v126 offset:22528
    s_mov_b64 exec, s[34:35]
    ds_read_b128 v[100:103], v3 offset:21504
    ds_read_b128 v[104:107], v3 offset:22016
    s_mov_b64 exec, -1
    v_exp_f32 v55, v55
    v_exp_f32 v56, v56
    v_exp_f32 v57, v57
    v_exp_f32 v58, v58
    v_exp_f32 v59, v59
    v_smfmac_f32_32x32x32_bf16 v[64:79], v[108:111], v[48:55], v127
    v_exp_f32 v60, v60
    v_exp_f32 v61, v61
    v_exp_f32 v62, v62
    v_exp_f32 v63, v63
    s_setprio 0
    s_waitcnt lgkmcnt(3)
    v_exp_f32 v32, v32
    v_exp_f32 v33, v33
    v_smfmac_f32_32x32x32_bf16 v[64:79], v[112:115], v[56:63], v127
    v_exp_f32 v34, v34
    v_exp_f32 v35, v35
    s_setprio 1
    v_exp_f32 v36, v36
    v_exp_f32 v37, v37
    v_exp_f32 v38, v38
    v_mfma_f32_32x32x16_bf16 v[48:63], v[88:91], v[4:7], v[16:31]
    s_waitcnt vmcnt(2)
    ds_read_b64_tr_b16 v[136:137], v9 offset:2048
    ds_read_b64_tr_b16 v[138:139], v9 offset:2304
    ds_read_b64_tr_b16 v[140:141], v9 offset:2560
    ds_read_b64_tr_b16 v[142:143], v9 offset:2816
    ds_read_b128 v[96:99], v126 offset:23552
    s_mov_b64 exec, s[34:35]
    ds_read_b128 v[108:111], v3 offset:22528
    ds_read_b128 v[112:115], v3 offset:23040
    s_mov_b64 exec, -1
    v_exp_f32 v39, v39
    v_exp_f32 v40, v40
    v_exp_f32 v41, v41
    v_exp_f32 v42, v42
    v_exp_f32 v43, v43
    v_smfmac_f32_32x32x32_bf16 v[64:79], v[116:119], v[32:39], v127
    v_exp_f32 v44, v44
    v_exp_f32 v45, v45
    v_exp_f32 v46, v46
    v_exp_f32 v47, v47
    s_waitcnt lgkmcnt(3)
    v_exp_f32 v48, v48
    v_exp_f32 v49, v49
    v_smfmac_f32_32x32x32_bf16 v[64:79], v[120:123], v[40:47], v127
    v_exp_f32 v50, v50
    s_setprio 2
    v_exp_f32 v51, v51
    v_exp_f32 v52, v52
    v_exp_f32 v53, v53
    v_exp_f32 v54, v54
    v_mfma_f32_32x32x16_bf16 v[32:47], v[92:95], v[4:7], v[16:31]
    ds_read_b128 v[88:91], v126 offset:24576
    s_mov_b64 exec, s[34:35]
    ds_read_b128 v[116:119], v3 offset:23552
    ds_read_b128 v[120:123], v3 offset:24064
    s_mov_b64 exec, -1
    v_exp_f32 v55, v55
    v_exp_f32 v56, v56
    v_exp_f32 v57, v57
    v_exp_f32 v58, v58
    v_exp_f32 v59, v59
    v_smfmac_f32_32x32x32_bf16 v[64:79], v[100:103], v[48:55], v127
    s_add_u32 m0, s55, 2048
    s_add_u32 s29, s54, 344064
    buffer_load_dwordx4 v8, s[12:15], s29 offen  lds
    s_add_u32 m0, s55, 3072
    s_nop 0
    buffer_load_dwordx4 v8, s[16:19], s29 offen  lds
    v_exp_f32 v60, v60
    v_exp_f32 v61, v61
    v_exp_f32 v62, v62
    v_exp_f32 v63, v63
    s_waitcnt lgkmcnt(3)
    v_exp_f32 v32, v32
    v_exp_f32 v33, v33
    v_smfmac_f32_32x32x32_bf16 v[64:79], v[104:107], v[56:63], v127
    v_exp_f32 v34, v34
    v_exp_f32 v35, v35
    v_exp_f32 v36, v36
    v_exp_f32 v37, v37
    v_exp_f32 v38, v38
    v_mfma_f32_32x32x16_bf16 v[48:63], v[96:99], v[4:7], v[16:31]
    ds_read_b128 v[92:95], v126 offset:25600
    s_mov_b64 exec, s[34:35]
    ds_read_b128 v[100:103], v3 offset:24576
    ds_read_b128 v[104:107], v3 offset:25088
    s_mov_b64 exec, -1
    v_exp_f32 v39, v39
    v_exp_f32 v40, v40
    v_exp_f32 v41, v41
    v_exp_f32 v42, v42
    v_exp_f32 v43, v43
    v_smfmac_f32_32x32x32_bf16 v[64:79], v[108:111], v[32:39], v127
    v_exp_f32 v44, v44
    v_exp_f32 v45, v45
    v_exp_f32 v46, v46
    v_exp_f32 v47, v47
    s_waitcnt lgkmcnt(3)
    v_exp_f32 v48, v48
    v_exp_f32 v49, v49
    v_smfmac_f32_32x32x32_bf16 v[64:79], v[112:115], v[40:47], v127
    v_exp_f32 v50, v50
    v_exp_f32 v51, v51
    v_exp_f32 v52, v52
    v_exp_f32 v53, v53
    v_exp_f32 v54, v54
    v_mfma_f32_32x32x16_bf16 v[32:47], v[88:91], v[4:7], v[16:31]
    s_waitcnt vmcnt(2)
    ds_read_b64_tr_b16 v[144:145], v9 offset:0
    ds_read_b64_tr_b16 v[146:147], v9 offset:256
    ds_read_b64_tr_b16 v[148:149], v9 offset:512
    ds_read_b64_tr_b16 v[150:151], v9 offset:768
    ds_read_b128 v[96:99], v126 offset:26624
    s_mov_b64 exec, s[34:35]
    ds_read_b128 v[108:111], v3 offset:25600
    ds_read_b128 v[112:115], v3 offset:26112
    s_mov_b64 exec, -1
    v_exp_f32 v55, v55
    v_exp_f32 v56, v56
    v_exp_f32 v57, v57
    v_exp_f32 v58, v58
    v_exp_f32 v59, v59
    v_smfmac_f32_32x32x32_bf16 v[64:79], v[116:119], v[48:55], v127
    v_exp_f32 v60, v60
    v_exp_f32 v61, v61
    v_exp_f32 v62, v62
    v_exp_f32 v63, v63
    s_waitcnt vmcnt(8)
    s_barrier
    s_setprio 0
    s_waitcnt lgkmcnt(3)
    v_exp_f32 v32, v32
    v_exp_f32 v33, v33
    v_smfmac_f32_32x32x32_bf16 v[64:79], v[120:123], v[56:63], v127
    v_exp_f32 v34, v34
    v_exp_f32 v35, v35
    s_setprio 1
    v_exp_f32 v36, v36
    v_exp_f32 v37, v37
    v_exp_f32 v38, v38
    v_mfma_f32_32x32x16_bf16 v[48:63], v[92:95], v[4:7], v[16:31]
    ds_read_b128 v[88:91], v126 offset:27648
    s_mov_b64 exec, s[34:35]
    ds_read_b128 v[116:119], v3 offset:26624
    ds_read_b128 v[120:123], v3 offset:27136
    s_mov_b64 exec, -1
    v_exp_f32 v39, v39
    v_exp_f32 v40, v40
    v_exp_f32 v41, v41
    v_exp_f32 v42, v42
    v_exp_f32 v43, v43
    v_smfmac_f32_32x32x32_bf16 v[64:79], v[100:103], v[32:39], v127
    s_add_u32 m0, s55, 0
    s_add_u32 s29, s54, 458752
    buffer_load_dwordx4 v8, s[12:15], s29 offen  lds
    s_add_u32 m0, s55, 1024
    s_nop 0
    buffer_load_dwordx4 v8, s[16:19], s29 offen  lds
    v_exp_f32 v44, v44
    v_exp_f32 v45, v45
    v_exp_f32 v46, v46
    v_exp_f32 v47, v47
    s_waitcnt lgkmcnt(3)
    v_exp_f32 v48, v48
    v_exp_f32 v49, v49
    v_smfmac_f32_32x32x32_bf16 v[64:79], v[104:107], v[40:47], v127
    v_exp_f32 v50, v50
    s_setprio 2
    v_exp_f32 v51, v51
    v_exp_f32 v52, v52
    v_exp_f32 v53, v53
    v_exp_f32 v54, v54
    v_mfma_f32_32x32x16_bf16 v[32:47], v[96:99], v[4:7], v[16:31]
    ds_read_b128 v[92:95], v126 offset:28672
    s_mov_b64 exec, s[34:35]
    ds_read_b128 v[100:103], v3 offset:27648
    ds_read_b128 v[104:107], v3 offset:28160
    s_mov_b64 exec, -1
    v_exp_f32 v55, v55
    v_exp_f32 v56, v56
    v_exp_f32 v57, v57
    v_exp_f32 v58, v58
    v_exp_f32 v59, v59
    v_smfmac_f32_32x32x32_bf16 v[64:79], v[108:111], v[48:55], v127
    v_exp_f32 v60, v60
    v_exp_f32 v61, v61
    v_exp_f32 v62, v62
    v_exp_f32 v63, v63
    s_waitcnt lgkmcnt(3)
    v_exp_f32 v32, v32
    v_exp_f32 v33, v33
    v_smfmac_f32_32x32x32_bf16 v[64:79], v[112:115], v[56:63], v127
    v_exp_f32 v34, v34
    v_exp_f32 v35, v35
    v_exp_f32 v36, v36
    v_exp_f32 v37, v37
    v_exp_f32 v38, v38
    v_mfma_f32_32x32x16_bf16 v[48:63], v[88:91], v[4:7], v[16:31]
    s_waitcnt vmcnt(2)
    ds_read_b64_tr_b16 v[152:153], v9 offset:2048
    ds_read_b64_tr_b16 v[154:155], v9 offset:2304
    ds_read_b64_tr_b16 v[156:157], v9 offset:2560
    ds_read_b64_tr_b16 v[158:159], v9 offset:2816
    ds_read_b128 v[96:99], v126 offset:29696
    s_mov_b64 exec, s[34:35]
    ds_read_b128 v[108:111], v3 offset:28672
    ds_read_b128 v[112:115], v3 offset:29184
    s_mov_b64 exec, -1
    v_exp_f32 v39, v39
    v_exp_f32 v40, v40
    v_exp_f32 v41, v41
    v_exp_f32 v42, v42
    v_exp_f32 v43, v43
    v_smfmac_f32_32x32x32_bf16 v[64:79], v[116:119], v[32:39], v127
    v_exp_f32 v44, v44
    v_exp_f32 v45, v45
    v_exp_f32 v46, v46
    v_exp_f32 v47, v47
    s_waitcnt lgkmcnt(3)
    v_exp_f32 v48, v48
    v_exp_f32 v49, v49
    v_smfmac_f32_32x32x32_bf16 v[64:79], v[120:123], v[40:47], v127
    v_exp_f32 v50, v50
    v_exp_f32 v51, v51
    v_exp_f32 v52, v52
    v_exp_f32 v53, v53
    v_exp_f32 v54, v54
    v_mfma_f32_32x32x16_bf16 v[32:47], v[92:95], v[4:7], v[16:31]
    ds_read_b128 v[88:91], v126 offset:30720
    s_mov_b64 exec, s[34:35]
    ds_read_b128 v[116:119], v3 offset:29696
    ds_read_b128 v[120:123], v3 offset:30208
    s_mov_b64 exec, -1
    v_exp_f32 v55, v55
    v_exp_f32 v56, v56
    v_exp_f32 v57, v57
    v_exp_f32 v58, v58
    v_exp_f32 v59, v59
    v_smfmac_f32_32x32x32_bf16 v[64:79], v[100:103], v[48:55], v127
    s_add_u32 m0, s55, 2048
    s_add_u32 s29, s54, 573440
    buffer_load_dwordx4 v8, s[12:15], s29 offen  lds
    s_add_u32 m0, s55, 3072
    s_nop 0
    buffer_load_dwordx4 v8, s[16:19], s29 offen  lds
    v_exp_f32 v60, v60
    v_exp_f32 v61, v61
    v_exp_f32 v62, v62
    v_exp_f32 v63, v63
    s_setprio 0
    s_waitcnt lgkmcnt(3)
    v_exp_f32 v32, v32
    v_exp_f32 v33, v33
    v_smfmac_f32_32x32x32_bf16 v[64:79], v[104:107], v[56:63], v127
    v_exp_f32 v34, v34
    v_exp_f32 v35, v35
    s_setprio 1
    v_exp_f32 v36, v36
    v_exp_f32 v37, v37
    v_exp_f32 v38, v38
    v_mfma_f32_32x32x16_bf16 v[48:63], v[96:99], v[4:7], v[16:31]
    ds_read_b128 v[92:95], v126 offset:31744
    s_mov_b64 exec, s[34:35]
    ds_read_b128 v[100:103], v3 offset:30720
    ds_read_b128 v[104:107], v3 offset:31232
    s_mov_b64 exec, -1
    v_exp_f32 v39, v39
    v_exp_f32 v40, v40
    v_exp_f32 v41, v41
    v_exp_f32 v42, v42
    v_exp_f32 v43, v43
    v_smfmac_f32_32x32x32_bf16 v[64:79], v[108:111], v[32:39], v127
    v_exp_f32 v44, v44
    v_exp_f32 v45, v45
    v_exp_f32 v46, v46
    v_exp_f32 v47, v47
    s_waitcnt lgkmcnt(3)
    v_exp_f32 v48, v48
    v_exp_f32 v49, v49
    v_smfmac_f32_32x32x32_bf16 v[64:79], v[112:115], v[40:47], v127
    v_exp_f32 v50, v50
    s_setprio 2
    v_exp_f32 v51, v51
    v_exp_f32 v52, v52
    v_exp_f32 v53, v53
    v_exp_f32 v54, v54
    v_mfma_f32_32x32x16_bf16 v[32:47], v[88:91], v[4:7], v[16:31]
    s_waitcnt vmcnt(2)
    ds_read_b64_tr_b16 v[160:161], v9 offset:0
    ds_read_b64_tr_b16 v[162:163], v9 offset:256
    ds_read_b64_tr_b16 v[164:165], v9 offset:512
    ds_read_b64_tr_b16 v[166:167], v9 offset:768
    ds_read_b128 v[96:99], v126 offset:32768
    s_mov_b64 exec, s[34:35]
    ds_read_b128 v[108:111], v3 offset:31744
    ds_read_b128 v[112:115], v3 offset:32256
    s_mov_b64 exec, -1
    v_exp_f32 v55, v55
    v_exp_f32 v56, v56
    v_exp_f32 v57, v57
    v_exp_f32 v58, v58
    v_exp_f32 v59, v59
    v_smfmac_f32_32x32x32_bf16 v[64:79], v[116:119], v[48:55], v127
    v_exp_f32 v60, v60
    v_exp_f32 v61, v61
    v_exp_f32 v62, v62
    v_exp_f32 v63, v63
    s_waitcnt lgkmcnt(3)
    v_exp_f32 v32, v32
    v_exp_f32 v33, v33
    v_smfmac_f32_32x32x32_bf16 v[64:79], v[120:123], v[56:63], v127
    v_exp_f32 v34, v34
    v_exp_f32 v35, v35
    v_exp_f32 v36, v36
    v_exp_f32 v37, v37
    v_exp_f32 v38, v38
    v_mfma_f32_32x32x16_bf16 v[48:63], v[92:95], v[4:7], v[16:31]
    ds_read_b128 v[88:91], v126 offset:33792
    s_mov_b64 exec, s[34:35]
    ds_read_b128 v[116:119], v3 offset:32768
    ds_read_b128 v[120:123], v3 offset:33280
    s_mov_b64 exec, -1
    v_exp_f32 v39, v39
    v_exp_f32 v40, v40
    v_exp_f32 v41, v41
    v_exp_f32 v42, v42
    v_exp_f32 v43, v43
    v_smfmac_f32_32x32x32_bf16 v[64:79], v[100:103], v[32:39], v127
    s_add_u32 m0, s55, 0
    s_add_u32 s29, s54, 688128
    buffer_load_dwordx4 v8, s[12:15], s29 offen  lds
    s_add_u32 m0, s55, 1024
    s_nop 0
    buffer_load_dwordx4 v8, s[16:19], s29 offen  lds
    v_exp_f32 v44, v44
    v_exp_f32 v45, v45
    v_exp_f32 v46, v46
    v_exp_f32 v47, v47
    s_waitcnt lgkmcnt(3)
    v_exp_f32 v48, v48
    v_exp_f32 v49, v49
    v_smfmac_f32_32x32x32_bf16 v[64:79], v[104:107], v[40:47], v127
    v_exp_f32 v50, v50
    v_exp_f32 v51, v51
    v_exp_f32 v52, v52
    v_exp_f32 v53, v53
    v_exp_f32 v54, v54
    v_mfma_f32_32x32x16_bf16 v[32:47], v[96:99], v[4:7], v[16:31]
    ds_read_b128 v[92:95], v126 offset:34816
    s_mov_b64 exec, s[34:35]
    ds_read_b128 v[100:103], v3 offset:33792
    ds_read_b128 v[104:107], v3 offset:34304
    s_mov_b64 exec, -1
    v_exp_f32 v55, v55
    v_exp_f32 v56, v56
    v_exp_f32 v57, v57
    v_exp_f32 v58, v58
    v_exp_f32 v59, v59
    v_smfmac_f32_32x32x32_bf16 v[64:79], v[108:111], v[48:55], v127
    v_exp_f32 v60, v60
    v_exp_f32 v61, v61
    v_exp_f32 v62, v62
    v_exp_f32 v63, v63
    s_setprio 0
    s_waitcnt lgkmcnt(3)
    v_exp_f32 v32, v32
    v_exp_f32 v33, v33
    v_smfmac_f32_32x32x32_bf16 v[64:79], v[112:115], v[56:63], v127
    v_exp_f32 v34, v34
    v_exp_f32 v35, v35
    s_setprio 1
    v_exp_f32 v36, v36
    v_exp_f32 v37, v37
    v_exp_f32 v38, v38
    v_mfma_f32_32x32x16_bf16 v[48:63], v[88:91], v[4:7], v[16:31]
    s_waitcnt vmcnt(2)
    ds_read_b64_tr_b16 v[168:169], v9 offset:2048
    ds_read_b64_tr_b16 v[170:171], v9 offset:2304
    ds_read_b64_tr_b16 v[172:173], v9 offset:2560
    ds_read_b64_tr_b16 v[174:175], v9 offset:2816
    ds_read_b128 v[96:99], v126 offset:35840
    s_mov_b64 exec, s[34:35]
    ds_read_b128 v[108:111], v3 offset:34816
    ds_read_b128 v[112:115], v3 offset:35328
    s_mov_b64 exec, -1
    v_exp_f32 v39, v39
    v_exp_f32 v40, v40
    v_exp_f32 v41, v41
    v_exp_f32 v42, v42
    v_exp_f32 v43, v43
    v_smfmac_f32_32x32x32_bf16 v[64:79], v[116:119], v[32:39], v127
    v_exp_f32 v44, v44
    v_exp_f32 v45, v45
    v_exp_f32 v46, v46
    v_exp_f32 v47, v47
    s_waitcnt lgkmcnt(3)
    v_exp_f32 v48, v48
    v_exp_f32 v49, v49
    v_smfmac_f32_32x32x32_bf16 v[64:79], v[120:123], v[40:47], v127
    v_exp_f32 v50, v50
    s_setprio 2
    v_exp_f32 v51, v51
    v_exp_f32 v52, v52
    v_exp_f32 v53, v53
    v_exp_f32 v54, v54
    v_mfma_f32_32x32x16_bf16 v[32:47], v[92:95], v[4:7], v[16:31]
    ds_read_b128 v[88:91], v126 offset:36864
    s_mov_b64 exec, s[34:35]
    ds_read_b128 v[116:119], v3 offset:35840
    ds_read_b128 v[120:123], v3 offset:36352
    s_mov_b64 exec, -1
    v_exp_f32 v55, v55
    v_exp_f32 v56, v56
    v_exp_f32 v57, v57
    v_exp_f32 v58, v58
    v_exp_f32 v59, v59
    v_smfmac_f32_32x32x32_bf16 v[64:79], v[100:103], v[48:55], v127
    s_add_u32 m0, s55, 2048
    s_add_u32 s29, s54, 802816
    buffer_load_dwordx4 v8, s[12:15], s29 offen  lds
    s_add_u32 m0, s55, 3072
    s_nop 0
    buffer_load_dwordx4 v8, s[16:19], s29 offen  lds
    v_exp_f32 v60, v60
    v_exp_f32 v61, v61
    v_exp_f32 v62, v62
    v_exp_f32 v63, v63
    s_waitcnt lgkmcnt(3)
    v_exp_f32 v32, v32
    v_exp_f32 v33, v33
    v_smfmac_f32_32x32x32_bf16 v[64:79], v[104:107], v[56:63], v127
    v_exp_f32 v34, v34
    v_exp_f32 v35, v35
    v_exp_f32 v36, v36
    v_exp_f32 v37, v37
    v_exp_f32 v38, v38
    v_mfma_f32_32x32x16_bf16 v[48:63], v[96:99], v[4:7], v[16:31]
    ds_read_b128 v[92:95], v126 offset:37888
    s_mov_b64 exec, s[34:35]
    ds_read_b128 v[100:103], v3 offset:36864
    ds_read_b128 v[104:107], v3 offset:37376
    s_mov_b64 exec, -1
    v_exp_f32 v39, v39
    v_exp_f32 v40, v40
    v_exp_f32 v41, v41
    v_exp_f32 v42, v42
    v_exp_f32 v43, v43
    v_smfmac_f32_32x32x32_bf16 v[64:79], v[108:111], v[32:39], v127
    v_exp_f32 v44, v44
    v_exp_f32 v45, v45
    v_exp_f32 v46, v46
    v_exp_f32 v47, v47
    s_waitcnt lgkmcnt(3)
    v_exp_f32 v48, v48
    v_exp_f32 v49, v49
    v_smfmac_f32_32x32x32_bf16 v[64:79], v[112:115], v[40:47], v127
    v_exp_f32 v50, v50
    v_exp_f32 v51, v51
    v_exp_f32 v52, v52
    v_exp_f32 v53, v53
    v_exp_f32 v54, v54
    v_mfma_f32_32x32x16_bf16 v[32:47], v[88:91], v[4:7], v[16:31]
    s_waitcnt vmcnt(2)
    ds_read_b64_tr_b16 v[176:177], v9 offset:0
    ds_read_b64_tr_b16 v[178:179], v9 offset:256
    ds_read_b64_tr_b16 v[180:181], v9 offset:512
    ds_read_b64_tr_b16 v[182:183], v9 offset:768
    ds_read_b128 v[96:99], v126 offset:38912
    s_mov_b64 exec, s[34:35]
    ds_read_b128 v[108:111], v3 offset:37888
    ds_read_b128 v[112:115], v3 offset:38400
    s_mov_b64 exec, -1
    v_exp_f32 v55, v55
    v_exp_f32 v56, v56
    v_exp_f32 v57, v57
    v_exp_f32 v58, v58
    v_exp_f32 v59, v59
    v_smfmac_f32_32x32x32_bf16 v[64:79], v[116:119], v[48:55], v127
    v_exp_f32 v60, v60
    v_exp_f32 v61, v61
    v_exp_f32 v62, v62
    v_exp_f32 v63, v63
    s_setprio 0
    s_waitcnt lgkmcnt(3)
    v_exp_f32 v32, v32
    v_exp_f32 v33, v33
    v_smfmac_f32_32x32x32_bf16 v[64:79], v[120:123], v[56:63], v127
    v_exp_f32 v34, v34
    v_exp_f32 v35, v35
    s_setprio 1
    v_exp_f32 v36, v36
    v_exp_f32 v37, v37
    v_exp_f32 v38, v38
    v_mfma_f32_32x32x16_bf16 v[48:63], v[92:95], v[4:7], v[16:31]
    ds_read_b128 v[88:91], v126 offset:39936
    s_mov_b64 exec, s[34:35]
    ds_read_b128 v[116:119], v3 offset:38912
    ds_read_b128 v[120:123], v3 offset:39424
    s_mov_b64 exec, -1
    v_exp_f32 v39, v39
    v_exp_f32 v40, v40
    v_exp_f32 v41, v41
    v_exp_f32 v42, v42
    v_exp_f32 v43, v43
    v_smfmac_f32_32x32x32_bf16 v[64:79], v[100:103], v[32:39], v127
    s_add_u32 m0, s55, 0
    s_add_u32 s29, s54, 917504
    buffer_load_dwordx4 v8, s[12:15], s29 offen  lds
    s_add_u32 m0, s55, 1024
    s_nop 0
    buffer_load_dwordx4 v8, s[16:19], s29 offen  lds
    v_exp_f32 v44, v44
    v_exp_f32 v45, v45
    v_exp_f32 v46, v46
    v_exp_f32 v47, v47
    s_waitcnt lgkmcnt(3)
    v_exp_f32 v48, v48
    v_exp_f32 v49, v49
    v_smfmac_f32_32x32x32_bf16 v[64:79], v[104:107], v[40:47], v127
    v_exp_f32 v50, v50
    s_setprio 2
    v_exp_f32 v51, v51
    v_exp_f32 v52, v52
    v_exp_f32 v53, v53
    v_exp_f32 v54, v54
    v_mfma_f32_32x32x16_bf16 v[32:47], v[96:99], v[4:7], v[16:31]
    ds_read_b128 v[92:95], v126 offset:40960
    s_mov_b64 exec, s[34:35]
    ds_read_b128 v[100:103], v3 offset:39936
    ds_read_b128 v[104:107], v3 offset:40448
    s_mov_b64 exec, -1
    v_exp_f32 v55, v55
    v_exp_f32 v56, v56
    v_exp_f32 v57, v57
    v_exp_f32 v58, v58
    v_exp_f32 v59, v59
    v_smfmac_f32_32x32x32_bf16 v[64:79], v[108:111], v[48:55], v127
    v_exp_f32 v60, v60
    v_exp_f32 v61, v61
    v_exp_f32 v62, v62
    v_exp_f32 v63, v63
    s_waitcnt lgkmcnt(3)
    v_exp_f32 v32, v32
    v_exp_f32 v33, v33
    v_smfmac_f32_32x32x32_bf16 v[64:79], v[112:115], v[56:63], v127
    v_exp_f32 v34, v34
    v_exp_f32 v35, v35
    v_exp_f32 v36, v36
    v_exp_f32 v37, v37
    v_exp_f32 v38, v38
    v_mfma_f32_32x32x16_bf16 v[48:63], v[88:91], v[4:7], v[16:31]
    s_waitcnt vmcnt(2)
    ds_read_b64_tr_b16 v[184:185], v9 offset:2048
    ds_read_b64_tr_b16 v[186:187], v9 offset:2304
    ds_read_b64_tr_b16 v[188:189], v9 offset:2560
    ds_read_b64_tr_b16 v[190:191], v9 offset:2816
    ds_read_b128 v[96:99], v126 offset:41984
    s_mov_b64 exec, s[34:35]
    ds_read_b128 v[108:111], v3 offset:40960
    ds_read_b128 v[112:115], v3 offset:41472
    s_mov_b64 exec, -1
    v_exp_f32 v39, v39
    v_exp_f32 v40, v40
    v_exp_f32 v41, v41
    v_exp_f32 v42, v42
    v_exp_f32 v43, v43
    v_smfmac_f32_32x32x32_bf16 v[64:79], v[116:119], v[32:39], v127
    v_exp_f32 v44, v44
    v_exp_f32 v45, v45
    v_exp_f32 v46, v46
    v_exp_f32 v47, v47
    s_waitcnt lgkmcnt(3)
    v_exp_f32 v48, v48
    v_exp_f32 v49, v49
    v_smfmac_f32_32x32x32_bf16 v[64:79], v[120:123], v[40:47], v127
    v_exp_f32 v50, v50
    v_exp_f32 v51, v51
    v_exp_f32 v52, v52
    v_exp_f32 v53, v53
    v_exp_f32 v54, v54
    v_mfma_f32_32x32x16_bf16 v[32:47], v[92:95], v[4:7], v[16:31]
    ds_read_b128 v[88:91], v126 offset:43008
    s_mov_b64 exec, s[34:35]
    ds_read_b128 v[116:119], v3 offset:41984
    ds_read_b128 v[120:123], v3 offset:42496
    s_mov_b64 exec, -1
    v_exp_f32 v55, v55
    v_exp_f32 v56, v56
    v_exp_f32 v57, v57
    v_exp_f32 v58, v58
    v_exp_f32 v59, v59
    v_smfmac_f32_32x32x32_bf16 v[64:79], v[100:103], v[48:55], v127
    s_add_u32 m0, s55, 2048
    s_add_u32 s29, s54, 1032192
    buffer_load_dwordx4 v8, s[12:15], s29 offen  lds
    s_add_u32 m0, s55, 3072
    s_nop 0
    buffer_load_dwordx4 v8, s[16:19], s29 offen  lds
    v_exp_f32 v60, v60
    v_exp_f32 v61, v61
    v_exp_f32 v62, v62
    v_exp_f32 v63, v63
    s_setprio 0
    s_waitcnt lgkmcnt(3)
    v_exp_f32 v32, v32
    v_exp_f32 v33, v33
    v_smfmac_f32_32x32x32_bf16 v[64:79], v[104:107], v[56:63], v127
    v_exp_f32 v34, v34
    v_exp_f32 v35, v35
    s_setprio 1
    v_exp_f32 v36, v36
    v_exp_f32 v37, v37
    v_exp_f32 v38, v38
    v_mfma_f32_32x32x16_bf16 v[48:63], v[96:99], v[4:7], v[16:31]
    ds_read_b128 v[92:95], v126 offset:44032
    s_mov_b64 exec, s[34:35]
    ds_read_b128 v[100:103], v3 offset:43008
    ds_read_b128 v[104:107], v3 offset:43520
    s_mov_b64 exec, -1
    v_exp_f32 v39, v39
    v_exp_f32 v40, v40
    v_exp_f32 v41, v41
    v_exp_f32 v42, v42
    v_exp_f32 v43, v43
    v_smfmac_f32_32x32x32_bf16 v[64:79], v[108:111], v[32:39], v127
    s_mov_b32 s96, s48
    s_mov_b32 s97, s49
    s_mov_b32 s98, 0x1c0000
    s_mov_b32 s99, 0x00020000
    s_lshl_b32 s29, s2, 3
    s_add_u32 s29, s29, s22
    s_mul_i32 s29, s29, 896
    v_min_u32 v12, 6, v0
    v_lshlrev_b32 v12, 7, v12
    buffer_load_dword v124, v12, s[96:99], s29 offen
    v_exp_f32 v44, v44
    v_exp_f32 v45, v45
    v_exp_f32 v46, v46
    v_exp_f32 v47, v47
    s_waitcnt lgkmcnt(3)
    v_exp_f32 v48, v48
    v_exp_f32 v49, v49
    v_smfmac_f32_32x32x32_bf16 v[64:79], v[112:115], v[40:47], v127
    v_exp_f32 v50, v50
    s_setprio 2
    v_exp_f32 v51, v51
    v_exp_f32 v52, v52
    v_exp_f32 v53, v53
    v_exp_f32 v54, v54
    v_mfma_f32_32x32x16_bf16 v[32:47], v[88:91], v[4:7], v[16:31]
    s_waitcnt vmcnt(3)
    ds_read_b64_tr_b16 v[192:193], v9 offset:0
    ds_read_b64_tr_b16 v[194:195], v9 offset:256
    ds_read_b64_tr_b16 v[196:197], v9 offset:512
    ds_read_b64_tr_b16 v[198:199], v9 offset:768
    ds_read_b128 v[96:99], v126 offset:45056
    s_mov_b64 exec, s[34:35]
    ds_read_b128 v[108:111], v3 offset:44032
    ds_read_b128 v[112:115], v3 offset:44544
    s_mov_b64 exec, -1
    v_exp_f32 v55, v55
    v_exp_f32 v56, v56
    v_exp_f32 v57, v57
    v_exp_f32 v58, v58
    v_exp_f32 v59, v59
    v_smfmac_f32_32x32x32_bf16 v[64:79], v[116:119], v[48:55], v127
    v_exp_f32 v60, v60
    v_exp_f32 v61, v61
    v_exp_f32 v62, v62
    v_exp_f32 v63, v63
    s_waitcnt lgkmcnt(3)
    v_exp_f32 v32, v32
    v_exp_f32 v33, v33
    v_smfmac_f32_32x32x32_bf16 v[64:79], v[120:123], v[56:63], v127
    v_exp_f32 v34, v34
    v_exp_f32 v35, v35
    v_exp_f32 v36, v36
    v_exp_f32 v37, v37
    v_exp_f32 v38, v38
    v_mfma_f32_32x32x16_bf16 v[48:63], v[92:95], v[4:7], v[16:31]
    ds_read_b128 v[88:91], v126 offset:46080
    s_mov_b64 exec, s[34:35]
    ds_read_b128 v[116:119], v3 offset:45056
    ds_read_b128 v[120:123], v3 offset:45568
    s_mov_b64 exec, -1
    v_exp_f32 v39, v39
    v_exp_f32 v40, v40
    v_exp_f32 v41, v41
    v_exp_f32 v42, v42
    v_exp_f32 v43, v43
    v_smfmac_f32_32x32x32_bf16 v[64:79], v[100:103], v[32:39], v127
    s_add_u32 m0, s55, 0
    s_add_u32 s29, s54, 1146880
    buffer_load_dwordx4 v8, s[12:15], s29 offen  lds
    s_add_u32 m0, s55, 1024
    s_nop 0
    buffer_load_dwordx4 v8, s[16:19], s29 offen  lds
    v_exp_f32 v44, v44
    v_exp_f32 v45, v45
    v_exp_f32 v46, v46
    v_exp_f32 v47, v47
    s_waitcnt lgkmcnt(3)
    v_exp_f32 v48, v48
    v_exp_f32 v49, v49
    v_smfmac_f32_32x32x32_bf16 v[64:79], v[104:107], v[40:47], v127
    v_exp_f32 v50, v50
    v_exp_f32 v51, v51
    v_exp_f32 v52, v52
    v_exp_f32 v53, v53
    v_exp_f32 v54, v54
    v_mfma_f32_32x32x16_bf16 v[32:47], v[96:99], v[4:7], v[16:31]
    ds_read_b128 v[92:95], v126 offset:47104
    s_mov_b64 exec, s[34:35]
    ds_read_b128 v[100:103], v3 offset:46080
    ds_read_b128 v[104:107], v3 offset:46592
    s_mov_b64 exec, -1
    v_exp_f32 v55, v55
    v_exp_f32 v56, v56
    v_exp_f32 v57, v57
    v_exp_f32 v58, v58
    v_exp_f32 v59, v59
    v_smfmac_f32_32x32x32_bf16 v[64:79], v[108:111], v[48:55], v127
    v_exp_f32 v60, v60
    v_exp_f32 v61, v61
    v_exp_f32 v62, v62
    v_exp_f32 v63, v63
    s_setprio 0
    s_waitcnt lgkmcnt(3)
    v_exp_f32 v32, v32
    v_exp_f32 v33, v33
    v_smfmac_f32_32x32x32_bf16 v[64:79], v[112:115], v[56:63], v127
    v_exp_f32 v34, v34
    v_exp_f32 v35, v35
    s_setprio 1
    v_exp_f32 v36, v36
    v_exp_f32 v37, v37
    v_exp_f32 v38, v38
    v_mfma_f32_32x32x16_bf16 v[48:63], v[88:91], v[4:7], v[16:31]
    s_waitcnt vmcnt(3)
    ds_read_b64_tr_b16 v[200:201], v9 offset:2048
    ds_read_b64_tr_b16 v[202:203], v9 offset:2304
    ds_read_b64_tr_b16 v[204:205], v9 offset:2560
    ds_read_b64_tr_b16 v[206:207], v9 offset:2816
    ds_read_b128 v[96:99], v126 offset:48128
    s_mov_b64 exec, s[34:35]
    ds_read_b128 v[108:111], v3 offset:47104
    ds_read_b128 v[112:115], v3 offset:47616
    s_mov_b64 exec, -1
    v_exp_f32 v39, v39
    v_exp_f32 v40, v40
    v_exp_f32 v41, v41
    v_exp_f32 v42, v42
    v_exp_f32 v43, v43
    v_smfmac_f32_32x32x32_bf16 v[64:79], v[116:119], v[32:39], v127
    v_exp_f32 v44, v44
    v_exp_f32 v45, v45
    v_exp_f32 v46, v46
    v_exp_f32 v47, v47
    s_waitcnt lgkmcnt(3)
    v_exp_f32 v48, v48
    v_exp_f32 v49, v49
    v_smfmac_f32_32x32x32_bf16 v[64:79], v[120:123], v[40:47], v127
    v_exp_f32 v50, v50
    s_setprio 2
    v_exp_f32 v51, v51
    v_exp_f32 v52, v52
    v_exp_f32 v53, v53
    v_exp_f32 v54, v54
    v_mfma_f32_32x32x16_bf16 v[32:47], v[92:95], v[4:7], v[16:31]
    ds_read_b128 v[88:91], v126 offset:49152
    s_mov_b64 exec, s[34:35]
    ds_read_b128 v[116:119], v3 offset:48128
    ds_read_b128 v[120:123], v3 offset:48640
    s_mov_b64 exec, -1
    v_exp_f32 v55, v55
    v_exp_f32 v56, v56
    v_exp_f32 v57, v57
    v_exp_f32 v58, v58
    v_exp_f32 v59, v59
    v_smfmac_f32_32x32x32_bf16 v[64:79], v[100:103], v[48:55], v127
    s_add_u32 m0, s55, 2048
    s_add_u32 s29, s54, 1261568
    buffer_load_dwordx4 v8, s[12:15], s29 offen  lds
    s_add_u32 m0, s55, 3072
    s_nop 0
    buffer_load_dwordx4 v8, s[16:19], s29 offen  lds
    v_exp_f32 v60, v60
    v_exp_f32 v61, v61
    v_exp_f32 v62, v62
    v_exp_f32 v63, v63
    s_waitcnt lgkmcnt(3)
    v_exp_f32 v32, v32
    v_exp_f32 v33, v33
    v_smfmac_f32_32x32x32_bf16 v[64:79], v[104:107], v[56:63], v127
    v_exp_f32 v34, v34
    v_exp_f32 v35, v35
    v_exp_f32 v36, v36
    v_exp_f32 v37, v37
    v_exp_f32 v38, v38
    v_mfma_f32_32x32x16_bf16 v[48:63], v[96:99], v[4:7], v[16:31]
    ds_read_b128 v[92:95], v126 offset:50176
    s_mov_b64 exec, s[34:35]
    ds_read_b128 v[100:103], v3 offset:49152
    ds_read_b128 v[104:107], v3 offset:49664
    s_mov_b64 exec, -1
    v_exp_f32 v39, v39
    v_exp_f32 v40, v40
    v_exp_f32 v41, v41
    v_exp_f32 v42, v42
    v_exp_f32 v43, v43
    v_smfmac_f32_32x32x32_bf16 v[64:79], v[108:111], v[32:39], v127
    v_exp_f32 v44, v44
    v_exp_f32 v45, v45
    v_exp_f32 v46, v46
    v_exp_f32 v47, v47
    s_waitcnt lgkmcnt(3)
    v_exp_f32 v48, v48
    v_exp_f32 v49, v49
    v_smfmac_f32_32x32x32_bf16 v[64:79], v[112:115], v[40:47], v127
    v_exp_f32 v50, v50
    v_exp_f32 v51, v51
    v_exp_f32 v52, v52
    v_exp_f32 v53, v53
    v_exp_f32 v54, v54
    v_mfma_f32_32x32x16_bf16 v[32:47], v[88:91], v[4:7], v[16:31]
    s_waitcnt vmcnt(2)
    ds_read_b64_tr_b16 v[208:209], v9 offset:0
    ds_read_b64_tr_b16 v[210:211], v9 offset:256
    ds_read_b64_tr_b16 v[212:213], v9 offset:512
    ds_read_b64_tr_b16 v[214:215], v9 offset:768
    ds_read_b128 v[96:99], v126 offset:51200
    s_mov_b64 exec, s[34:35]
    ds_read_b128 v[108:111], v3 offset:50176
    ds_read_b128 v[112:115], v3 offset:50688
    s_mov_b64 exec, -1
    v_exp_f32 v55, v55
    v_exp_f32 v56, v56
    v_exp_f32 v57, v57
    v_exp_f32 v58, v58
    v_exp_f32 v59, v59
    v_smfmac_f32_32x32x32_bf16 v[64:79], v[116:119], v[48:55], v127
    v_exp_f32 v60, v60
    v_exp_f32 v61, v61
    v_exp_f32 v62, v62
    v_exp_f32 v63, v63
    s_setprio 0
    s_waitcnt lgkmcnt(3)
    v_exp_f32 v32, v32
    v_exp_f32 v33, v33
    v_smfmac_f32_32x32x32_bf16 v[64:79], v[120:123], v[56:63], v127
    v_exp_f32 v34, v34
    v_exp_f32 v35, v35
    s_setprio 1
    v_exp_f32 v36, v36
    v_exp_f32 v37, v37
    v_exp_f32 v38, v38
    v_mfma_f32_32x32x16_bf16 v[48:63], v[92:95], v[4:7], v[16:31]
    ds_read_b128 v[88:91], v126 offset:52224
    s_mov_b64 exec, s[34:35]
    ds_read_b128 v[116:119], v3 offset:51200
    ds_read_b128 v[120:123], v3 offset:51712
    s_mov_b64 exec, -1
    v_exp_f32 v39, v39
    v_exp_f32 v40, v40
    v_exp_f32 v41, v41
    v_exp_f32 v42, v42
    v_exp_f32 v43, v43
    v_smfmac_f32_32x32x32_bf16 v[64:79], v[100:103], v[32:39], v127
    s_add_u32 m0, s55, 0
    s_add_u32 s29, s54, 1376256
    buffer_load_dwordx4 v8, s[12:15], s29 offen  lds
    s_add_u32 m0, s55, 1024
    s_nop 0
    buffer_load_dwordx4 v8, s[16:19], s29 offen  lds
    v_exp_f32 v44, v44
    v_exp_f32 v45, v45
    v_exp_f32 v46, v46
    v_exp_f32 v47, v47
    s_waitcnt lgkmcnt(3)
    v_exp_f32 v48, v48
    v_exp_f32 v49, v49
    v_smfmac_f32_32x32x32_bf16 v[64:79], v[104:107], v[40:47], v127
    v_exp_f32 v50, v50
    s_setprio 2
    v_exp_f32 v51, v51
    v_exp_f32 v52, v52
    v_exp_f32 v53, v53
    v_exp_f32 v54, v54
    v_mfma_f32_32x32x16_bf16 v[32:47], v[96:99], v[4:7], v[16:31]
    ds_read_b128 v[92:95], v126 offset:53248
    s_mov_b64 exec, s[34:35]
    ds_read_b128 v[100:103], v3 offset:52224
    ds_read_b128 v[104:107], v3 offset:52736
    s_mov_b64 exec, -1
    v_exp_f32 v55, v55
    v_exp_f32 v56, v56
    v_exp_f32 v57, v57
    v_exp_f32 v58, v58
    v_exp_f32 v59, v59
    v_smfmac_f32_32x32x32_bf16 v[64:79], v[108:111], v[48:55], v127
    v_exp_f32 v60, v60
    v_exp_f32 v61, v61
    v_exp_f32 v62, v62
    v_exp_f32 v63, v63
    s_waitcnt lgkmcnt(3)
    v_exp_f32 v32, v32
    v_exp_f32 v33, v33
    v_smfmac_f32_32x32x32_bf16 v[64:79], v[112:115], v[56:63], v127
    v_exp_f32 v34, v34
    v_exp_f32 v35, v35
    v_exp_f32 v36, v36
    v_exp_f32 v37, v37
    v_exp_f32 v38, v38
    v_mfma_f32_32x32x16_bf16 v[48:63], v[88:91], v[4:7], v[16:31]
    s_waitcnt vmcnt(2)
    ds_read_b64_tr_b16 v[216:217], v9 offset:2048
    ds_read_b64_tr_b16 v[218:219], v9 offset:2304
    ds_read_b64_tr_b16 v[220:221], v9 offset:2560
    ds_read_b64_tr_b16 v[222:223], v9 offset:2816
    ds_read_b128 v[96:99], v126 offset:54272
    s_mov_b64 exec, s[34:35]
    ds_read_b128 v[108:111], v3 offset:53248
    ds_read_b128 v[112:115], v3 offset:53760
    s_mov_b64 exec, -1
    v_exp_f32 v39, v39
    v_exp_f32 v40, v40
    v_exp_f32 v41, v41
    v_exp_f32 v42, v42
    v_exp_f32 v43, v43
    v_smfmac_f32_32x32x32_bf16 v[64:79], v[116:119], v[32:39], v127
    v_exp_f32 v44, v44
    v_exp_f32 v45, v45
    v_exp_f32 v46, v46
    v_exp_f32 v47, v47
    s_waitcnt lgkmcnt(3)
    v_exp_f32 v48, v48
    v_exp_f32 v49, v49
    v_smfmac_f32_32x32x32_bf16 v[64:79], v[120:123], v[40:47], v127
    v_exp_f32 v50, v50
    v_exp_f32 v51, v51
    v_exp_f32 v52, v52
    v_exp_f32 v53, v53
    v_exp_f32 v54, v54
    v_mfma_f32_32x32x16_bf16 v[32:47], v[92:95], v[4:7], v[16:31]
    ds_read_b128 v[88:91], v126 offset:55296
    s_mov_b64 exec, s[34:35]
    ds_read_b128 v[116:119], v3 offset:54272
    ds_read_b128 v[120:123], v3 offset:54784
    s_mov_b64 exec, -1
    v_exp_f32 v55, v55
    v_exp_f32 v56, v56
    v_exp_f32 v57, v57
    v_exp_f32 v58, v58
    v_exp_f32 v59, v59
    v_smfmac_f32_32x32x32_bf16 v[64:79], v[100:103], v[48:55], v127
    s_add_u32 m0, s55, 2048
    s_add_u32 s29, s54, 1490944
    buffer_load_dwordx4 v8, s[12:15], s29 offen  lds
    s_add_u32 m0, s55, 3072
    s_nop 0
    buffer_load_dwordx4 v8, s[16:19], s29 offen  lds
    v_exp_f32 v60, v60
    v_exp_f32 v61, v61
    v_exp_f32 v62, v62
    v_exp_f32 v63, v63
    s_setprio 0
    s_waitcnt lgkmcnt(3)
    v_exp_f32 v32, v32
    v_exp_f32 v33, v33
    v_smfmac_f32_32x32x32_bf16 v[64:79], v[104:107], v[56:63], v127
    v_exp_f32 v34, v34
    v_exp_f32 v35, v35
    s_setprio 1
    v_exp_f32 v36, v36
    v_exp_f32 v37, v37
    v_exp_f32 v38, v38
    v_mfma_f32_32x32x16_bf16 v[48:63], v[96:99], v[4:7], v[16:31]
    ds_read_b128 v[92:95], v126 offset:56320
    s_mov_b64 exec, s[34:35]
    ds_read_b128 v[100:103], v3 offset:55296
    ds_read_b128 v[104:107], v3 offset:55808
    s_mov_b64 exec, -1
    v_exp_f32 v39, v39
    v_exp_f32 v40, v40
    v_exp_f32 v41, v41
    v_exp_f32 v42, v42
    v_exp_f32 v43, v43
    v_smfmac_f32_32x32x32_bf16 v[64:79], v[108:111], v[32:39], v127
    v_exp_f32 v44, v44
    v_exp_f32 v45, v45
    v_exp_f32 v46, v46
    v_exp_f32 v47, v47
    s_waitcnt lgkmcnt(3)
    v_exp_f32 v48, v48
    v_exp_f32 v49, v49
    v_smfmac_f32_32x32x32_bf16 v[64:79], v[112:115], v[40:47], v127
    v_exp_f32 v50, v50
    s_setprio 2
    v_exp_f32 v51, v51
    v_exp_f32 v52, v52
    v_exp_f32 v53, v53
    v_exp_f32 v54, v54
    v_mfma_f32_32x32x16_bf16 v[32:47], v[88:91], v[4:7], v[16:31]
    s_waitcnt vmcnt(2)
    ds_read_b64_tr_b16 v[224:225], v9 offset:0
    ds_read_b64_tr_b16 v[226:227], v9 offset:256
    ds_read_b64_tr_b16 v[228:229], v9 offset:512
    ds_read_b64_tr_b16 v[230:231], v9 offset:768
    ds_read_b128 v[96:99], v126 offset:57344
    s_mov_b64 exec, s[34:35]
    ds_read_b128 v[108:111], v3 offset:56320
    ds_read_b128 v[112:115], v3 offset:56832
    s_mov_b64 exec, -1
    v_exp_f32 v55, v55
    v_exp_f32 v56, v56
    v_exp_f32 v57, v57
    v_exp_f32 v58, v58
    v_exp_f32 v59, v59
    v_smfmac_f32_32x32x32_bf16 v[64:79], v[116:119], v[48:55], v127
    v_exp_f32 v60, v60
    v_exp_f32 v61, v61
    v_exp_f32 v62, v62
    v_exp_f32 v63, v63
    s_waitcnt lgkmcnt(3)
    v_exp_f32 v32, v32
    v_exp_f32 v33, v33
    v_smfmac_f32_32x32x32_bf16 v[64:79], v[120:123], v[56:63], v127
    v_exp_f32 v34, v34
    v_exp_f32 v35, v35
    v_exp_f32 v36, v36
    v_exp_f32 v37, v37
    v_exp_f32 v38, v38
    v_mfma_f32_32x32x16_bf16 v[48:63], v[92:95], v[4:7], v[16:31]
    ds_read_b128 v[88:91], v126 offset:58368
    s_mov_b64 exec, s[34:35]
    ds_read_b128 v[116:119], v3 offset:57344
    ds_read_b128 v[120:123], v3 offset:57856
    s_mov_b64 exec, -1
    v_exp_f32 v39, v39
    v_exp_f32 v40, v40
    v_exp_f32 v41, v41
    v_exp_f32 v42, v42
    v_exp_f32 v43, v43
    v_smfmac_f32_32x32x32_bf16 v[64:79], v[100:103], v[32:39], v127
    s_add_u32 m0, s55, 0
    s_add_u32 s29, s54, 1605632
    buffer_load_dwordx4 v8, s[12:15], s29 offen  lds
    s_add_u32 m0, s55, 1024
    s_nop 0
    buffer_load_dwordx4 v8, s[16:19], s29 offen  lds
    v_exp_f32 v44, v44
    v_exp_f32 v45, v45
    v_exp_f32 v46, v46
    v_exp_f32 v47, v47
    s_waitcnt lgkmcnt(3)
    v_exp_f32 v48, v48
    v_exp_f32 v49, v49
    v_smfmac_f32_32x32x32_bf16 v[64:79], v[104:107], v[40:47], v127
    v_exp_f32 v50, v50
    v_exp_f32 v51, v51
    v_exp_f32 v52, v52
    v_exp_f32 v53, v53
    v_exp_f32 v54, v54
    v_mfma_f32_32x32x16_bf16 v[32:47], v[96:99], v[4:7], v[16:31]
    ds_read_b128 v[92:95], v126 offset:59392
    s_mov_b64 exec, s[34:35]
    ds_read_b128 v[100:103], v3 offset:58368
    ds_read_b128 v[104:107], v3 offset:58880
    s_mov_b64 exec, -1
    v_exp_f32 v55, v55
    v_exp_f32 v56, v56
    v_exp_f32 v57, v57
    v_exp_f32 v58, v58
    v_exp_f32 v59, v59
    v_smfmac_f32_32x32x32_bf16 v[64:79], v[108:111], v[48:55], v127
    v_exp_f32 v60, v60
    v_exp_f32 v61, v61
    v_exp_f32 v62, v62
    v_exp_f32 v63, v63
    s_setprio 0
    s_waitcnt lgkmcnt(3)
    v_exp_f32 v32, v32
    v_exp_f32 v33, v33
    v_smfmac_f32_32x32x32_bf16 v[64:79], v[112:115], v[56:63], v127
    v_exp_f32 v34, v34
    v_exp_f32 v35, v35
    s_setprio 1
    v_exp_f32 v36, v36
    v_exp_f32 v37, v37
    v_exp_f32 v38, v38
    v_mfma_f32_32x32x16_bf16 v[48:63], v[88:91], v[4:7], v[16:31]
    s_waitcnt vmcnt(2)
    ds_read_b64_tr_b16 v[232:233], v9 offset:2048
    ds_read_b64_tr_b16 v[234:235], v9 offset:2304
    ds_read_b64_tr_b16 v[236:237], v9 offset:2560
    ds_read_b64_tr_b16 v[238:239], v9 offset:2816
    ds_read_b128 v[96:99], v126 offset:60416
    s_mov_b64 exec, s[34:35]
    ds_read_b128 v[108:111], v3 offset:59392
    ds_read_b128 v[112:115], v3 offset:59904
    s_mov_b64 exec, -1
    v_exp_f32 v39, v39
    v_exp_f32 v40, v40
    v_exp_f32 v41, v41
    v_exp_f32 v42, v42
    v_exp_f32 v43, v43
    v_smfmac_f32_32x32x32_bf16 v[64:79], v[116:119], v[32:39], v127
    v_exp_f32 v44, v44
    v_exp_f32 v45, v45
    v_exp_f32 v46, v46
    v_exp_f32 v47, v47
    s_waitcnt lgkmcnt(3)
    v_exp_f32 v48, v48
    v_exp_f32 v49, v49
    v_smfmac_f32_32x32x32_bf16 v[64:79], v[120:123], v[40:47], v127
    v_exp_f32 v50, v50
    s_setprio 2
    v_exp_f32 v51, v51
    v_exp_f32 v52, v52
    v_exp_f32 v53, v53
    v_exp_f32 v54, v54
    v_mfma_f32_32x32x16_bf16 v[32:47], v[92:95], v[4:7], v[16:31]
    ds_read_b128 v[88:91], v126 offset:61440
    s_mov_b64 exec, s[34:35]
    ds_read_b128 v[116:119], v3 offset:60416
    ds_read_b128 v[120:123], v3 offset:60928
    s_mov_b64 exec, -1
    v_exp_f32 v55, v55
    v_exp_f32 v56, v56
    v_exp_f32 v57, v57
    v_exp_f32 v58, v58
    v_exp_f32 v59, v59
    v_smfmac_f32_32x32x32_bf16 v[64:79], v[100:103], v[48:55], v127
    s_add_u32 m0, s55, 2048
    s_add_u32 s29, s54, 1720320
    buffer_load_dwordx4 v8, s[12:15], s29 offen  lds
    s_add_u32 m0, s55, 3072
    s_nop 0
    buffer_load_dwordx4 v8, s[16:19], s29 offen  lds
    v_exp_f32 v60, v60
    v_exp_f32 v61, v61
    v_exp_f32 v62, v62
    v_exp_f32 v63, v63
    s_waitcnt lgkmcnt(3)
    v_exp_f32 v32, v32
    v_exp_f32 v33, v33
    v_smfmac_f32_32x32x32_bf16 v[64:79], v[104:107], v[56:63], v127
    v_exp_f32 v34, v34
    v_exp_f32 v35, v35
    v_exp_f32 v36, v36
    v_exp_f32 v37, v37
    v_exp_f32 v38, v38
    v_mfma_f32_32x32x16_bf16 v[48:63], v[96:99], v[4:7], v[16:31]
    ds_read_b128 v[92:95], v126 offset:62464
    s_mov_b64 exec, s[34:35]
    ds_read_b128 v[100:103], v3 offset:61440
    ds_read_b128 v[104:107], v3 offset:61952
    s_mov_b64 exec, -1
    v_exp_f32 v39, v39
    v_exp_f32 v40, v40
    v_exp_f32 v41, v41
    v_exp_f32 v42, v42
    v_exp_f32 v43, v43
    v_smfmac_f32_32x32x32_bf16 v[64:79], v[108:111], v[32:39], v127
    v_exp_f32 v44, v44
    v_exp_f32 v45, v45
    v_exp_f32 v46, v46
    v_exp_f32 v47, v47
    s_waitcnt lgkmcnt(3)
    v_exp_f32 v48, v48
    v_exp_f32 v49, v49
    v_smfmac_f32_32x32x32_bf16 v[64:79], v[112:115], v[40:47], v127
    v_exp_f32 v50, v50
    v_exp_f32 v51, v51
    v_exp_f32 v52, v52
    v_exp_f32 v53, v53
    v_exp_f32 v54, v54
    v_mfma_f32_32x32x16_bf16 v[32:47], v[88:91], v[4:7], v[16:31]
    s_waitcnt vmcnt(2)
    ds_read_b64_tr_b16 v[240:241], v9 offset:0
    ds_read_b64_tr_b16 v[242:243], v9 offset:256
    ds_read_b64_tr_b16 v[244:245], v9 offset:512
    ds_read_b64_tr_b16 v[246:247], v9 offset:768
    ds_read_b128 v[96:99], v126 offset:63488
    s_mov_b64 exec, s[34:35]
    ds_read_b128 v[108:111], v3 offset:62464
    ds_read_b128 v[112:115], v3 offset:62976
    s_mov_b64 exec, -1
    v_exp_f32 v55, v55
    v_exp_f32 v56, v56
    v_exp_f32 v57, v57
    v_exp_f32 v58, v58
    v_exp_f32 v59, v59
    v_smfmac_f32_32x32x32_bf16 v[64:79], v[116:119], v[48:55], v127
    s_lshr_b32 s29, s2, 3
    s_lshl_b32 s29, s29, 14
    s_lshl_b32 s31, s22, 11
    s_add_u32 s29, s29, s31
    s_mov_b32 s96, s44
    s_mov_b32 s97, s45
    s_mov_b32 s98, 0x80000
    s_mov_b32 s99, 0x00020000
    v_and_b32 v12, 15, v0
    v_lshlrev_b32 v12, 7, v12
    buffer_load_dword v124, v12, s[96:99], s29 offen
    v_exp_f32 v60, v60
    v_exp_f32 v61, v61
    v_exp_f32 v62, v62
    v_exp_f32 v63, v63
    s_setprio 0
    s_waitcnt lgkmcnt(3)
    v_exp_f32 v32, v32
    v_exp_f32 v33, v33
    v_smfmac_f32_32x32x32_bf16 v[64:79], v[120:123], v[56:63], v127
    v_exp_f32 v34, v34
    v_exp_f32 v35, v35
    s_setprio 1
    v_exp_f32 v36, v36
    v_exp_f32 v37, v37
    v_exp_f32 v38, v38
    v_mfma_f32_32x32x16_bf16 v[48:63], v[92:95], v[4:7], v[16:31]
    ds_read_b128 v[88:91], v126 offset:64512
    s_mov_b64 exec, s[34:35]
    ds_read_b128 v[116:119], v3 offset:63488
    ds_read_b128 v[120:123], v3 offset:64000
    s_mov_b64 exec, -1
    v_exp_f32 v39, v39
    v_exp_f32 v40, v40
    v_exp_f32 v41, v41
    v_exp_f32 v42, v42
    v_exp_f32 v43, v43
    v_smfmac_f32_32x32x32_bf16 v[64:79], v[100:103], v[32:39], v127
    v_exp_f32 v44, v44
    v_exp_f32 v45, v45
    v_exp_f32 v46, v46
    v_exp_f32 v47, v47
    s_waitcnt lgkmcnt(3)
    v_exp_f32 v48, v48
    v_exp_f32 v49, v49
    v_smfmac_f32_32x32x32_bf16 v[64:79], v[104:107], v[40:47], v127
    v_exp_f32 v50, v50
    s_setprio 2
    v_exp_f32 v51, v51
    v_exp_f32 v52, v52
    v_exp_f32 v53, v53
    v_exp_f32 v54, v54
    v_mfma_f32_32x32x16_bf16 v[32:47], v[96:99], v[4:7], v[16:31]
    s_mov_b64 exec, s[34:35]
    ds_read_b128 v[100:103], v3 offset:64512
    ds_read_b128 v[104:107], v3 offset:65024
    s_mov_b64 exec, -1
    v_exp_f32 v55, v55
    v_exp_f32 v56, v56
    v_exp_f32 v57, v57
    v_exp_f32 v58, v58
    v_exp_f32 v59, v59
    v_smfmac_f32_32x32x32_bf16 v[64:79], v[108:111], v[48:55], v127
    v_exp_f32 v60, v60
    v_exp_f32 v61, v61
    v_exp_f32 v62, v62
    v_exp_f32 v63, v63
    s_waitcnt lgkmcnt(2)
    v_exp_f32 v32, v32
    v_exp_f32 v33, v33
    v_smfmac_f32_32x32x32_bf16 v[64:79], v[112:115], v[56:63], v127
    v_exp_f32 v34, v34
    v_exp_f32 v35, v35
    v_exp_f32 v36, v36
    v_exp_f32 v37, v37
    v_exp_f32 v38, v38
    v_mfma_f32_32x32x16_bf16 v[48:63], v[88:91], v[4:7], v[16:31]
    s_nop 3
    s_waitcnt vmcnt(1)
    ds_read_b64_tr_b16 v[248:249], v9 offset:2048
    ds_read_b64_tr_b16 v[250:251], v9 offset:2304
    ds_read_b64_tr_b16 v[252:253], v9 offset:2560
    ds_read_b64_tr_b16 v[254:255], v9 offset:2816
    v_exp_f32 v39, v39
    v_exp_f32 v40, v40
    v_exp_f32 v41, v41
    v_exp_f32 v42, v42
    v_exp_f32 v43, v43
    v_smfmac_f32_32x32x32_bf16 v[64:79], v[116:119], v[32:39], v127
    v_exp_f32 v44, v44
    v_exp_f32 v45, v45
    v_exp_f32 v46, v46
    v_exp_f32 v47, v47
    s_waitcnt lgkmcnt(0)
    v_exp_f32 v48, v48
    v_exp_f32 v49, v49
    v_smfmac_f32_32x32x32_bf16 v[64:79], v[120:123], v[40:47], v127
    v_exp_f32 v50, v50
    v_exp_f32 v51, v51
    v_exp_f32 v52, v52
    v_exp_f32 v53, v53
    v_exp_f32 v54, v54
    v_exp_f32 v55, v55
    v_exp_f32 v56, v56
    v_exp_f32 v57, v57
    v_exp_f32 v58, v58
    v_exp_f32 v59, v59
    v_smfmac_f32_32x32x32_bf16 v[64:79], v[100:103], v[48:55], v127
    v_exp_f32 v60, v60
    v_exp_f32 v61, v61
    v_exp_f32 v62, v62
    v_exp_f32 v63, v63
    s_setprio 0
    s_lshl_b32 s29, s24, 3
    s_add_u32 s29, s29, s22
    v_smfmac_f32_32x32x32_bf16 v[64:79], v[104:107], v[56:63], v127
    s_nop 7
    s_lshl_b32 s31, s24, 8
    s_lshl_b32 s30, s23, 2
    s_add_u32 s31, s31, s30
    s_add_u32 s31, s31, 11534336
    s_lshl_b32 s29, s29, 15
    s_lshl_b32 s30, s23, 10
    s_add_u32 s29, s29, s30
    s_add_u32 s29, s29, 6291456
    v_mov_b32 v12, 0
    v_mov_b32 v13, 1
    s_waitcnt lgkmcnt(0)
    s_nop 0
    v_cmp_gt_f32 vcc, s50, v72
    s_nop 1
    s_cmp_eq_u64 vcc, -1
    s_cbranch_scc0 K2_FALLBACK
K2_FIN:
    v_rcp_f32 v14, v72
    s_nop 0
    v_mul_f32 v64, v14, v64
    v_mul_f32 v65, v14, v65
    v_mul_f32 v66, v14, v66
    v_mul_f32 v67, v14, v67
    v_mul_f32 v68, v14, v68
    v_mul_f32 v69, v14, v69
    v_mul_f32 v70, v14, v70
    v_mul_f32 v71, v14, v71
    v_cvt_pk_bf16_f32 v80, v64, v65
    v_cvt_pk_bf16_f32 v81, v66, v67
    v_cvt_pk_bf16_f32 v82, v68, v69
    v_cvt_pk_bf16_f32 v83, v70, v71
    buffer_store_dwordx4 v[80:83], v2, s[8:11], s29 offen sc1
    s_mov_b32 s12, s44
    s_mov_b32 s13, s45
    s_mov_b32 s14, 0x80000
    s_mov_b32 s15, 0x00020000
    s_mov_b32 s16, s46
    s_mov_b32 s17, s47
    s_mov_b32 s18, 0x200000
    s_mov_b32 s19, 0x00020000
    s_and_b32 s25, s22, 1
    s_bfe_u32 s26, s22, 0x10001
    s_lshr_b32 s27, s22, 2
    s_lshl_b32 s28, s24, 1
    s_add_u32 s28, s28, s25
    s_lshl_b32 s30, s23, 1
    s_add_u32 s30, s30, s26
    v_bfe_u32 v8, v0, 2, 3
    v_lshlrev_b32 v8, 10, v8
    v_lshl_add_u32 v8, v11, 6, v8
    v_and_b32 v1, 3, v0
    v_lshl_add_u32 v8, v1, 4, v8
    v_lshlrev_b32 v9, 6, v10
    v_lshl_add_u32 v9, v1, 3, v9
    v_bfe_u32 v1, v0, 4, 1
    v_lshl_add_u32 v9, v1, 5, v9
    s_lshl_b32 s32, s25, 9
    s_lshl_b32 s33, s27, 15
    s_add_u32 s32, s32, s33
    v_add_u32 v9, s32, v9
    v_and_b32 v3, 31, v0
    v_lshlrev_b32 v3, 10, v3
    v_lshl_add_u32 v3, v11, 4, v3
    s_lshl_b32 s51, s30, 15
    s_lshl_b32 s33, s28, 6
    s_add_u32 s51, s51, s33
    s_waitcnt vmcnt(0)
    s_barrier
    s_cmp_eq_u32 s22, 7
    s_cbranch_scc0 K2_S2
    v_lshlrev_b32 v12, 14, v0
    s_mov_b64 exec, 1
    s_and_b32 s31, s31, 0xffffff80
    buffer_atomic_add v13, v12, s[8:11], s31 offen sc1
    s_mov_b64 exec, -1
K2_S2:
    s_cmp_eq_u32 s22, 7
    s_cbranch_scc1 K2_POLL2
    s_cmp_ge_u32 s22, 4
    s_cbranch_scc1 K2_CS
    s_lshl_b32 s52, s22, 14
    s_lshl_b32 s53, s22, 17
    s_lshl_b32 s33, s24, 7
    s_add_u32 s53, s53, s33
    s_add_u32 m0, s52, 0
    s_add_u32 s29, s53, 0
    buffer_load_dwordx4 v8, s[12:15], s29 offen lds
    s_add_u32 m0, s52, 1024
    s_add_u32 s29, s53, 8192
    buffer_load_dwordx4 v8, s[12:15], s29 offen lds
    s_add_u32 m0, s52, 2048
    s_add_u32 s29, s53, 16384
    buffer_load_dwordx4 v8, s[12:15], s29 offen lds
    s_add_u32 m0, s52, 3072
    s_add_u32 s29, s53, 24576
    buffer_load_dwordx4 v8, s[12:15], s29 offen lds
    s_add_u32 m0, s52, 4096
    s_add_u32 s29, s53, 32768
    buffer_load_dwordx4 v8, s[12:15], s29 offen lds
    s_add_u32 m0, s52, 5120
    s_add_u32 s29, s53, 40960
    buffer_load_dwordx4 v8, s[12:15], s29 offen lds
    s_add_u32 m0, s52, 6144
    s_add_u32 s29, s53, 49152
    buffer_load_dwordx4 v8, s[12:15], s29 offen lds
    s_add_u32 m0, s52, 7168
    s_add_u32 s29, s53, 57344
    buffer_load_dwordx4 v8, s[12:15], s29 offen lds
    s_add_u32 m0, s52, 8192
    s_add_u32 s29, s53, 65536
    buffer_load_dwordx4 v8, s[12:15], s29 offen lds
    s_add_u32 m0, s52, 9216
    s_add_u32 s29, s53, 73728
    buffer_load_dwordx4 v8, s[12:15], s29 offen lds
    s_add_u32 m0, s52, 10240
    s_add_u32 s29, s53, 81920
    buffer_load_dwordx4 v8, s[12:15], s29 offen lds
    s_add_u32 m0, s52, 11264
    s_add_u32 s29, s53, 90112
    buffer_load_dwordx4 v8, s[12:15], s29 offen lds
    s_add_u32 m0, s52, 12288
    s_add_u32 s29, s53, 98304
    buffer_load_dwordx4 v8, s[12:15], s29 offen lds
    s_add_u32 m0, s52, 13312
    s_add_u32 s29, s53, 106496
    buffer_load_dwordx4 v8, s[12:15], s29 offen lds
    s_add_u32 m0, s52, 14336
    s_add_u32 s29, s53, 114688
    buffer_load_dwordx4 v8, s[12:15], s29 offen lds
    s_add_u32 m0, s52, 15360
    s_add_u32 s29, s53, 122880
    buffer_load_dwordx4 v8, s[12:15], s29 offen lds
    buffer_load_dwordx4 v[112:115], v3, s[16:19], s51 offen offset:0
    buffer_load_dwordx4 v[116:119], v3, s[16:19], s51 offen offset:32
    s_waitcnt vmcnt(2)
    s_branch K2_B2
K2_CS:
    s_mov_b32 s56, 0x3f803f80
    v_mov_b32 v124, 0
    v_mov_b32 v125, 0
    v_mov_b32 v126, 0
    v_mov_b32 v127, 0
    v_dot2c_f32_bf16 v124, s56, v128
    v_dot2c_f32_bf16 v125, s56, v129
    v_dot2c_f32_bf16 v126, s56, v130
    v_dot2c_f32_bf16 v127, s56, v131
    v_dot2c_f32_bf16 v124, s56, v132
    v_dot2c_f32_bf16 v125, s56, v133
    v_dot2c_f32_bf16 v126, s56, v134
    v_dot2c_f32_bf16 v127, s56, v135
    v_dot2c_f32_bf16 v124, s56, v136
    v_dot2c_f32_bf16 v125, s56, v137
    v_dot2c_f32_bf16 v126, s56, v138
    v_dot2c_f32_bf16 v127, s56, v139
    v_dot2c_f32_bf16 v124, s56, v140
    v_dot2c_f32_bf16 v125, s56, v141
    v_dot2c_f32_bf16 v126, s56, v142
    v_dot2c_f32_bf16 v127, s56, v143
    v_dot2c_f32_bf16 v124, s56, v144
    v_dot2c_f32_bf16 v125, s56, v145
    v_dot2c_f32_bf16 v126, s56, v146
    v_dot2c_f32_bf16 v127, s56, v147
    v_dot2c_f32_bf16 v124, s56, v148
    v_dot2c_f32_bf16 v125, s56, v149
    v_dot2c_f32_bf16 v126, s56, v150
    v_dot2c_f32_bf16 v127, s56, v151
    v_dot2c_f32_bf16 v124, s56, v152
    v_dot2c_f32_bf16 v125, s56, v153
    v_dot2c_f32_bf16 v126, s56, v154
    v_dot2c_f32_bf16 v127, s56, v155
    v_dot2c_f32_bf16 v124, s56, v156
    v_dot2c_f32_bf16 v125, s56, v157
    v_dot2c_f32_bf16 v126, s56, v158
    v_dot2c_f32_bf16 v127, s56, v159
    v_dot2c_f32_bf16 v124, s56, v160
    v_dot2c_f32_bf16 v125, s56, v161
    v_dot2c_f32_bf16 v126, s56, v162
    v_dot2c_f32_bf16 v127, s56, v163
    v_dot2c_f32_bf16 v124, s56, v164
    v_dot2c_f32_bf16 v125, s56, v165
    v_dot2c_f32_bf16 v126, s56, v166
    v_dot2c_f32_bf16 v127, s56, v167
    v_dot2c_f32_bf16 v124, s56, v168
    v_dot2c_f32_bf16 v125, s56, v169
    v_dot2c_f32_bf16 v126, s56, v170
    v_dot2c_f32_bf16 v127, s56, v171
    v_dot2c_f32_bf16 v124, s56, v172
    v_dot2c_f32_bf16 v125, s56, v173
    v_dot2c_f32_bf16 v126, s56, v174
    v_dot2c_f32_bf16 v127, s56, v175
    v_dot2c_f32_bf16 v124, s56, v176
    v_dot2c_f32_bf16 v125, s56, v177
    v_dot2c_f32_bf16 v126, s56, v178
    v_dot2c_f32_bf16 v127, s56, v179
    v_dot2c_f32_bf16 v124, s56, v180
    v_dot2c_f32_bf16 v125, s56, v181
    v_dot2c_f32_bf16 v126, s56, v182
    v_dot2c_f32_bf16 v127, s56, v183
    v_dot2c_f32_bf16 v124, s56, v184
    v_dot2c_f32_bf16 v125, s56, v185
    v_dot2c_f32_bf16 v126, s56, v186
    v_dot2c_f32_bf16 v127, s56, v187
    v_dot2c_f32_bf16 v124, s56, v188
    v_dot2c_f32_bf16 v125, s56, v189
    v_dot2c_f32_bf16 v126, s56, v190
    v_dot2c_f32_bf16 v127, s56, v191
    v_dot2c_f32_bf16 v124, s56, v192
    v_dot2c_f32_bf16 v125, s56, v193
    v_dot2c_f32_bf16 v126, s56, v194
    v_dot2c_f32_bf16 v127, s56, v195
    v_dot2c_f32_bf16 v124, s56, v196
    v_dot2c_f32_bf16 v125, s56, v197
    v_dot2c_f32_bf16 v126, s56, v198
    v_dot2c_f32_bf16 v127, s56, v199
    v_dot2c_f32_bf16 v124, s56, v200
    v_dot2c_f32_bf16 v125, s56, v201
    v_dot2c_f32_bf16 v126, s56, v202
    v_dot2c_f32_bf16 v127, s56, v203
    v_dot2c_f32_bf16 v124, s56, v204
    v_dot2c_f32_bf16 v125, s56, v205
    v_dot2c_f32_bf16 v126, s56, v206
    v_dot2c_f32_bf16 v127, s56, v207
    v_dot2c_f32_bf16 v124, s56, v208
    v_dot2c_f32_bf16 v125, s56, v209
    v_dot2c_f32_bf16 v126, s56, v210
    v_dot2c_f32_bf16 v127, s56, v211
    v_dot2c_f32_bf16 v124, s56, v212
    v_dot2c_f32_bf16 v125, s56, v213
    v_dot2c_f32_bf16 v126, s56, v214
    v_dot2c_f32_bf16 v127, s56, v215
    v_dot2c_f32_bf16 v124, s56, v216
    v_dot2c_f32_bf16 v125, s56, v217
    v_dot2c_f32_bf16 v126, s56, v218
    v_dot2c_f32_bf16 v127, s56, v219
    v_dot2c_f32_bf16 v124, s56, v220
    v_dot2c_f32_bf16 v125, s56, v221
    v_dot2c_f32_bf16 v126, s56, v222
    v_dot2c_f32_bf16 v127, s56, v223
    v_dot2c_f32_bf16 v124, s56, v224
    v_dot2c_f32_bf16 v125, s56, v225
    v_dot2c_f32_bf16 v126, s56, v226
    v_dot2c_f32_bf16 v127, s56, v227
    v_dot2c_f32_bf16 v124, s56, v228
    v_dot2c_f32_bf16 v125, s56, v229
    v_dot2c_f32_bf16 v126, s56, v230
    v_dot2c_f32_bf16 v127, s56, v231
    v_dot2c_f32_bf16 v124, s56, v232
    v_dot2c_f32_bf16 v125, s56, v233
    v_dot2c_f32_bf16 v126, s56, v234
    v_dot2c_f32_bf16 v127, s56, v235
    v_dot2c_f32_bf16 v124, s56, v236
    v_dot2c_f32_bf16 v125, s56, v237
    v_dot2c_f32_bf16 v126, s56, v238
    v_dot2c_f32_bf16 v127, s56, v239
    v_dot2c_f32_bf16 v124, s56, v240
    v_dot2c_f32_bf16 v125, s56, v241
    v_dot2c_f32_bf16 v126, s56, v242
    v_dot2c_f32_bf16 v127, s56, v243
    v_dot2c_f32_bf16 v124, s56, v244
    v_dot2c_f32_bf16 v125, s56, v245
    v_dot2c_f32_bf16 v126, s56, v246
    v_dot2c_f32_bf16 v127, s56, v247
    v_dot2c_f32_bf16 v124, s56, v248
    v_dot2c_f32_bf16 v125, s56, v249
    v_dot2c_f32_bf16 v126, s56, v250
    v_dot2c_f32_bf16 v127, s56, v251
    v_dot2c_f32_bf16 v124, s56, v252
    v_dot2c_f32_bf16 v125, s56, v253
    v_dot2c_f32_bf16 v126, s56, v254
    v_dot2c_f32_bf16 v127, s56, v255
    s_nop 2
    v_add_f32 v124, v124, v125
    v_add_f32 v126, v126, v127
    v_add_f32 v126, v124, v126
    v_cvt_pk_bf16_f32 v124, v126, v126
    v_lshlrev_b32 v125, 16, v124
    v_sub_f32 v125, v126, v125
    v_cvt_pk_bf16_f32 v125, v125, v125
    v_mov_b32 v126, 0
    v_mov_b32 v127, 0
    s_branch K2_B2
K2_POLL2:
    s_lshr_b32 s29, s23, 2
    s_lshl_b32 s29, s29, 8
    s_add_u32 s29, s29, 11534336
    s_lshr_b32 s33, s2, 5
    s_and_b32 s33, s33, 0
    s_lshl_b32 s33, s33, 14
    v_mov_b32 v1, s33
    s_mov_b32 s33, 0
    s_mov_b64 exec, 1
K2_P2:
    v_mov_b32 v15, 0
    buffer_atomic_add v15, v1, s[8:11], s29 offen sc0 sc1
    s_add_u32 s33, s33, 1
    s_waitcnt vmcnt(0)
    v_cmp_eq_u32 vcc, 32, v15
    s_nop 0
    s_cbranch_vccnz K2_P2_X
    s_cmp_lt_u32 s33, 0x40000
    s_cbranch_scc1 K2_P2
K2_P2_X:
    s_mov_b64 exec, -1
K2_B2:
    s_lshl_b32 s29, s25, 15
    s_lshr_b32 s33, s22, 1
    s_lshl_b32 s33, s33, 12
    s_add_u32 s29, s29, s33
    s_lshl_b32 s33, s23, 16
    s_add_u32 s33, s33, s29
    s_add_u32 s33, s33, 6291456
    s_add_u32 s52, s33, 16384
    s_add_u32 m0, s29, 81920
    s_barrier
    buffer_load_dwordx4 v2, s[8:11], s52 offen offset:0 sc1 lds
    buffer_load_dwordx4 v2, s[8:11], s52 offen offset:1024 sc1 lds
    buffer_load_dwordx4 v2, s[8:11], s52 offen offset:2048 sc1 lds
    buffer_load_dwordx4 v2, s[8:11], s52 offen offset:3072 sc1 lds
    s_add_u32 m0, s29, 65536
    s_nop 0
    buffer_load_dwordx4 v2, s[8:11], s33 offen offset:0 sc1 lds
    buffer_load_dwordx4 v2, s[8:11], s33 offen offset:1024 sc1 lds
    buffer_load_dwordx4 v2, s[8:11], s33 offen offset:2048 sc1 lds
    buffer_load_dwordx4 v2, s[8:11], s33 offen offset:3072 sc1 lds
    ds_read_b64_tr_b16 v[32:33], v9 offset:0
    ds_read_b64_tr_b16 v[34:35], v9 offset:1024
    ds_read_b64_tr_b16 v[36:37], v9 offset:2048
    ds_read_b64_tr_b16 v[38:39], v9 offset:3072
    ds_read_b64_tr_b16 v[40:41], v9 offset:4096
    ds_read_b64_tr_b16 v[42:43], v9 offset:5120
    ds_read_b64_tr_b16 v[44:45], v9 offset:6144
    ds_read_b64_tr_b16 v[46:47], v9 offset:7168
    ds_read_b64_tr_b16 v[48:49], v9 offset:8192
    ds_read_b64_tr_b16 v[50:51], v9 offset:9216
    ds_read_b64_tr_b16 v[52:53], v9 offset:10240
    ds_read_b64_tr_b16 v[54:55], v9 offset:11264
    ds_read_b64_tr_b16 v[56:57], v9 offset:12288
    ds_read_b64_tr_b16 v[58:59], v9 offset:13312
    ds_read_b64_tr_b16 v[60:61], v9 offset:14336
    ds_read_b64_tr_b16 v[62:63], v9 offset:15360
    ds_read_b64_tr_b16 v[64:65], v9 offset:16384
    ds_read_b64_tr_b16 v[66:67], v9 offset:17408
    ds_read_b64_tr_b16 v[68:69], v9 offset:18432
    ds_read_b64_tr_b16 v[70:71], v9 offset:19456
    ds_read_b64_tr_b16 v[72:73], v9 offset:20480
    ds_read_b64_tr_b16 v[74:75], v9 offset:21504
    ds_read_b64_tr_b16 v[76:77], v9 offset:22528
    ds_read_b64_tr_b16 v[78:79], v9 offset:23552
    ds_read_b64_tr_b16 v[80:81], v9 offset:24576
    ds_read_b64_tr_b16 v[82:83], v9 offset:25600
    ds_read_b64_tr_b16 v[84:85], v9 offset:26624
    ds_read_b64_tr_b16 v[86:87], v9 offset:27648
    ds_read_b64_tr_b16 v[88:89], v9 offset:28672
    ds_read_b64_tr_b16 v[90:91], v9 offset:29696
    ds_read_b64_tr_b16 v[92:93], v9 offset:30720
    ds_read_b64_tr_b16 v[94:95], v9 offset:31744
    s_lshl_b32 s29, s26, 15
    s_lshl_b32 s33, s27, 14
    s_add_u32 s29, s29, s33
    s_add_u32 s29, s29, 65536
    v_add_u32 v8, s29, v2
    s_and_b32 s29, s22, 3
    s_lshl_b32 s29, s29, 12
    s_add_u32 s29, s29, 131072
    v_add_u32 v9, s29, v2
    s_cmp_lt_u32 s22, 4
    s_cbranch_scc1 K2_O_LO
    s_waitcnt vmcnt(4) lgkmcnt(0)
    s_barrier
    ds_read_b128 v[96:99], v8 offset:0
    ds_read_b128 v[100:103], v8 offset:1024
    ds_read_b128 v[104:107], v8 offset:2048
    ds_read_b128 v[108:111], v8 offset:3072
    s_waitcnt lgkmcnt(3)
    v_mfma_f32_32x32x16_bf16 v[16:31], v[32:35], v[96:99], 0
    ds_read_b128 v[96:99], v8 offset:4096
    s_waitcnt lgkmcnt(3)
    v_mfma_f32_32x32x16_bf16 v[16:31], v[36:39], v[100:103], v[16:31]
    ds_read_b128 v[100:103], v8 offset:5120
    s_waitcnt lgkmcnt(3)
    v_mfma_f32_32x32x16_bf16 v[16:31], v[40:43], v[104:107], v[16:31]
    ds_read_b128 v[104:107], v8 offset:6144
    s_waitcnt lgkmcnt(3)
    v_mfma_f32_32x32x16_bf16 v[16:31], v[44:47], v[108:111], v[16:31]
    ds_read_b128 v[108:111], v8 offset:7168
    s_waitcnt lgkmcnt(3)
    v_mfma_f32_32x32x16_bf16 v[16:31], v[48:51], v[96:99], v[16:31]
    ds_read_b128 v[96:99], v8 offset:8192
    s_waitcnt lgkmcnt(3)
    v_mfma_f32_32x32x16_bf16 v[16:31], v[52:55], v[100:103], v[16:31]
    ds_read_b128 v[100:103], v8 offset:9216
    s_waitcnt lgkmcnt(3)
    v_mfma_f32_32x32x16_bf16 v[16:31], v[56:59], v[104:107], v[16:31]
    ds_read_b128 v[104:107], v8 offset:10240
    s_waitcnt lgkmcnt(3)
    v_mfma_f32_32x32x16_bf16 v[16:31], v[60:63], v[108:111], v[16:31]
    ds_read_b128 v[108:111], v8 offset:11264
    s_waitcnt lgkmcnt(3)
    v_mfma_f32_32x32x16_bf16 v[16:31], v[64:67], v[96:99], v[16:31]
    ds_read_b128 v[96:99], v8 offset:12288
    s_waitcnt lgkmcnt(3)
    v_mfma_f32_32x32x16_bf16 v[16:31], v[68:71], v[100:103], v[16:31]
    ds_read_b128 v[100:103], v8 offset:13312
    s_waitcnt lgkmcnt(3)
    v_mfma_f32_32x32x16_bf16 v[16:31], v[72:75], v[104:107], v[16:31]
    s_waitcnt vmcnt(0)
    s_barrier
    ds_read_b128 v[104:107], v8 offset:14336
    s_waitcnt lgkmcnt(3)
    v_mfma_f32_32x32x16_bf16 v[16:31], v[76:79], v[108:111], v[16:31]
    ds_read_b128 v[108:111], v8 offset:15360
    s_waitcnt lgkmcnt(3)
    v_mfma_f32_32x32x16_bf16 v[16:31], v[80:83], v[96:99], v[16:31]
    s_waitcnt lgkmcnt(2)
    v_mfma_f32_32x32x16_bf16 v[16:31], v[84:87], v[100:103], v[16:31]
    s_waitcnt lgkmcnt(1)
    v_mfma_f32_32x32x16_bf16 v[16:31], v[88:91], v[104:107], v[16:31]
    s_waitcnt lgkmcnt(0)
    v_mfma_f32_32x32x16_bf16 v[16:31], v[92:95], v[108:111], v[16:31]
    s_nop 11
    ds_write_b128 v9, v[16:19] offset:0
    ds_write_b128 v9, v[20:23] offset:1024
    ds_write_b128 v9, v[24:27] offset:2048
    ds_write_b128 v9, v[28:31] offset:3072
    s_waitcnt lgkmcnt(0)
    s_barrier
    s_lshr_b32 s31, s23, 1
    s_lshl_b32 s31, s31, 8
    s_and_b32 s33, s23, 1
    s_lshl_b32 s33, s33, 3
    s_add_u32 s33, s33, s24
    s_lshl_b32 s33, s33, 2
    s_add_u32 s31, s31, s33
    s_add_u32 s31, s31, 11536384
    s_lshl_b32 s29, s36, 8
    s_add_u32 s29, s29, 11536384
    s_barrier
    s_cmp_eq_u32 s22, 7
    s_cbranch_scc0 K2_S3
    v_lshlrev_b32 v12, 14, v0
    s_mov_b64 exec, 1
    s_and_b32 s31, s31, 0xffffff80
    buffer_atomic_add v13, v12, s[8:11], s31 offen sc1
    s_mov_b64 exec, -1
K2_S3:
    s_cmp_eq_u32 s22, 7
    s_cbranch_scc0 K2_B3
    s_lshr_b32 s33, s2, 5
    s_and_b32 s33, s33, 0
    s_lshl_b32 s33, s33, 14
    v_mov_b32 v1, s33
    s_mov_b32 s33, 0
    s_mov_b64 exec, 1
K2_P3:
    v_mov_b32 v15, 0
    buffer_atomic_add v15, v1, s[8:11], s29 offen sc0 sc1
    s_add_u32 s33, s33, 1
    s_waitcnt vmcnt(0)
    v_cmp_eq_u32 vcc, 16, v15
    s_nop 0
    s_cbranch_vccnz K2_P3_X
    s_cmp_lt_u32 s33, 0x40000
    s_cbranch_scc1 K2_P3
K2_P3_X:
    s_mov_b64 exec, -1
    s_branch K2_B3
K2_O_LO:
    s_waitcnt vmcnt(8)
    v_permlane32_swap_b32 v112, v114
    v_permlane32_swap_b32 v113, v115
    v_permlane32_swap_b32 v116, v118
    v_permlane32_swap_b32 v117, v119
    s_mov_b32 s29, 0xffff0000
    v_lshlrev_b32 v16, 16, v112
    v_and_b32 v17, s29, v112
    v_lshlrev_b32 v18, 16, v113
    v_and_b32 v19, s29, v113
    v_lshlrev_b32 v20, 16, v114
    v_and_b32 v21, s29, v114
    v_lshlrev_b32 v22, 16, v115
    v_and_b32 v23, s29, v115
    v_lshlrev_b32 v24, 16, v116
    v_and_b32 v25, s29, v116
    v_lshlrev_b32 v26, 16, v117
    v_and_b32 v27, s29, v117
    v_lshlrev_b32 v28, 16, v118
    v_and_b32 v29, s29, v118
    v_lshlrev_b32 v30, 16, v119
    v_and_b32 v31, s29, v119
    s_lshl_b32 s52, s30, 15
    s_lshl_b32 s33, s28, 11
    s_add_u32 s52, s52, s33
    s_add_u32 s52, s52, 8388608
    s_lshl_b32 s53, s30, 12
    s_lshl_b32 s33, s28, 8
    s_add_u32 s53, s53, s33
    s_add_u32 s53, s53, 10485760
    v_lshlrev_b32 v3, 3, v0
    s_mov_b32 s29, 0x3f803f80
    v_mov_b32 v14, 0
    v_mov_b32 v15, 0
    s_waitcnt vmcnt(4) lgkmcnt(0)
    s_barrier
    s_waitcnt vmcnt(0)
    s_barrier
    ds_read_b128 v[96:99], v8 offset:0
    ds_read_b128 v[100:103], v8 offset:1024
    ds_read_b128 v[104:107], v8 offset:2048
    ds_read_b128 v[108:111], v8 offset:3072
    s_waitcnt lgkmcnt(3)
    v_mfma_f32_32x32x16_bf16 v[16:31], v[32:35], v[96:99], v[16:31]
    ds_read_b128 v[96:99], v8 offset:4096
    s_waitcnt lgkmcnt(3)
    v_mfma_f32_32x32x16_bf16 v[16:31], v[36:39], v[100:103], v[16:31]
    ds_read_b128 v[100:103], v8 offset:5120
    s_waitcnt lgkmcnt(3)
    v_mfma_f32_32x32x16_bf16 v[16:31], v[40:43], v[104:107], v[16:31]
    ds_read_b128 v[104:107], v8 offset:6144
    s_waitcnt lgkmcnt(3)
    v_mfma_f32_32x32x16_bf16 v[16:31], v[44:47], v[108:111], v[16:31]
    ds_read_b128 v[108:111], v8 offset:7168
    s_waitcnt lgkmcnt(3)
    v_mfma_f32_32x32x16_bf16 v[16:31], v[48:51], v[96:99], v[16:31]
    ds_read_b128 v[96:99], v8 offset:8192
    s_waitcnt lgkmcnt(3)
    v_mfma_f32_32x32x16_bf16 v[16:31], v[52:55], v[100:103], v[16:31]
    ds_read_b128 v[100:103], v8 offset:9216
    s_waitcnt lgkmcnt(3)
    v_mfma_f32_32x32x16_bf16 v[16:31], v[56:59], v[104:107], v[16:31]
    ds_read_b128 v[104:107], v8 offset:10240
    s_waitcnt lgkmcnt(3)
    v_mfma_f32_32x32x16_bf16 v[16:31], v[60:63], v[108:111], v[16:31]
    ds_read_b128 v[108:111], v8 offset:11264
    s_waitcnt lgkmcnt(3)
    v_mfma_f32_32x32x16_bf16 v[16:31], v[64:67], v[96:99], v[16:31]
    ds_read_b128 v[96:99], v8 offset:12288
    s_waitcnt lgkmcnt(3)
    v_mfma_f32_32x32x16_bf16 v[16:31], v[68:71], v[100:103], v[16:31]
    ds_read_b128 v[100:103], v8 offset:13312
    s_waitcnt lgkmcnt(3)
    v_mfma_f32_32x32x16_bf16 v[16:31], v[72:75], v[104:107], v[16:31]
    ds_read_b128 v[104:107], v8 offset:14336
    s_waitcnt lgkmcnt(3)
    v_mfma_f32_32x32x16_bf16 v[16:31], v[76:79], v[108:111], v[16:31]
    ds_read_b128 v[108:111], v8 offset:15360
    s_waitcnt lgkmcnt(3)
    v_mfma_f32_32x32x16_bf16 v[16:31], v[80:83], v[96:99], v[16:31]
    s_waitcnt lgkmcnt(2)
    v_mfma_f32_32x32x16_bf16 v[16:31], v[84:87], v[100:103], v[16:31]
    s_barrier
    ds_read_b128 v[32:35], v9 offset:0
    ds_read_b128 v[36:39], v9 offset:1024
    ds_read_b128 v[40:43], v9 offset:2048
    ds_read_b128 v[44:47], v9 offset:3072
    s_waitcnt lgkmcnt(5)
    v_mfma_f32_32x32x16_bf16 v[16:31], v[88:91], v[104:107], v[16:31]
    s_waitcnt lgkmcnt(4)
    v_mfma_f32_32x32x16_bf16 v[16:31], v[92:95], v[108:111], v[16:31]
    s_nop 10
    s_waitcnt lgkmcnt(3)
    v_add_f32 v16, v16, v32
    v_add_f32 v17, v17, v33
    v_add_f32 v18, v18, v34
    v_add_f32 v19, v19, v35
    v_cvt_pk_bf16_f32 v112, v16, v17
    v_cvt_pk_bf16_f32 v113, v18, v19
    s_waitcnt lgkmcnt(2)
    v_add_f32 v20, v20, v36
    v_add_f32 v21, v21, v37
    v_add_f32 v22, v22, v38
    v_add_f32 v23, v23, v39
    v_cvt_pk_bf16_f32 v114, v20, v21
    v_cvt_pk_bf16_f32 v115, v22, v23
    buffer_store_dwordx4 v[112:115], v2, s[8:11], s52 offen offset:0 sc1
    s_waitcnt lgkmcnt(1)
    v_add_f32 v24, v24, v40
    v_add_f32 v25, v25, v41
    v_add_f32 v26, v26, v42
    v_add_f32 v27, v27, v43
    v_cvt_pk_bf16_f32 v116, v24, v25
    v_cvt_pk_bf16_f32 v117, v26, v27
    s_waitcnt lgkmcnt(0)
    v_add_f32 v28, v28, v44
    v_add_f32 v29, v29, v45
    v_add_f32 v30, v30, v46
    v_add_f32 v31, v31, v47
    v_cvt_pk_bf16_f32 v118, v28, v29
    v_cvt_pk_bf16_f32 v119, v30, v31
    buffer_store_dwordx4 v[116:119], v2, s[8:11], s52 offen offset:1024 sc1
    v_dot2c_f32_bf16 v14, s29, v112
    v_dot2c_f32_bf16 v15, v112, v112
    v_dot2c_f32_bf16 v14, s29, v113
    v_dot2c_f32_bf16 v15, v113, v113
    v_dot2c_f32_bf16 v14, s29, v114
    v_dot2c_f32_bf16 v15, v114, v114
    v_dot2c_f32_bf16 v14, s29, v115
    v_dot2c_f32_bf16 v15, v115, v115
    v_dot2c_f32_bf16 v14, s29, v116
    v_dot2c_f32_bf16 v15, v116, v116
    v_dot2c_f32_bf16 v14, s29, v117
    v_dot2c_f32_bf16 v15, v117, v117
    v_dot2c_f32_bf16 v14, s29, v118
    v_dot2c_f32_bf16 v15, v118, v118
    v_dot2c_f32_bf16 v14, s29, v119
    v_dot2c_f32_bf16 v15, v119, v119
    s_nop 2
    v_mov_b32 v16, v14
    v_mov_b32 v17, v15
    s_nop 0
    v_permlane32_swap_b32 v14, v16
    v_permlane32_swap_b32 v15, v17
    v_add_f32 v14, v14, v16
    v_add_f32 v15, v15, v17
    s_mov_b64 exec, 0xffffffff
    buffer_store_dwordx2 v[14:15], v3, s[8:11], s53 offen sc1
    s_mov_b64 exec, -1
    s_setprio 0
    s_waitcnt vmcnt(0)
    s_barrier
    s_mov_b32 s56, 0x3f803f80
    v_mov_b32 v124, 0
    v_mov_b32 v125, 0
    v_mov_b32 v126, 0
    v_mov_b32 v127, 0
    v_dot2c_f32_bf16 v124, s56, v128
    v_dot2c_f32_bf16 v125, s56, v129
    v_dot2c_f32_bf16 v126, s56, v130
    v_dot2c_f32_bf16 v127, s56, v131
    v_dot2c_f32_bf16 v124, s56, v132
    v_dot2c_f32_bf16 v125, s56, v133
    v_dot2c_f32_bf16 v126, s56, v134
    v_dot2c_f32_bf16 v127, s56, v135
    v_dot2c_f32_bf16 v124, s56, v136
    v_dot2c_f32_bf16 v125, s56, v137
    v_dot2c_f32_bf16 v126, s56, v138
    v_dot2c_f32_bf16 v127, s56, v139
    v_dot2c_f32_bf16 v124, s56, v140
    v_dot2c_f32_bf16 v125, s56, v141
    v_dot2c_f32_bf16 v126, s56, v142
    v_dot2c_f32_bf16 v127, s56, v143
    v_dot2c_f32_bf16 v124, s56, v144
    v_dot2c_f32_bf16 v125, s56, v145
    v_dot2c_f32_bf16 v126, s56, v146
    v_dot2c_f32_bf16 v127, s56, v147
    v_dot2c_f32_bf16 v124, s56, v148
    v_dot2c_f32_bf16 v125, s56, v149
    v_dot2c_f32_bf16 v126, s56, v150
    v_dot2c_f32_bf16 v127, s56, v151
    v_dot2c_f32_bf16 v124, s56, v152
    v_dot2c_f32_bf16 v125, s56, v153
    v_dot2c_f32_bf16 v126, s56, v154
    v_dot2c_f32_bf16 v127, s56, v155
    v_dot2c_f32_bf16 v124, s56, v156
    v_dot2c_f32_bf16 v125, s56, v157
    v_dot2c_f32_bf16 v126, s56, v158
    v_dot2c_f32_bf16 v127, s56, v159
    v_dot2c_f32_bf16 v124, s56, v160
    v_dot2c_f32_bf16 v125, s56, v161
    v_dot2c_f32_bf16 v126, s56, v162
    v_dot2c_f32_bf16 v127, s56, v163
    v_dot2c_f32_bf16 v124, s56, v164
    v_dot2c_f32_bf16 v125, s56, v165
    v_dot2c_f32_bf16 v126, s56, v166
    v_dot2c_f32_bf16 v127, s56, v167
    v_dot2c_f32_bf16 v124, s56, v168
    v_dot2c_f32_bf16 v125, s56, v169
    v_dot2c_f32_bf16 v126, s56, v170
    v_dot2c_f32_bf16 v127, s56, v171
    v_dot2c_f32_bf16 v124, s56, v172
    v_dot2c_f32_bf16 v125, s56, v173
    v_dot2c_f32_bf16 v126, s56, v174
    v_dot2c_f32_bf16 v127, s56, v175
    v_dot2c_f32_bf16 v124, s56, v176
    v_dot2c_f32_bf16 v125, s56, v177
    v_dot2c_f32_bf16 v126, s56, v178
    v_dot2c_f32_bf16 v127, s56, v179
    v_dot2c_f32_bf16 v124, s56, v180
    v_dot2c_f32_bf16 v125, s56, v181
    v_dot2c_f32_bf16 v126, s56, v182
    v_dot2c_f32_bf16 v127, s56, v183
    v_dot2c_f32_bf16 v124, s56, v184
    v_dot2c_f32_bf16 v125, s56, v185
    v_dot2c_f32_bf16 v126, s56, v186
    v_dot2c_f32_bf16 v127, s56, v187
    v_dot2c_f32_bf16 v124, s56, v188
    v_dot2c_f32_bf16 v125, s56, v189
    v_dot2c_f32_bf16 v126, s56, v190
    v_dot2c_f32_bf16 v127, s56, v191
    v_dot2c_f32_bf16 v124, s56, v192
    v_dot2c_f32_bf16 v125, s56, v193
    v_dot2c_f32_bf16 v126, s56, v194
    v_dot2c_f32_bf16 v127, s56, v195
    v_dot2c_f32_bf16 v124, s56, v196
    v_dot2c_f32_bf16 v125, s56, v197
    v_dot2c_f32_bf16 v126, s56, v198
    v_dot2c_f32_bf16 v127, s56, v199
    v_dot2c_f32_bf16 v124, s56, v200
    v_dot2c_f32_bf16 v125, s56, v201
    v_dot2c_f32_bf16 v126, s56, v202
    v_dot2c_f32_bf16 v127, s56, v203
    v_dot2c_f32_bf16 v124, s56, v204
    v_dot2c_f32_bf16 v125, s56, v205
    v_dot2c_f32_bf16 v126, s56, v206
    v_dot2c_f32_bf16 v127, s56, v207
    v_dot2c_f32_bf16 v124, s56, v208
    v_dot2c_f32_bf16 v125, s56, v209
    v_dot2c_f32_bf16 v126, s56, v210
    v_dot2c_f32_bf16 v127, s56, v211
    v_dot2c_f32_bf16 v124, s56, v212
    v_dot2c_f32_bf16 v125, s56, v213
    v_dot2c_f32_bf16 v126, s56, v214
    v_dot2c_f32_bf16 v127, s56, v215
    v_dot2c_f32_bf16 v124, s56, v216
    v_dot2c_f32_bf16 v125, s56, v217
    v_dot2c_f32_bf16 v126, s56, v218
    v_dot2c_f32_bf16 v127, s56, v219
    v_dot2c_f32_bf16 v124, s56, v220
    v_dot2c_f32_bf16 v125, s56, v221
    v_dot2c_f32_bf16 v126, s56, v222
    v_dot2c_f32_bf16 v127, s56, v223
    v_dot2c_f32_bf16 v124, s56, v224
    v_dot2c_f32_bf16 v125, s56, v225
    v_dot2c_f32_bf16 v126, s56, v226
    v_dot2c_f32_bf16 v127, s56, v227
    v_dot2c_f32_bf16 v124, s56, v228
    v_dot2c_f32_bf16 v125, s56, v229
    v_dot2c_f32_bf16 v126, s56, v230
    v_dot2c_f32_bf16 v127, s56, v231
    v_dot2c_f32_bf16 v124, s56, v232
    v_dot2c_f32_bf16 v125, s56, v233
    v_dot2c_f32_bf16 v126, s56, v234
    v_dot2c_f32_bf16 v127, s56, v235
    v_dot2c_f32_bf16 v124, s56, v236
    v_dot2c_f32_bf16 v125, s56, v237
    v_dot2c_f32_bf16 v126, s56, v238
    v_dot2c_f32_bf16 v127, s56, v239
    v_dot2c_f32_bf16 v124, s56, v240
    v_dot2c_f32_bf16 v125, s56, v241
    v_dot2c_f32_bf16 v126, s56, v242
    v_dot2c_f32_bf16 v127, s56, v243
    v_dot2c_f32_bf16 v124, s56, v244
    v_dot2c_f32_bf16 v125, s56, v245
    v_dot2c_f32_bf16 v126, s56, v246
    v_dot2c_f32_bf16 v127, s56, v247
    v_dot2c_f32_bf16 v124, s56, v248
    v_dot2c_f32_bf16 v125, s56, v249
    v_dot2c_f32_bf16 v126, s56, v250
    v_dot2c_f32_bf16 v127, s56, v251
    v_dot2c_f32_bf16 v124, s56, v252
    v_dot2c_f32_bf16 v125, s56, v253
    v_dot2c_f32_bf16 v126, s56, v254
    v_dot2c_f32_bf16 v127, s56, v255
    s_nop 2
    v_add_f32 v124, v124, v125
    v_add_f32 v126, v126, v127
    v_add_f32 v126, v124, v126
    v_cvt_pk_bf16_f32 v124, v126, v126
    v_lshlrev_b32 v125, 16, v124
    v_sub_f32 v125, v126, v125
    v_cvt_pk_bf16_f32 v125, v125, v125
    v_mov_b32 v126, 0
    v_mov_b32 v127, 0
K2_B3:
    v_add_u32 v3, 65536, v2
    v_and_b32 v8, 31, v0
    v_lshlrev_b32 v8, 4, v8
    v_add_u32 v8, 131072, v8
    s_mul_i32 s32, s36, 458752
    s_lshl_b32 s33, s39, 10
    s_add_u32 s32, s32, s33
    s_add_u32 s32, s32, 18874368
    s_and_b32 s25, s22, 3
    s_and_b32 s57, s37, 1
    s_lshl_b32 s57, s57, 1
    s_xor_b32 s33, s25, s57
    s_lshl_b32 s30, s36, 2
    s_add_u32 s30, s30, s33
    s_mul_i32 s33, s57, 114688
    s_sub_u32 s56, 229376, s33
    s_add_u32 s56, s56, s32
    s_add_u32 s32, s32, s33
    v_mov_b32 v4, 133120
    v_mov_b32 v5, 1
    v_mov_b32 v94, 0
    v_mov_b32 v95, 0
    s_lshl_b32 s26, s36, 17
    s_add_u32 s26, s26, 8388608
    s_lshl_b32 s33, s57, 15
    s_sub_u32 s27, 65536, s33
    s_add_u32 s27, s27, s26
    s_add_u32 s26, s26, s33
    s_lshl_b32 s28, s22, 12
    s_add_u32 s29, s26, s28
    s_mov_b32 m0, s28
    s_lshl_b32 s52, s30, 12
    s_add_u32 s52, s52, 10485760
    s_lshl_b32 s53, s25, 9
    v_add_u32 v9, s53, v8
    v_and_b32 v1, 31, v0
    v_lshlrev_b32 v1, 3, v1
    v_lshl_add_u32 v1, v11, 11, v1
    s_barrier
    buffer_load_dwordx4 v2, s[8:11], s29 offen offset:0 sc1 lds
    buffer_load_dwordx4 v2, s[8:11], s29 offen offset:1024 sc1 lds
    buffer_load_dwordx4 v2, s[8:11], s29 offen offset:2048 sc1 lds
    buffer_load_dwordx4 v2, s[8:11], s29 offen offset:3072 sc1 lds
    s_cmp_lt_u32 s22, 4
    s_cbranch_scc1 K2_GA
    s_lshl_b32 s28, s25, 13
    buffer_load_dwordx2 v[96:97], v1, s[8:11], s52 offen offset:0 sc1
    buffer_load_dwordx2 v[98:99], v1, s[8:11], s52 offen offset:256 sc1
    buffer_load_dwordx2 v[100:101], v1, s[8:11], s52 offen offset:512 sc1
    buffer_load_dwordx2 v[102:103], v1, s[8:11], s52 offen offset:768 sc1
    buffer_load_dwordx2 v[104:105], v1, s[8:11], s52 offen offset:1024 sc1
    buffer_load_dwordx2 v[106:107], v1, s[8:11], s52 offen offset:1280 sc1
    buffer_load_dwordx2 v[108:109], v1, s[8:11], s52 offen offset:1536 sc1
    buffer_load_dwordx2 v[110:111], v1, s[8:11], s52 offen offset:1792 sc1
    s_add_u32 m0, s28, 32768
    s_add_u32 s29, s26, 32768
    s_add_u32 s29, s29, s28
    buffer_load_dwordx4 v2, s[8:11], s29 offen offset:0 sc1 lds
    buffer_load_dwordx4 v2, s[8:11], s29 offen offset:1024 sc1 lds
    buffer_load_dwordx4 v2, s[8:11], s29 offen offset:2048 sc1 lds
    buffer_load_dwordx4 v2, s[8:11], s29 offen offset:3072 sc1 lds
    v_mov_b32 v6, 0
    v_mov_b32 v7, 0
    ds_write_b64 v4, v[6:7] offset:0
    ds_write_b64 v4, v[6:7] offset:8
    ds_write_b64 v4, v[6:7] offset:16
    ds_write_b64 v4, v[6:7] offset:24
    s_waitcnt vmcnt(12) lgkmcnt(0)
    s_barrier
    s_add_u32 m0, s28, 36864
    s_add_u32 s29, s26, 36864
    s_add_u32 s29, s29, s28
    buffer_load_dwordx4 v2, s[8:11], s29 offen offset:0 sc1 lds
    buffer_load_dwordx4 v2, s[8:11], s29 offen offset:1024 sc1 lds
    buffer_load_dwordx4 v2, s[8:11], s29 offen offset:2048 sc1 lds
    buffer_load_dwordx4 v2, s[8:11], s29 offen offset:3072 sc1 lds
    s_waitcnt vmcnt(8)
    v_add_f32 v96, v96, v100
    v_add_f32 v97, v97, v101
    v_add_f32 v98, v98, v102
    v_add_f32 v99, v99, v103
    v_add_f32 v96, v96, v104
    v_add_f32 v97, v97, v105
    v_add_f32 v98, v98, v106
    v_add_f32 v99, v99, v107
    v_add_f32 v96, v96, v108
    v_add_f32 v97, v97, v109
    v_add_f32 v98, v98, v110
    v_add_f32 v99, v99, v111
    v_add_f32 v12, v96, v98
    v_add_f32 v13, v97, v99
    v_mov_b32 v14, v12
    v_mov_b32 v15, v13
    s_nop 0
    v_permlane32_swap_b32 v12, v14
    v_permlane32_swap_b32 v13, v15
    v_add_f32 v12, v12, v14
    v_add_f32 v13, v13, v15
    v_mul_f32 v12, 0xbb000000, v12
    v_mul_f32 v13, 0x3b000000, v13
    v_fma_f32 v13, -v12, v12, v13
    v_max_f32 v13, 0, v13
    v_add_f32 v97, 0x3727c5ac, v13
    v_rsq_f32 v14, v97
    v_cvt_pk_bf16_f32 v15, v12, v12
    v_lshlrev_b32 v15, 16, v15
    v_sub_f32 v12, v12, v15
    v_cvt_pk_bf16_f32 v96, v15, v12
    v_mul_f32 v98, 0xc0135761, v14
    v_mul_f32 v14, v14, v14
    v_mul_f32 v14, v14, v98
    v_mul_f32 v99, 0x3d372713, v14
    ds_write_b128 v9, v[96:99]
    s_add_u32 m0, s28, 65536
    s_add_u32 s29, s27, 0
    s_add_u32 s29, s29, s28
    buffer_load_dwordx4 v2, s[8:11], s29 offen offset:0 sc1 lds
    buffer_load_dwordx4 v2, s[8:11], s29 offen offset:1024 sc1 lds
    buffer_load_dwordx4 v2, s[8:11], s29 offen offset:2048 sc1 lds
    buffer_load_dwordx4 v2, s[8:11], s29 offen offset:3072 sc1 lds
    s_add_u32 m0, s28, 69632
    s_add_u32 s29, s27, 4096
    s_add_u32 s29, s29, s28
    buffer_load_dwordx4 v2, s[8:11], s29 offen offset:0 sc1 lds
    buffer_load_dwordx4 v2, s[8:11], s29 offen offset:1024 sc1 lds
    buffer_load_dwordx4 v2, s[8:11], s29 offen offset:2048 sc1 lds
    buffer_load_dwordx4 v2, s[8:11], s29 offen offset:3072 sc1 lds
    s_waitcnt lgkmcnt(0)
    s_barrier
    s_cmp_eq_u32 s22, 7
    s_cbranch_scc1 K2_W7
    s_setprio 1
    ds_read_b128 v[32:35], v2 offset:0
    ds_read_b128 v[36:39], v2 offset:1024
    ds_read_b128 v[40:43], v2 offset:2048
    ds_read_b128 v[44:47], v2 offset:3072
    ds_read_b128 v[48:51], v2 offset:4096
    ds_read_b128 v[52:55], v2 offset:5120
    ds_read_b128 v[56:59], v2 offset:6144
    ds_read_b128 v[60:63], v2 offset:7168
    ds_read_b128 v[64:67], v2 offset:8192
    ds_read_b128 v[68:71], v2 offset:9216
    ds_read_b128 v[72:75], v2 offset:10240
    ds_read_b128 v[76:79], v2 offset:11264
    s_waitcnt lgkmcnt(8)
    v_mfma_f32_32x32x16_bf16 v[16:31], v[128:131], v[32:35], 0
    ds_read_b128 v[32:35], v2 offset:12288
    v_mfma_f32_32x32x16_bf16 v[16:31], v[132:135], v[36:39], v[16:31]
    ds_read_b128 v[36:39], v2 offset:13312
    v_mfma_f32_32x32x16_bf16 v[16:31], v[136:139], v[40:43], v[16:31]
    ds_read_b128 v[40:43], v2 offset:14336
    v_mfma_f32_32x32x16_bf16 v[16:31], v[140:143], v[44:47], v[16:31]
    ds_read_b128 v[44:47], v2 offset:15360
    s_waitcnt lgkmcnt(8)
    v_mfma_f32_32x32x16_bf16 v[16:31], v[144:147], v[48:51], v[16:31]
    ds_read_b128 v[48:51], v2 offset:16384
    v_mfma_f32_32x32x16_bf16 v[16:31], v[148:151], v[52:55], v[16:31]
    ds_read_b128 v[52:55], v2 offset:17408
    v_mfma_f32_32x32x16_bf16 v[16:31], v[152:155], v[56:59], v[16:31]
    ds_read_b128 v[56:59], v2 offset:18432
    v_mfma_f32_32x32x16_bf16 v[16:31], v[156:159], v[60:63], v[16:31]
    ds_read_b128 v[60:63], v2 offset:19456
    s_waitcnt lgkmcnt(8)
    v_mfma_f32_32x32x16_bf16 v[16:31], v[160:163], v[64:67], v[16:31]
    s_setprio 2
    ds_read_b128 v[64:67], v2 offset:20480
    v_mfma_f32_32x32x16_bf16 v[16:31], v[164:167], v[68:71], v[16:31]
    ds_read_b128 v[68:71], v2 offset:21504
    v_mfma_f32_32x32x16_bf16 v[16:31], v[168:171], v[72:75], v[16:31]
    ds_read_b128 v[72:75], v2 offset:22528
    v_mfma_f32_32x32x16_bf16 v[16:31], v[172:175], v[76:79], v[16:31]
    ds_read_b128 v[76:79], v2 offset:23552
    s_waitcnt lgkmcnt(8)
    v_mfma_f32_32x32x16_bf16 v[16:31], v[176:179], v[32:35], v[16:31]
    ds_read_b128 v[32:35], v2 offset:24576
    v_mfma_f32_32x32x16_bf16 v[16:31], v[180:183], v[36:39], v[16:31]
    ds_read_b128 v[36:39], v2 offset:25600
    v_mfma_f32_32x32x16_bf16 v[16:31], v[184:187], v[40:43], v[16:31]
    ds_read_b128 v[40:43], v2 offset:26624
    v_mfma_f32_32x32x16_bf16 v[16:31], v[188:191], v[44:47], v[16:31]
    ds_read_b128 v[44:47], v2 offset:27648
    s_waitcnt lgkmcnt(8)
    v_mfma_f32_32x32x16_bf16 v[16:31], v[192:195], v[48:51], v[16:31]
    ds_read_b128 v[48:51], v2 offset:28672
    v_mfma_f32_32x32x16_bf16 v[16:31], v[196:199], v[52:55], v[16:31]
    ds_read_b128 v[52:55], v2 offset:29696
    v_mfma_f32_32x32x16_bf16 v[16:31], v[200:203], v[56:59], v[16:31]
    ds_read_b128 v[56:59], v2 offset:30720
    v_mfma_f32_32x32x16_bf16 v[16:31], v[204:207], v[60:63], v[16:31]
    ds_read_b128 v[60:63], v2 offset:31744
    s_waitcnt lgkmcnt(8)
    v_mfma_f32_32x32x16_bf16 v[16:31], v[208:211], v[64:67], v[16:31]
    s_waitcnt vmcnt(0)
    s_barrier
    v_mfma_f32_32x32x16_bf16 v[16:31], v[212:215], v[68:71], v[16:31]
    v_mfma_f32_32x32x16_bf16 v[16:31], v[216:219], v[72:75], v[16:31]
    ds_read_b128 v[88:91], v8 offset:0
    v_mfma_f32_32x32x16_bf16 v[16:31], v[220:223], v[76:79], v[16:31]
    s_waitcnt lgkmcnt(4)
    v_mfma_f32_32x32x16_bf16 v[16:31], v[224:227], v[32:35], v[16:31]
    v_mfma_f32_32x32x16_bf16 v[16:31], v[228:231], v[36:39], v[16:31]
    v_mfma_f32_32x32x16_bf16 v[16:31], v[232:235], v[40:43], v[16:31]
    v_mfma_f32_32x32x16_bf16 v[16:31], v[236:239], v[44:47], v[16:31]
    s_waitcnt lgkmcnt(0)
    v_mfma_f32_32x32x16_bf16 v[16:31], v[240:243], v[48:51], v[16:31]
    s_mov_b64 exec, 1
    ds_add_u32 v4, v5 offset:0
    s_mov_b64 exec, -1
    v_mfma_f32_32x32x16_bf16 v[16:31], v[244:247], v[52:55], v[16:31]
    v_mov_b32 v92, v88
    v_mov_b32 v93, v88
    v_mfma_f32_32x32x16_bf16 v[16:31], v[248:251], v[56:59], v[16:31]
    v_mfma_f32_32x32x16_bf16 v[16:31], v[252:255], v[60:63], v[16:31]
    v_mfma_f32_32x32x16_bf16 v[16:31], v[124:127], v[92:95], v[16:31]
    s_setprio 0
    ds_read_b128 v[32:35], v2 offset:32768
    ds_read_b128 v[36:39], v2 offset:33792
    ds_read_b128 v[40:43], v2 offset:34816
    ds_read_b128 v[44:47], v2 offset:35840
    ds_read_b128 v[48:51], v2 offset:36864
    ds_read_b128 v[52:55], v2 offset:37888
    ds_read_b128 v[56:59], v2 offset:38912
    ds_read_b128 v[60:63], v2 offset:39936
    ds_read_b128 v[64:67], v2 offset:40960
    ds_read_b128 v[68:71], v2 offset:41984
    ds_read_b128 v[72:75], v2 offset:43008
    v_mul_f32 v80, v16, v16
    v_mul_f32 v81, v17, v17
    v_mul_f32 v82, v18, v18
    v_mul_f32 v83, v19, v19
    v_mul_f32 v84, v20, v20
    v_mul_f32 v85, v21, v21
    v_mul_f32 v86, v22, v22
    v_mul_f32 v87, v23, v23
    v_fma_f32 v80, v80, v91, v90
    v_fma_f32 v81, v81, v91, v90
    v_fma_f32 v82, v82, v91, v90
    v_fma_f32 v83, v83, v91, v90
    v_fma_f32 v84, v84, v91, v90
    v_fma_f32 v85, v85, v91, v90
    v_fma_f32 v86, v86, v91, v90
    v_fma_f32 v87, v87, v91, v90
    v_mul_f32 v80, v80, v16
    v_mul_f32 v81, v81, v17
    v_mul_f32 v82, v82, v18
    v_mul_f32 v83, v83, v19
    v_mul_f32 v84, v84, v20
    v_mul_f32 v85, v85, v21
    v_mul_f32 v86, v86, v22
    v_mul_f32 v87, v87, v23
    v_exp_f32 v80, v80
    v_mul_f32 v16, v16, v24
    v_exp_f32 v81, v81
    v_mul_f32 v17, v17, v25
    v_exp_f32 v82, v82
    v_mul_f32 v18, v18, v26
    v_exp_f32 v83, v83
    v_mul_f32 v19, v19, v27
    v_exp_f32 v84, v84
    v_mul_f32 v20, v20, v28
    v_exp_f32 v85, v85
    v_mul_f32 v21, v21, v29
    v_exp_f32 v86, v86
    v_mul_f32 v22, v22, v30
    v_exp_f32 v87, v87
    v_mul_f32 v23, v23, v31
    v_fma_f32 v80, v80, v89, v89
    v_fma_f32 v81, v81, v89, v89
    v_fma_f32 v82, v82, v89, v89
    v_fma_f32 v83, v83, v89, v89
    v_fma_f32 v84, v84, v89, v89
    v_fma_f32 v85, v85, v89, v89
    v_fma_f32 v86, v86, v89, v89
    v_fma_f32 v87, v87, v89, v89
    v_rcp_f32 v80, v80
    v_rcp_f32 v81, v81
    v_rcp_f32 v82, v82
    v_rcp_f32 v83, v83
    v_rcp_f32 v84, v84
    v_rcp_f32 v85, v85
    v_rcp_f32 v86, v86
    v_rcp_f32 v87, v87
    s_add_u32 s29, s32, 0
    v_mul_f32 v16, v16, v80
    v_mul_f32 v17, v17, v81
    v_mul_f32 v18, v18, v82
    v_mul_f32 v19, v19, v83
    v_mul_f32 v20, v20, v84
    v_mul_f32 v21, v21, v85
    v_mul_f32 v22, v22, v86
    v_mul_f32 v23, v23, v87
    v_cvt_pk_bf16_f32 v24, v16, v17
    v_cvt_pk_bf16_f32 v25, v18, v19
    v_cvt_pk_bf16_f32 v26, v20, v21
    v_cvt_pk_bf16_f32 v27, v22, v23
    buffer_store_dwordx4 v[24:27], v2, s[8:11], s29 offen sc1
    s_setprio 1
    ds_read_b128 v[76:79], v2 offset:44032
    s_waitcnt lgkmcnt(8)
    v_mfma_f32_32x32x16_bf16 v[16:31], v[128:131], v[32:35], 0
    ds_read_b128 v[32:35], v2 offset:45056
    v_mfma_f32_32x32x16_bf16 v[16:31], v[132:135], v[36:39], v[16:31]
    ds_read_b128 v[36:39], v2 offset:46080
    v_mfma_f32_32x32x16_bf16 v[16:31], v[136:139], v[40:43], v[16:31]
    ds_read_b128 v[40:43], v2 offset:47104
    v_mfma_f32_32x32x16_bf16 v[16:31], v[140:143], v[44:47], v[16:31]
    ds_read_b128 v[44:47], v2 offset:48128
    s_waitcnt lgkmcnt(8)
    v_mfma_f32_32x32x16_bf16 v[16:31], v[144:147], v[48:51], v[16:31]
    ds_read_b128 v[48:51], v2 offset:49152
    v_mfma_f32_32x32x16_bf16 v[16:31], v[148:151], v[52:55], v[16:31]
    ds_read_b128 v[52:55], v2 offset:50176
    v_mfma_f32_32x32x16_bf16 v[16:31], v[152:155], v[56:59], v[16:31]
    ds_read_b128 v[56:59], v2 offset:51200
    v_mfma_f32_32x32x16_bf16 v[16:31], v[156:159], v[60:63], v[16:31]
    ds_read_b128 v[60:63], v2 offset:52224
    s_waitcnt lgkmcnt(8)
    v_mfma_f32_32x32x16_bf16 v[16:31], v[160:163], v[64:67], v[16:31]
    s_setprio 2
    ds_read_b128 v[64:67], v2 offset:53248
    v_mfma_f32_32x32x16_bf16 v[16:31], v[164:167], v[68:71], v[16:31]
    ds_read_b128 v[68:71], v2 offset:54272
    v_mfma_f32_32x32x16_bf16 v[16:31], v[168:171], v[72:75], v[16:31]
    ds_read_b128 v[72:75], v2 offset:55296
    v_mfma_f32_32x32x16_bf16 v[16:31], v[172:175], v[76:79], v[16:31]
    ds_read_b128 v[76:79], v2 offset:56320
    s_waitcnt lgkmcnt(8)
    v_mfma_f32_32x32x16_bf16 v[16:31], v[176:179], v[32:35], v[16:31]
    ds_read_b128 v[32:35], v2 offset:57344
    v_mfma_f32_32x32x16_bf16 v[16:31], v[180:183], v[36:39], v[16:31]
    ds_read_b128 v[36:39], v2 offset:58368
    v_mfma_f32_32x32x16_bf16 v[16:31], v[184:187], v[40:43], v[16:31]
    ds_read_b128 v[40:43], v2 offset:59392
    v_mfma_f32_32x32x16_bf16 v[16:31], v[188:191], v[44:47], v[16:31]
    ds_read_b128 v[44:47], v2 offset:60416
    s_waitcnt lgkmcnt(8)
    v_mfma_f32_32x32x16_bf16 v[16:31], v[192:195], v[48:51], v[16:31]
    ds_read_b128 v[48:51], v2 offset:61440
    v_mfma_f32_32x32x16_bf16 v[16:31], v[196:199], v[52:55], v[16:31]
    ds_read_b128 v[52:55], v2 offset:62464
    v_mfma_f32_32x32x16_bf16 v[16:31], v[200:203], v[56:59], v[16:31]
    ds_read_b128 v[56:59], v2 offset:63488
    v_mfma_f32_32x32x16_bf16 v[16:31], v[204:207], v[60:63], v[16:31]
    ds_read_b128 v[60:63], v2 offset:64512
    s_waitcnt lgkmcnt(8)
    v_mfma_f32_32x32x16_bf16 v[16:31], v[208:211], v[64:67], v[16:31]
    v_mfma_f32_32x32x16_bf16 v[16:31], v[212:215], v[68:71], v[16:31]
    v_mfma_f32_32x32x16_bf16 v[16:31], v[216:219], v[72:75], v[16:31]
    ds_read_b128 v[88:91], v8 offset:512
    v_mfma_f32_32x32x16_bf16 v[16:31], v[220:223], v[76:79], v[16:31]
    s_waitcnt lgkmcnt(4)
    v_mfma_f32_32x32x16_bf16 v[16:31], v[224:227], v[32:35], v[16:31]
    v_mfma_f32_32x32x16_bf16 v[16:31], v[228:231], v[36:39], v[16:31]
    v_mfma_f32_32x32x16_bf16 v[16:31], v[232:235], v[40:43], v[16:31]
    v_mfma_f32_32x32x16_bf16 v[16:31], v[236:239], v[44:47], v[16:31]
    s_waitcnt lgkmcnt(0)
    v_mfma_f32_32x32x16_bf16 v[16:31], v[240:243], v[48:51], v[16:31]
    s_mov_b64 exec, 1
    ds_add_u32 v4, v5 offset:4
    s_mov_b64 exec, -1
    v_mfma_f32_32x32x16_bf16 v[16:31], v[244:247], v[52:55], v[16:31]
    v_mov_b32 v92, v88
    v_mov_b32 v93, v88
    v_mfma_f32_32x32x16_bf16 v[16:31], v[248:251], v[56:59], v[16:31]
    v_mfma_f32_32x32x16_bf16 v[16:31], v[252:255], v[60:63], v[16:31]
    v_mfma_f32_32x32x16_bf16 v[16:31], v[124:127], v[92:95], v[16:31]
    s_setprio 0
    ds_read_b128 v[32:35], v3 offset:0
    ds_read_b128 v[36:39], v3 offset:1024
    ds_read_b128 v[40:43], v3 offset:2048
    ds_read_b128 v[44:47], v3 offset:3072
    ds_read_b128 v[48:51], v3 offset:4096
    ds_read_b128 v[52:55], v3 offset:5120
    ds_read_b128 v[56:59], v3 offset:6144
    ds_read_b128 v[60:63], v3 offset:7168
    ds_read_b128 v[64:67], v3 offset:8192
    ds_read_b128 v[68:71], v3 offset:9216
    ds_read_b128 v[72:75], v3 offset:10240
    v_mul_f32 v80, v16, v16
    v_mul_f32 v81, v17, v17
    v_mul_f32 v82, v18, v18
    v_mul_f32 v83, v19, v19
    v_mul_f32 v84, v20, v20
    v_mul_f32 v85, v21, v21
    v_mul_f32 v86, v22, v22
    v_mul_f32 v87, v23, v23
    v_fma_f32 v80, v80, v91, v90
    v_fma_f32 v81, v81, v91, v90
    v_fma_f32 v82, v82, v91, v90
    v_fma_f32 v83, v83, v91, v90
    v_fma_f32 v84, v84, v91, v90
    v_fma_f32 v85, v85, v91, v90
    v_fma_f32 v86, v86, v91, v90
    v_fma_f32 v87, v87, v91, v90
    v_mul_f32 v80, v80, v16
    v_mul_f32 v81, v81, v17
    v_mul_f32 v82, v82, v18
    v_mul_f32 v83, v83, v19
    v_mul_f32 v84, v84, v20
    v_mul_f32 v85, v85, v21
    v_mul_f32 v86, v86, v22
    v_mul_f32 v87, v87, v23
    v_exp_f32 v80, v80
    v_mul_f32 v16, v16, v24
    v_exp_f32 v81, v81
    v_mul_f32 v17, v17, v25
    v_exp_f32 v82, v82
    v_mul_f32 v18, v18, v26
    v_exp_f32 v83, v83
    v_mul_f32 v19, v19, v27
    v_exp_f32 v84, v84
    v_mul_f32 v20, v20, v28
    v_exp_f32 v85, v85
    v_mul_f32 v21, v21, v29
    v_exp_f32 v86, v86
    v_mul_f32 v22, v22, v30
    v_exp_f32 v87, v87
    v_mul_f32 v23, v23, v31
    v_fma_f32 v80, v80, v89, v89
    v_fma_f32 v81, v81, v89, v89
    v_fma_f32 v82, v82, v89, v89
    v_fma_f32 v83, v83, v89, v89
    v_fma_f32 v84, v84, v89, v89
    v_fma_f32 v85, v85, v89, v89
    v_fma_f32 v86, v86, v89, v89
    v_fma_f32 v87, v87, v89, v89
    v_rcp_f32 v80, v80
    v_rcp_f32 v81, v81
    v_rcp_f32 v82, v82
    v_rcp_f32 v83, v83
    v_rcp_f32 v84, v84
    v_rcp_f32 v85, v85
    v_rcp_f32 v86, v86
    v_rcp_f32 v87, v87
    s_add_u32 s29, s32, 114688
    v_mul_f32 v16, v16, v80
    v_mul_f32 v17, v17, v81
    v_mul_f32 v18, v18, v82
    v_mul_f32 v19, v19, v83
    v_mul_f32 v20, v20, v84
    v_mul_f32 v21, v21, v85
    v_mul_f32 v22, v22, v86
    v_mul_f32 v23, v23, v87
    v_cvt_pk_bf16_f32 v24, v16, v17
    v_cvt_pk_bf16_f32 v25, v18, v19
    v_cvt_pk_bf16_f32 v26, v20, v21
    v_cvt_pk_bf16_f32 v27, v22, v23
    buffer_store_dwordx4 v[24:27], v2, s[8:11], s29 offen sc1
    s_setprio 1
    ds_read_b128 v[76:79], v3 offset:11264
    s_waitcnt lgkmcnt(8)
    v_mfma_f32_32x32x16_bf16 v[16:31], v[128:131], v[32:35], 0
    ds_read_b128 v[32:35], v3 offset:12288
    v_mfma_f32_32x32x16_bf16 v[16:31], v[132:135], v[36:39], v[16:31]
    ds_read_b128 v[36:39], v3 offset:13312
    v_mfma_f32_32x32x16_bf16 v[16:31], v[136:139], v[40:43], v[16:31]
    ds_read_b128 v[40:43], v3 offset:14336
    v_mfma_f32_32x32x16_bf16 v[16:31], v[140:143], v[44:47], v[16:31]
    ds_read_b128 v[44:47], v3 offset:15360
    s_waitcnt lgkmcnt(8)
    v_mfma_f32_32x32x16_bf16 v[16:31], v[144:147], v[48:51], v[16:31]
    ds_read_b128 v[48:51], v3 offset:16384
    v_mfma_f32_32x32x16_bf16 v[16:31], v[148:151], v[52:55], v[16:31]
    ds_read_b128 v[52:55], v3 offset:17408
    v_mfma_f32_32x32x16_bf16 v[16:31], v[152:155], v[56:59], v[16:31]
    ds_read_b128 v[56:59], v3 offset:18432
    v_mfma_f32_32x32x16_bf16 v[16:31], v[156:159], v[60:63], v[16:31]
    ds_read_b128 v[60:63], v3 offset:19456
    s_waitcnt lgkmcnt(8)
    v_mfma_f32_32x32x16_bf16 v[16:31], v[160:163], v[64:67], v[16:31]
    s_setprio 2
    ds_read_b128 v[64:67], v3 offset:20480
    v_mfma_f32_32x32x16_bf16 v[16:31], v[164:167], v[68:71], v[16:31]
    ds_read_b128 v[68:71], v3 offset:21504
    v_mfma_f32_32x32x16_bf16 v[16:31], v[168:171], v[72:75], v[16:31]
    ds_read_b128 v[72:75], v3 offset:22528
    v_mfma_f32_32x32x16_bf16 v[16:31], v[172:175], v[76:79], v[16:31]
    ds_read_b128 v[76:79], v3 offset:23552
    s_waitcnt lgkmcnt(8)
    v_mfma_f32_32x32x16_bf16 v[16:31], v[176:179], v[32:35], v[16:31]
    s_waitcnt vmcnt(0)
    s_mov_b64 exec, 1
    ds_add_u32 v4, v5 offset:16
    s_mov_b64 exec, -1
    ds_read_b128 v[32:35], v3 offset:24576
    v_mfma_f32_32x32x16_bf16 v[16:31], v[180:183], v[36:39], v[16:31]
    ds_read_b128 v[36:39], v3 offset:25600
    v_mfma_f32_32x32x16_bf16 v[16:31], v[184:187], v[40:43], v[16:31]
    ds_read_b128 v[40:43], v3 offset:26624
    v_mfma_f32_32x32x16_bf16 v[16:31], v[188:191], v[44:47], v[16:31]
    ds_read_b128 v[44:47], v3 offset:27648
    s_waitcnt lgkmcnt(8)
    v_mfma_f32_32x32x16_bf16 v[16:31], v[192:195], v[48:51], v[16:31]
    ds_read_b128 v[48:51], v3 offset:28672
    v_mfma_f32_32x32x16_bf16 v[16:31], v[196:199], v[52:55], v[16:31]
    ds_read_b128 v[52:55], v3 offset:29696
    v_mfma_f32_32x32x16_bf16 v[16:31], v[200:203], v[56:59], v[16:31]
    ds_read_b128 v[56:59], v3 offset:30720
    v_mfma_f32_32x32x16_bf16 v[16:31], v[204:207], v[60:63], v[16:31]
    ds_read_b128 v[60:63], v3 offset:31744
    s_waitcnt lgkmcnt(8)
    v_mfma_f32_32x32x16_bf16 v[16:31], v[208:211], v[64:67], v[16:31]
    v_mfma_f32_32x32x16_bf16 v[16:31], v[212:215], v[68:71], v[16:31]
    v_mfma_f32_32x32x16_bf16 v[16:31], v[216:219], v[72:75], v[16:31]
    ds_read_b128 v[88:91], v8 offset:1024
    v_mfma_f32_32x32x16_bf16 v[16:31], v[220:223], v[76:79], v[16:31]
    s_waitcnt lgkmcnt(4)
    v_mfma_f32_32x32x16_bf16 v[16:31], v[224:227], v[32:35], v[16:31]
    v_mfma_f32_32x32x16_bf16 v[16:31], v[228:231], v[36:39], v[16:31]
    v_mfma_f32_32x32x16_bf16 v[16:31], v[232:235], v[40:43], v[16:31]
    v_mfma_f32_32x32x16_bf16 v[16:31], v[236:239], v[44:47], v[16:31]
    s_waitcnt lgkmcnt(0)
    v_mfma_f32_32x32x16_bf16 v[16:31], v[240:243], v[48:51], v[16:31]
    s_mov_b64 exec, 1
    ds_add_u32 v4, v5 offset:8
    s_mov_b64 exec, -1
    v_mfma_f32_32x32x16_bf16 v[16:31], v[244:247], v[52:55], v[16:31]
    v_mov_b32 v92, v88
    v_mov_b32 v93, v88
    v_mfma_f32_32x32x16_bf16 v[16:31], v[248:251], v[56:59], v[16:31]
    v_mfma_f32_32x32x16_bf16 v[16:31], v[252:255], v[60:63], v[16:31]
    v_mfma_f32_32x32x16_bf16 v[16:31], v[124:127], v[92:95], v[16:31]
    s_setprio 0
    s_mov_b32 s33, 0
K2_WCT1:
    ds_read_b32 v6, v4 offset:24
    s_add_u32 s33, s33, 1
    s_waitcnt lgkmcnt(0)
    v_cmp_eq_u32 vcc, 1, v6
    s_cmp_gt_u32 s33, 0x100000
    s_cbranch_scc1 K2_WXT1
    s_cbranch_vccnz K2_WXT1
    s_sleep 2
    s_branch K2_WCT1
K2_WXT1:
    ds_read_b128 v[32:35], v3 offset:32768
    ds_read_b128 v[36:39], v3 offset:33792
    ds_read_b128 v[40:43], v3 offset:34816
    ds_read_b128 v[44:47], v3 offset:35840
    ds_read_b128 v[48:51], v3 offset:36864
    ds_read_b128 v[52:55], v3 offset:37888
    ds_read_b128 v[56:59], v3 offset:38912
    ds_read_b128 v[60:63], v3 offset:39936
    ds_read_b128 v[64:67], v3 offset:40960
    ds_read_b128 v[68:71], v3 offset:41984
    ds_read_b128 v[72:75], v3 offset:43008
    v_mul_f32 v80, v16, v16
    v_mul_f32 v81, v17, v17
    v_mul_f32 v82, v18, v18
    v_mul_f32 v83, v19, v19
    v_mul_f32 v84, v20, v20
    v_mul_f32 v85, v21, v21
    v_mul_f32 v86, v22, v22
    v_mul_f32 v87, v23, v23
    v_fma_f32 v80, v80, v91, v90
    v_fma_f32 v81, v81, v91, v90
    v_fma_f32 v82, v82, v91, v90
    v_fma_f32 v83, v83, v91, v90
    v_fma_f32 v84, v84, v91, v90
    v_fma_f32 v85, v85, v91, v90
    v_fma_f32 v86, v86, v91, v90
    v_fma_f32 v87, v87, v91, v90
    v_mul_f32 v80, v80, v16
    v_mul_f32 v81, v81, v17
    v_mul_f32 v82, v82, v18
    v_mul_f32 v83, v83, v19
    v_mul_f32 v84, v84, v20
    v_mul_f32 v85, v85, v21
    v_mul_f32 v86, v86, v22
    v_mul_f32 v87, v87, v23
    v_exp_f32 v80, v80
    v_mul_f32 v16, v16, v24
    v_exp_f32 v81, v81
    v_mul_f32 v17, v17, v25
    v_exp_f32 v82, v82
    v_mul_f32 v18, v18, v26
    v_exp_f32 v83, v83
    v_mul_f32 v19, v19, v27
    v_exp_f32 v84, v84
    v_mul_f32 v20, v20, v28
    v_exp_f32 v85, v85
    v_mul_f32 v21, v21, v29
    v_exp_f32 v86, v86
    v_mul_f32 v22, v22, v30
    v_exp_f32 v87, v87
    v_mul_f32 v23, v23, v31
    v_fma_f32 v80, v80, v89, v89
    v_fma_f32 v81, v81, v89, v89
    v_fma_f32 v82, v82, v89, v89
    v_fma_f32 v83, v83, v89, v89
    v_fma_f32 v84, v84, v89, v89
    v_fma_f32 v85, v85, v89, v89
    v_fma_f32 v86, v86, v89, v89
    v_fma_f32 v87, v87, v89, v89
    v_rcp_f32 v80, v80
    v_rcp_f32 v81, v81
    v_rcp_f32 v82, v82
    v_rcp_f32 v83, v83
    v_rcp_f32 v84, v84
    v_rcp_f32 v85, v85
    v_rcp_f32 v86, v86
    v_rcp_f32 v87, v87
    s_add_u32 s29, s56, 0
    v_mul_f32 v16, v16, v80
    v_mul_f32 v17, v17, v81
    v_mul_f32 v18, v18, v82
    v_mul_f32 v19, v19, v83
    v_mul_f32 v20, v20, v84
    v_mul_f32 v21, v21, v85
    v_mul_f32 v22, v22, v86
    v_mul_f32 v23, v23, v87
    v_cvt_pk_bf16_f32 v24, v16, v17
    v_cvt_pk_bf16_f32 v25, v18, v19
    v_cvt_pk_bf16_f32 v26, v20, v21
    v_cvt_pk_bf16_f32 v27, v22, v23
    buffer_store_dwordx4 v[24:27], v2, s[8:11], s29 offen sc1
    s_setprio 1
    ds_read_b128 v[76:79], v3 offset:44032
    s_waitcnt lgkmcnt(8)
    v_mfma_f32_32x32x16_bf16 v[16:31], v[128:131], v[32:35], 0
    ds_read_b128 v[32:35], v3 offset:45056
    v_mfma_f32_32x32x16_bf16 v[16:31], v[132:135], v[36:39], v[16:31]
    ds_read_b128 v[36:39], v3 offset:46080
    v_mfma_f32_32x32x16_bf16 v[16:31], v[136:139], v[40:43], v[16:31]
    ds_read_b128 v[40:43], v3 offset:47104
    v_mfma_f32_32x32x16_bf16 v[16:31], v[140:143], v[44:47], v[16:31]
    ds_read_b128 v[44:47], v3 offset:48128
    s_waitcnt lgkmcnt(8)
    v_mfma_f32_32x32x16_bf16 v[16:31], v[144:147], v[48:51], v[16:31]
    ds_read_b128 v[48:51], v3 offset:49152
    v_mfma_f32_32x32x16_bf16 v[16:31], v[148:151], v[52:55], v[16:31]
    ds_read_b128 v[52:55], v3 offset:50176
    v_mfma_f32_32x32x16_bf16 v[16:31], v[152:155], v[56:59], v[16:31]
    ds_read_b128 v[56:59], v3 offset:51200
    v_mfma_f32_32x32x16_bf16 v[16:31], v[156:159], v[60:63], v[16:31]
    ds_read_b128 v[60:63], v3 offset:52224
    s_waitcnt lgkmcnt(8)
    v_mfma_f32_32x32x16_bf16 v[16:31], v[160:163], v[64:67], v[16:31]
    s_setprio 2
    ds_read_b128 v[64:67], v3 offset:53248
    v_mfma_f32_32x32x16_bf16 v[16:31], v[164:167], v[68:71], v[16:31]
    ds_read_b128 v[68:71], v3 offset:54272
    v_mfma_f32_32x32x16_bf16 v[16:31], v[168:171], v[72:75], v[16:31]
    ds_read_b128 v[72:75], v3 offset:55296
    v_mfma_f32_32x32x16_bf16 v[16:31], v[172:175], v[76:79], v[16:31]
    ds_read_b128 v[76:79], v3 offset:56320
    s_waitcnt lgkmcnt(8)
    v_mfma_f32_32x32x16_bf16 v[16:31], v[176:179], v[32:35], v[16:31]
    ds_read_b128 v[32:35], v3 offset:57344
    v_mfma_f32_32x32x16_bf16 v[16:31], v[180:183], v[36:39], v[16:31]
    ds_read_b128 v[36:39], v3 offset:58368
    v_mfma_f32_32x32x16_bf16 v[16:31], v[184:187], v[40:43], v[16:31]
    ds_read_b128 v[40:43], v3 offset:59392
    v_mfma_f32_32x32x16_bf16 v[16:31], v[188:191], v[44:47], v[16:31]
    ds_read_b128 v[44:47], v3 offset:60416
    s_waitcnt lgkmcnt(8)
    v_mfma_f32_32x32x16_bf16 v[16:31], v[192:195], v[48:51], v[16:31]
    ds_read_b128 v[48:51], v3 offset:61440
    v_mfma_f32_32x32x16_bf16 v[16:31], v[196:199], v[52:55], v[16:31]
    ds_read_b128 v[52:55], v3 offset:62464
    v_mfma_f32_32x32x16_bf16 v[16:31], v[200:203], v[56:59], v[16:31]
    ds_read_b128 v[56:59], v3 offset:63488
    v_mfma_f32_32x32x16_bf16 v[16:31], v[204:207], v[60:63], v[16:31]
    ds_read_b128 v[60:63], v3 offset:64512
    s_waitcnt lgkmcnt(8)
    v_mfma_f32_32x32x16_bf16 v[16:31], v[208:211], v[64:67], v[16:31]
    v_mfma_f32_32x32x16_bf16 v[16:31], v[212:215], v[68:71], v[16:31]
    v_mfma_f32_32x32x16_bf16 v[16:31], v[216:219], v[72:75], v[16:31]
    ds_read_b128 v[88:91], v8 offset:1536
    v_mfma_f32_32x32x16_bf16 v[16:31], v[220:223], v[76:79], v[16:31]
    s_waitcnt lgkmcnt(4)
    v_mfma_f32_32x32x16_bf16 v[16:31], v[224:227], v[32:35], v[16:31]
    v_mfma_f32_32x32x16_bf16 v[16:31], v[228:231], v[36:39], v[16:31]
    v_mfma_f32_32x32x16_bf16 v[16:31], v[232:235], v[40:43], v[16:31]
    v_mfma_f32_32x32x16_bf16 v[16:31], v[236:239], v[44:47], v[16:31]
    s_waitcnt lgkmcnt(0)
    v_mfma_f32_32x32x16_bf16 v[16:31], v[240:243], v[48:51], v[16:31]
    v_mfma_f32_32x32x16_bf16 v[16:31], v[244:247], v[52:55], v[16:31]
    v_mov_b32 v92, v88
    v_mov_b32 v93, v88
    v_mfma_f32_32x32x16_bf16 v[16:31], v[248:251], v[56:59], v[16:31]
    v_mfma_f32_32x32x16_bf16 v[16:31], v[252:255], v[60:63], v[16:31]
    v_mfma_f32_32x32x16_bf16 v[16:31], v[124:127], v[92:95], v[16:31]
    s_setprio 0
    s_nop 10
    v_mul_f32 v80, v16, v16
    v_mul_f32 v81, v17, v17
    v_mul_f32 v82, v18, v18
    v_mul_f32 v83, v19, v19
    v_mul_f32 v84, v20, v20
    v_mul_f32 v85, v21, v21
    v_mul_f32 v86, v22, v22
    v_mul_f32 v87, v23, v23
    v_fma_f32 v80, v80, v91, v90
    v_fma_f32 v81, v81, v91, v90
    v_fma_f32 v82, v82, v91, v90
    v_fma_f32 v83, v83, v91, v90
    v_fma_f32 v84, v84, v91, v90
    v_fma_f32 v85, v85, v91, v90
    v_fma_f32 v86, v86, v91, v90
    v_fma_f32 v87, v87, v91, v90
    v_mul_f32 v80, v80, v16
    v_mul_f32 v81, v81, v17
    v_mul_f32 v82, v82, v18
    v_mul_f32 v83, v83, v19
    v_mul_f32 v84, v84, v20
    v_mul_f32 v85, v85, v21
    v_mul_f32 v86, v86, v22
    v_mul_f32 v87, v87, v23
    v_exp_f32 v80, v80
    v_mul_f32 v16, v16, v24
    v_exp_f32 v81, v81
    v_mul_f32 v17, v17, v25
    v_exp_f32 v82, v82
    v_mul_f32 v18, v18, v26
    v_exp_f32 v83, v83
    v_mul_f32 v19, v19, v27
    v_exp_f32 v84, v84
    v_mul_f32 v20, v20, v28
    v_exp_f32 v85, v85
    v_mul_f32 v21, v21, v29
    v_exp_f32 v86, v86
    v_mul_f32 v22, v22, v30
    v_exp_f32 v87, v87
    v_mul_f32 v23, v23, v31
    v_fma_f32 v80, v80, v89, v89
    v_fma_f32 v81, v81, v89, v89
    v_fma_f32 v82, v82, v89, v89
    v_fma_f32 v83, v83, v89, v89
    v_fma_f32 v84, v84, v89, v89
    v_fma_f32 v85, v85, v89, v89
    v_fma_f32 v86, v86, v89, v89
    v_fma_f32 v87, v87, v89, v89
    v_rcp_f32 v80, v80
    v_rcp_f32 v81, v81
    v_rcp_f32 v82, v82
    v_rcp_f32 v83, v83
    v_rcp_f32 v84, v84
    v_rcp_f32 v85, v85
    v_rcp_f32 v86, v86
    v_rcp_f32 v87, v87
    s_add_u32 s29, s56, 114688
    v_mul_f32 v16, v16, v80
    v_mul_f32 v17, v17, v81
    v_mul_f32 v18, v18, v82
    v_mul_f32 v19, v19, v83
    v_mul_f32 v20, v20, v84
    v_mul_f32 v21, v21, v85
    v_mul_f32 v22, v22, v86
    v_mul_f32 v23, v23, v87
    v_cvt_pk_bf16_f32 v24, v16, v17
    v_cvt_pk_bf16_f32 v25, v18, v19
    v_cvt_pk_bf16_f32 v26, v20, v21
    v_cvt_pk_bf16_f32 v27, v22, v23
    buffer_store_dwordx4 v[24:27], v2, s[8:11], s29 offen sc1
    s_branch K2_DOWN
K2_W7:
    s_add_u32 m0, 0, 98304
    s_add_u32 s29, s27, 32768
    buffer_load_dwordx4 v2, s[8:11], s29 offen offset:0 sc1 lds
    buffer_load_dwordx4 v2, s[8:11], s29 offen offset:1024 sc1 lds
    buffer_load_dwordx4 v2, s[8:11], s29 offen offset:2048 sc1 lds
    buffer_load_dwordx4 v2, s[8:11], s29 offen offset:3072 sc1 lds
    s_add_u32 m0, 0, 102400
    s_add_u32 s29, s27, 36864
    buffer_load_dwordx4 v2, s[8:11], s29 offen offset:0 sc1 lds
    buffer_load_dwordx4 v2, s[8:11], s29 offen offset:1024 sc1 lds
    buffer_load_dwordx4 v2, s[8:11], s29 offen offset:2048 sc1 lds
    buffer_load_dwordx4 v2, s[8:11], s29 offen offset:3072 sc1 lds
    s_add_u32 m0, 0, 106496
    s_add_u32 s29, s27, 40960
    buffer_load_dwordx4 v2, s[8:11], s29 offen offset:0 sc1 lds
    buffer_load_dwordx4 v2, s[8:11], s29 offen offset:1024 sc1 lds
    buffer_load_dwordx4 v2, s[8:11], s29 offen offset:2048 sc1 lds
    buffer_load_dwordx4 v2, s[8:11], s29 offen offset:3072 sc1 lds
    s_add_u32 m0, 0, 110592
    s_add_u32 s29, s27, 45056
    buffer_load_dwordx4 v2, s[8:11], s29 offen offset:0 sc1 lds
    buffer_load_dwordx4 v2, s[8:11], s29 offen offset:1024 sc1 lds
    buffer_load_dwordx4 v2, s[8:11], s29 offen offset:2048 sc1 lds
    buffer_load_dwordx4 v2, s[8:11], s29 offen offset:3072 sc1 lds
    s_add_u32 m0, 0, 114688
    s_add_u32 s29, s27, 49152
    buffer_load_dwordx4 v2, s[8:11], s29 offen offset:0 sc1 lds
    buffer_load_dwordx4 v2, s[8:11], s29 offen offset:1024 sc1 lds
    buffer_load_dwordx4 v2, s[8:11], s29 offen offset:2048 sc1 lds
    buffer_load_dwordx4 v2, s[8:11], s29 offen offset:3072 sc1 lds
    s_add_u32 m0, 0, 118784
    s_add_u32 s29, s27, 53248
    buffer_load_dwordx4 v2, s[8:11], s29 offen offset:0 sc1 lds
    buffer_load_dwordx4 v2, s[8:11], s29 offen offset:1024 sc1 lds
    buffer_load_dwordx4 v2, s[8:11], s29 offen offset:2048 sc1 lds
    buffer_load_dwordx4 v2, s[8:11], s29 offen offset:3072 sc1 lds
    s_add_u32 m0, 0, 122880
    s_add_u32 s29, s27, 57344
    buffer_load_dwordx4 v2, s[8:11], s29 offen offset:0 sc1 lds
    buffer_load_dwordx4 v2, s[8:11], s29 offen offset:1024 sc1 lds
    buffer_load_dwordx4 v2, s[8:11], s29 offen offset:2048 sc1 lds
    buffer_load_dwordx4 v2, s[8:11], s29 offen offset:3072 sc1 lds
    s_add_u32 m0, 0, 126976
    s_add_u32 s29, s27, 61440
    buffer_load_dwordx4 v2, s[8:11], s29 offen offset:0 sc1 lds
    buffer_load_dwordx4 v2, s[8:11], s29 offen offset:1024 sc1 lds
    buffer_load_dwordx4 v2, s[8:11], s29 offen offset:2048 sc1 lds
    buffer_load_dwordx4 v2, s[8:11], s29 offen offset:3072 sc1 lds
    s_waitcnt vmcnt(32)
    s_barrier
    s_mov_b32 s12, s48
    s_mov_b32 s13, s49
    s_mov_b32 s14, 0x1c0000
    s_mov_b32 s15, 0x00020000
    v_bfe_u32 v8, v0, 2, 3
    v_lshlrev_b32 v8, 10, v8
    v_lshl_add_u32 v8, v11, 6, v8
    v_and_b32 v1, 3, v0
    v_lshl_add_u32 v8, v1, 4, v8
    v_lshlrev_b32 v9, 6, v10
    v_lshl_add_u32 v9, v1, 3, v9
    v_bfe_u32 v1, v0, 4, 1
    v_lshl_add_u32 v9, v1, 5, v9
    v_add_u32 v9, 135168, v9
    v_xor_b32 v7, 64, v8
    s_lshl_b32 s26, s24, 7
    s_and_b32 s52, s23, 1
    s_mul_i32 s27, s52, 114688
    s_add_u32 s27, s27, s26
    s_mov_b32 m0, 135168
    s_add_u32 s29, s27, 1376256
    buffer_load_dwordx4 v7, s[12:15], s29 offen lds
    s_mov_b32 m0, 136192
    s_add_u32 s29, s27, 1384448
    buffer_load_dwordx4 v7, s[12:15], s29 offen lds
    s_mov_b32 m0, 137216
    s_add_u32 s29, s27, 1392640
    buffer_load_dwordx4 v7, s[12:15], s29 offen lds
    s_mov_b32 m0, 138240
    s_add_u32 s29, s27, 1400832
    buffer_load_dwordx4 v7, s[12:15], s29 offen lds
    s_mov_b32 m0, 139264
    s_add_u32 s29, s27, 1409024
    buffer_load_dwordx4 v7, s[12:15], s29 offen lds
    s_mov_b32 m0, 140288
    s_add_u32 s29, s27, 1417216
    buffer_load_dwordx4 v7, s[12:15], s29 offen lds
    s_mov_b32 m0, 141312
    s_add_u32 s29, s27, 1425408
    buffer_load_dwordx4 v7, s[12:15], s29 offen lds
    s_mov_b32 m0, 142336
    s_add_u32 s29, s27, 1433600
    buffer_load_dwordx4 v7, s[12:15], s29 offen lds
    s_mov_b32 m0, 143360
    s_add_u32 s29, s27, 1441792
    buffer_load_dwordx4 v7, s[12:15], s29 offen lds
    s_mov_b32 m0, 144384
    s_add_u32 s29, s27, 1449984
    buffer_load_dwordx4 v7, s[12:15], s29 offen lds
    s_mov_b32 m0, 145408
    s_add_u32 s29, s27, 1458176
    buffer_load_dwordx4 v7, s[12:15], s29 offen lds
    s_mov_b32 m0, 146432
    s_add_u32 s29, s27, 1466368
    buffer_load_dwordx4 v7, s[12:15], s29 offen lds
    s_mov_b32 m0, 147456
    s_add_u32 s29, s27, 1474560
    buffer_load_dwordx4 v7, s[12:15], s29 offen lds
    s_mov_b32 m0, 148480
    s_add_u32 s29, s27, 1482752
    buffer_load_dwordx4 v7, s[12:15], s29 offen lds
    s_mov_b32 m0, 149504
    s_add_u32 s29, s27, 1605632
    buffer_load_dwordx4 v7, s[12:15], s29 offen lds
    s_mov_b32 m0, 150528
    s_add_u32 s29, s27, 1613824
    buffer_load_dwordx4 v7, s[12:15], s29 offen lds
    s_mov_b32 m0, 151552
    s_add_u32 s29, s27, 1622016
    buffer_load_dwordx4 v7, s[12:15], s29 offen lds
    s_mov_b32 m0, 152576
    s_add_u32 s29, s27, 1630208
    buffer_load_dwordx4 v7, s[12:15], s29 offen lds
    s_mov_b32 m0, 153600
    s_add_u32 s29, s27, 1638400
    buffer_load_dwordx4 v7, s[12:15], s29 offen lds
    s_mov_b32 m0, 154624
    s_add_u32 s29, s27, 1646592
    buffer_load_dwordx4 v7, s[12:15], s29 offen lds
    s_mov_b32 m0, 155648
    s_add_u32 s29, s27, 1654784
    buffer_load_dwordx4 v7, s[12:15], s29 offen lds
    s_mov_b32 m0, 156672
    s_add_u32 s29, s27, 1662976
    buffer_load_dwordx4 v7, s[12:15], s29 offen lds
    s_mov_b32 m0, 157696
    s_add_u32 s29, s27, 1671168
    buffer_load_dwordx4 v7, s[12:15], s29 offen lds
    s_mov_b32 m0, 158720
    s_add_u32 s29, s27, 1679360
    buffer_load_dwordx4 v7, s[12:15], s29 offen lds
    s_mov_b32 m0, 159744
    s_add_u32 s29, s27, 1687552
    buffer_load_dwordx4 v7, s[12:15], s29 offen lds
    s_mov_b32 m0, 160768
    s_add_u32 s29, s27, 1695744
    buffer_load_dwordx4 v7, s[12:15], s29 offen lds
    s_mov_b32 m0, 161792
    s_add_u32 s29, s27, 1703936
    buffer_load_dwordx4 v7, s[12:15], s29 offen lds
    s_mov_b32 m0, 162816
    s_add_u32 s29, s27, 1712128
    buffer_load_dwordx4 v7, s[12:15], s29 offen lds
    s_waitcnt vmcnt(28)
    ds_write_b32 v4, v5 offset:24
    s_waitcnt vmcnt(0)
    ds_read_b64_tr_b16 v[128:129], v9 offset:0
    ds_read_b64_tr_b16 v[132:133], v9 offset:512
    ds_read_b64_tr_b16 v[130:131], v9 offset:1024
    ds_read_b64_tr_b16 v[134:135], v9 offset:1536
    ds_read_b64_tr_b16 v[136:137], v9 offset:2048
    ds_read_b64_tr_b16 v[140:141], v9 offset:2560
    ds_read_b64_tr_b16 v[138:139], v9 offset:3072
    ds_read_b64_tr_b16 v[142:143], v9 offset:3584
    ds_read_b64_tr_b16 v[144:145], v9 offset:4096
    ds_read_b64_tr_b16 v[148:149], v9 offset:4608
    ds_read_b64_tr_b16 v[146:147], v9 offset:5120
    ds_read_b64_tr_b16 v[150:151], v9 offset:5632
    ds_read_b64_tr_b16 v[152:153], v9 offset:6144
    ds_read_b64_tr_b16 v[156:157], v9 offset:6656
    ds_read_b64_tr_b16 v[154:155], v9 offset:7168
    ds_read_b64_tr_b16 v[158:159], v9 offset:7680
    ds_read_b64_tr_b16 v[160:161], v9 offset:8192
    ds_read_b64_tr_b16 v[164:165], v9 offset:8704
    ds_read_b64_tr_b16 v[162:163], v9 offset:9216
    ds_read_b64_tr_b16 v[166:167], v9 offset:9728
    ds_read_b64_tr_b16 v[168:169], v9 offset:10240
    ds_read_b64_tr_b16 v[172:173], v9 offset:10752
    ds_read_b64_tr_b16 v[170:171], v9 offset:11264
    ds_read_b64_tr_b16 v[174:175], v9 offset:11776
    ds_read_b64_tr_b16 v[176:177], v9 offset:12288
    ds_read_b64_tr_b16 v[180:181], v9 offset:12800
    ds_read_b64_tr_b16 v[178:179], v9 offset:13312
    ds_read_b64_tr_b16 v[182:183], v9 offset:13824
    ds_read_b64_tr_b16 v[184:185], v9 offset:14336
    ds_read_b64_tr_b16 v[188:189], v9 offset:14848
    ds_read_b64_tr_b16 v[186:187], v9 offset:15360
    ds_read_b64_tr_b16 v[190:191], v9 offset:15872
    ds_read_b64_tr_b16 v[192:193], v9 offset:16384
    ds_read_b64_tr_b16 v[196:197], v9 offset:16896
    ds_read_b64_tr_b16 v[194:195], v9 offset:17408
    ds_read_b64_tr_b16 v[198:199], v9 offset:17920
    ds_read_b64_tr_b16 v[200:201], v9 offset:18432
    ds_read_b64_tr_b16 v[204:205], v9 offset:18944
    ds_read_b64_tr_b16 v[202:203], v9 offset:19456
    ds_read_b64_tr_b16 v[206:207], v9 offset:19968
    ds_read_b64_tr_b16 v[208:209], v9 offset:20480
    ds_read_b64_tr_b16 v[212:213], v9 offset:20992
    ds_read_b64_tr_b16 v[210:211], v9 offset:21504
    ds_read_b64_tr_b16 v[214:215], v9 offset:22016
    ds_read_b64_tr_b16 v[216:217], v9 offset:22528
    ds_read_b64_tr_b16 v[220:221], v9 offset:23040
    ds_read_b64_tr_b16 v[218:219], v9 offset:23552
    ds_read_b64_tr_b16 v[222:223], v9 offset:24064
    ds_read_b64_tr_b16 v[224:225], v9 offset:24576
    ds_read_b64_tr_b16 v[228:229], v9 offset:25088
    ds_read_b64_tr_b16 v[226:227], v9 offset:25600
    ds_read_b64_tr_b16 v[230:231], v9 offset:26112
    ds_read_b64_tr_b16 v[232:233], v9 offset:26624
    ds_read_b64_tr_b16 v[236:237], v9 offset:27136
    ds_read_b64_tr_b16 v[234:235], v9 offset:27648
    ds_read_b64_tr_b16 v[238:239], v9 offset:28160
    s_waitcnt lgkmcnt(0)
    s_xor_b32 s53, s52, 1
    s_mul_i32 s53, s53, 114688
    s_add_u32 s53, s53, s26
    s_mov_b32 m0, 135168
    s_add_u32 s29, s53, 0
    buffer_load_dwordx4 v8, s[12:15], s29 offen lds
    s_mov_b32 m0, 136192
    s_add_u32 s29, s53, 8192
    buffer_load_dwordx4 v8, s[12:15], s29 offen lds
    s_mov_b32 m0, 137216
    s_add_u32 s29, s53, 16384
    buffer_load_dwordx4 v8, s[12:15], s29 offen lds
    s_mov_b32 m0, 138240
    s_add_u32 s29, s53, 24576
    buffer_load_dwordx4 v8, s[12:15], s29 offen lds
    s_mov_b32 m0, 139264
    s_add_u32 s29, s53, 32768
    buffer_load_dwordx4 v8, s[12:15], s29 offen lds
    s_mov_b32 m0, 140288
    s_add_u32 s29, s53, 40960
    buffer_load_dwordx4 v8, s[12:15], s29 offen lds
    s_mov_b32 m0, 141312
    s_add_u32 s29, s53, 49152
    buffer_load_dwordx4 v8, s[12:15], s29 offen lds
    s_mov_b32 m0, 142336
    s_add_u32 s29, s53, 458752
    buffer_load_dwordx4 v7, s[12:15], s29 offen lds
    s_mov_b32 m0, 143360
    s_add_u32 s29, s53, 466944
    buffer_load_dwordx4 v7, s[12:15], s29 offen lds
    s_mov_b32 m0, 144384
    s_add_u32 s29, s53, 475136
    buffer_load_dwordx4 v7, s[12:15], s29 offen lds
    s_mov_b32 m0, 145408
    s_add_u32 s29, s53, 483328
    buffer_load_dwordx4 v7, s[12:15], s29 offen lds
    s_mov_b32 m0, 146432
    s_add_u32 s29, s53, 491520
    buffer_load_dwordx4 v7, s[12:15], s29 offen lds
    s_mov_b32 m0, 147456
    s_add_u32 s29, s53, 499712
    buffer_load_dwordx4 v7, s[12:15], s29 offen lds
    s_mov_b32 m0, 148480
    s_add_u32 s29, s53, 507904
    buffer_load_dwordx4 v7, s[12:15], s29 offen lds
    s_mov_b32 m0, 149504
    s_add_u32 s29, s53, 917504
    buffer_load_dwordx4 v8, s[12:15], s29 offen lds
    s_mov_b32 m0, 150528
    s_add_u32 s29, s53, 925696
    buffer_load_dwordx4 v8, s[12:15], s29 offen lds
    s_mov_b32 m0, 151552
    s_add_u32 s29, s53, 933888
    buffer_load_dwordx4 v8, s[12:15], s29 offen lds
    s_mov_b32 m0, 152576
    s_add_u32 s29, s53, 942080
    buffer_load_dwordx4 v8, s[12:15], s29 offen lds
    s_mov_b32 m0, 153600
    s_add_u32 s29, s53, 950272
    buffer_load_dwordx4 v8, s[12:15], s29 offen lds
    s_mov_b32 m0, 154624
    s_add_u32 s29, s53, 958464
    buffer_load_dwordx4 v8, s[12:15], s29 offen lds
    s_mov_b32 m0, 155648
    s_add_u32 s29, s53, 966656
    buffer_load_dwordx4 v8, s[12:15], s29 offen lds
    s_mov_b32 m0, 156672
    s_add_u32 s29, s53, 1376256
    buffer_load_dwordx4 v7, s[12:15], s29 offen lds
    s_mov_b32 m0, 157696
    s_add_u32 s29, s53, 1384448
    buffer_load_dwordx4 v7, s[12:15], s29 offen lds
    s_mov_b32 m0, 158720
    s_add_u32 s29, s53, 1392640
    buffer_load_dwordx4 v7, s[12:15], s29 offen lds
    s_mov_b32 m0, 159744
    s_add_u32 s29, s53, 1400832
    buffer_load_dwordx4 v7, s[12:15], s29 offen lds
    s_mov_b32 m0, 160768
    s_add_u32 s29, s53, 1409024
    buffer_load_dwordx4 v7, s[12:15], s29 offen lds
    s_mov_b32 m0, 161792
    s_add_u32 s29, s53, 1417216
    buffer_load_dwordx4 v7, s[12:15], s29 offen lds
    s_mov_b32 m0, 162816
    s_add_u32 s29, s53, 1425408
    buffer_load_dwordx4 v7, s[12:15], s29 offen lds
    s_mov_b32 s33, 0
K2_WC0:
    ds_read_b32 v6, v4 offset:0
    s_add_u32 s33, s33, 1
    s_waitcnt lgkmcnt(0)
    v_cmp_eq_u32 vcc, 7, v6
    s_cmp_gt_u32 s33, 0x100000
    s_cbranch_scc1 K2_WX0
    s_cbranch_vccnz K2_WX0
    s_sleep 2
    s_branch K2_WC0
K2_WX0:
    s_mov_b32 m0, 28672
    s_add_u32 s29, s53, 57344
    buffer_load_dwordx4 v8, s[12:15], s29 offen lds
    s_mov_b32 m0, 29696
    s_add_u32 s29, s53, 516096
    buffer_load_dwordx4 v7, s[12:15], s29 offen lds
    s_mov_b32 m0, 30720
    s_add_u32 s29, s53, 974848
    buffer_load_dwordx4 v8, s[12:15], s29 offen lds
    s_mov_b32 m0, 31744
    s_add_u32 s29, s53, 1433600
    buffer_load_dwordx4 v7, s[12:15], s29 offen lds
    s_mov_b32 m0, 0
    s_add_u32 s29, s27, 0
    buffer_load_dwordx4 v8, s[12:15], s29 offen lds
    s_mov_b32 m0, 1024
    s_add_u32 s29, s27, 8192
    buffer_load_dwordx4 v8, s[12:15], s29 offen lds
    s_mov_b32 m0, 2048
    s_add_u32 s29, s27, 16384
    buffer_load_dwordx4 v8, s[12:15], s29 offen lds
    s_mov_b32 m0, 3072
    s_add_u32 s29, s27, 24576
    buffer_load_dwordx4 v8, s[12:15], s29 offen lds
    s_mov_b32 m0, 4096
    s_add_u32 s29, s27, 32768
    buffer_load_dwordx4 v8, s[12:15], s29 offen lds
    s_mov_b32 m0, 5120
    s_add_u32 s29, s27, 40960
    buffer_load_dwordx4 v8, s[12:15], s29 offen lds
    s_mov_b32 m0, 6144
    s_add_u32 s29, s27, 49152
    buffer_load_dwordx4 v8, s[12:15], s29 offen lds
    s_mov_b32 m0, 7168
    s_add_u32 s29, s27, 57344
    buffer_load_dwordx4 v8, s[12:15], s29 offen lds
    s_mov_b32 m0, 8192
    s_add_u32 s29, s27, 65536
    buffer_load_dwordx4 v8, s[12:15], s29 offen lds
    s_mov_b32 m0, 9216
    s_add_u32 s29, s27, 73728
    buffer_load_dwordx4 v8, s[12:15], s29 offen lds
    s_mov_b32 m0, 10240
    s_add_u32 s29, s27, 81920
    buffer_load_dwordx4 v8, s[12:15], s29 offen lds
    s_mov_b32 m0, 11264
    s_add_u32 s29, s27, 90112
    buffer_load_dwordx4 v8, s[12:15], s29 offen lds
    s_mov_b32 m0, 12288
    s_add_u32 s29, s27, 98304
    buffer_load_dwordx4 v8, s[12:15], s29 offen lds
    s_mov_b32 m0, 13312
    s_add_u32 s29, s27, 106496
    buffer_load_dwordx4 v8, s[12:15], s29 offen lds
    s_mov_b32 m0, 14336
    s_add_u32 s29, s27, 229376
    buffer_load_dwordx4 v8, s[12:15], s29 offen lds
    s_mov_b32 m0, 15360
    s_add_u32 s29, s27, 237568
    buffer_load_dwordx4 v8, s[12:15], s29 offen lds
    s_mov_b32 m0, 16384
    s_add_u32 s29, s27, 245760
    buffer_load_dwordx4 v8, s[12:15], s29 offen lds
    s_mov_b32 m0, 17408
    s_add_u32 s29, s27, 253952
    buffer_load_dwordx4 v8, s[12:15], s29 offen lds
    s_mov_b32 m0, 18432
    s_add_u32 s29, s27, 262144
    buffer_load_dwordx4 v8, s[12:15], s29 offen lds
    s_mov_b32 m0, 19456
    s_add_u32 s29, s27, 270336
    buffer_load_dwordx4 v8, s[12:15], s29 offen lds
    s_mov_b32 m0, 20480
    s_add_u32 s29, s27, 278528
    buffer_load_dwordx4 v8, s[12:15], s29 offen lds
    s_mov_b32 m0, 21504
    s_add_u32 s29, s27, 286720
    buffer_load_dwordx4 v8, s[12:15], s29 offen lds
    s_mov_b32 m0, 22528
    s_add_u32 s29, s27, 294912
    buffer_load_dwordx4 v8, s[12:15], s29 offen lds
    s_mov_b32 m0, 23552
    s_add_u32 s29, s27, 303104
    buffer_load_dwordx4 v8, s[12:15], s29 offen lds
    s_mov_b32 m0, 24576
    s_add_u32 s29, s27, 311296
    buffer_load_dwordx4 v8, s[12:15], s29 offen lds
    s_mov_b32 m0, 25600
    s_add_u32 s29, s27, 319488
    buffer_load_dwordx4 v8, s[12:15], s29 offen lds
    s_mov_b32 m0, 26624
    s_add_u32 s29, s27, 327680
    buffer_load_dwordx4 v8, s[12:15], s29 offen lds
    s_mov_b32 m0, 27648
    s_add_u32 s29, s27, 335872
    buffer_load_dwordx4 v8, s[12:15], s29 offen lds
    s_mov_b32 s33, 0
K2_WC1:
    ds_read_b32 v6, v4 offset:4
    s_add_u32 s33, s33, 1
    s_waitcnt lgkmcnt(0)
    v_cmp_eq_u32 vcc, 7, v6
    s_cmp_gt_u32 s33, 0x100000
    s_cbranch_scc1 K2_WX1
    s_cbranch_vccnz K2_WX1
    s_sleep 2
    s_branch K2_WC1
K2_WX1:
    s_mov_b32 m0, 61440
    s_add_u32 s29, s53, 65536
    buffer_load_dwordx4 v8, s[12:15], s29 offen lds
    s_mov_b32 m0, 62464
    s_add_u32 s29, s53, 524288
    buffer_load_dwordx4 v7, s[12:15], s29 offen lds
    s_mov_b32 m0, 63488
    s_add_u32 s29, s53, 983040
    buffer_load_dwordx4 v8, s[12:15], s29 offen lds
    s_mov_b32 m0, 64512
    s_add_u32 s29, s53, 1441792
    buffer_load_dwordx4 v7, s[12:15], s29 offen lds
    s_mov_b32 m0, 32768
    s_add_u32 s29, s27, 458752
    buffer_load_dwordx4 v7, s[12:15], s29 offen lds
    s_mov_b32 m0, 33792
    s_add_u32 s29, s27, 466944
    buffer_load_dwordx4 v7, s[12:15], s29 offen lds
    s_mov_b32 m0, 34816
    s_add_u32 s29, s27, 475136
    buffer_load_dwordx4 v7, s[12:15], s29 offen lds
    s_mov_b32 m0, 35840
    s_add_u32 s29, s27, 483328
    buffer_load_dwordx4 v7, s[12:15], s29 offen lds
    s_mov_b32 m0, 36864
    s_add_u32 s29, s27, 491520
    buffer_load_dwordx4 v7, s[12:15], s29 offen lds
    s_mov_b32 m0, 37888
    s_add_u32 s29, s27, 499712
    buffer_load_dwordx4 v7, s[12:15], s29 offen lds
    s_mov_b32 m0, 38912
    s_add_u32 s29, s27, 507904
    buffer_load_dwordx4 v7, s[12:15], s29 offen lds
    s_mov_b32 m0, 39936
    s_add_u32 s29, s27, 516096
    buffer_load_dwordx4 v7, s[12:15], s29 offen lds
    s_mov_b32 m0, 40960
    s_add_u32 s29, s27, 524288
    buffer_load_dwordx4 v7, s[12:15], s29 offen lds
    s_mov_b32 m0, 41984
    s_add_u32 s29, s27, 532480
    buffer_load_dwordx4 v7, s[12:15], s29 offen lds
    s_mov_b32 m0, 43008
    s_add_u32 s29, s27, 540672
    buffer_load_dwordx4 v7, s[12:15], s29 offen lds
    s_mov_b32 m0, 44032
    s_add_u32 s29, s27, 548864
    buffer_load_dwordx4 v7, s[12:15], s29 offen lds
    s_mov_b32 m0, 45056
    s_add_u32 s29, s27, 557056
    buffer_load_dwordx4 v7, s[12:15], s29 offen lds
    s_mov_b32 m0, 46080
    s_add_u32 s29, s27, 565248
    buffer_load_dwordx4 v7, s[12:15], s29 offen lds
    s_mov_b32 m0, 47104
    s_add_u32 s29, s27, 688128
    buffer_load_dwordx4 v7, s[12:15], s29 offen lds
    s_mov_b32 m0, 48128
    s_add_u32 s29, s27, 696320
    buffer_load_dwordx4 v7, s[12:15], s29 offen lds
    s_mov_b32 m0, 49152
    s_add_u32 s29, s27, 704512
    buffer_load_dwordx4 v7, s[12:15], s29 offen lds
    s_mov_b32 m0, 50176
    s_add_u32 s29, s27, 712704
    buffer_load_dwordx4 v7, s[12:15], s29 offen lds
    s_mov_b32 m0, 51200
    s_add_u32 s29, s27, 720896
    buffer_load_dwordx4 v7, s[12:15], s29 offen lds
    s_mov_b32 m0, 52224
    s_add_u32 s29, s27, 729088
    buffer_load_dwordx4 v7, s[12:15], s29 offen lds
    s_mov_b32 m0, 53248
    s_add_u32 s29, s27, 737280
    buffer_load_dwordx4 v7, s[12:15], s29 offen lds
    s_mov_b32 m0, 54272
    s_add_u32 s29, s27, 745472
    buffer_load_dwordx4 v7, s[12:15], s29 offen lds
    s_mov_b32 m0, 55296
    s_add_u32 s29, s27, 753664
    buffer_load_dwordx4 v7, s[12:15], s29 offen lds
    s_mov_b32 m0, 56320
    s_add_u32 s29, s27, 761856
    buffer_load_dwordx4 v7, s[12:15], s29 offen lds
    s_mov_b32 m0, 57344
    s_add_u32 s29, s27, 770048
    buffer_load_dwordx4 v7, s[12:15], s29 offen lds
    s_mov_b32 m0, 58368
    s_add_u32 s29, s27, 778240
    buffer_load_dwordx4 v7, s[12:15], s29 offen lds
    s_mov_b32 m0, 59392
    s_add_u32 s29, s27, 786432
    buffer_load_dwordx4 v7, s[12:15], s29 offen lds
    s_mov_b32 m0, 60416
    s_add_u32 s29, s27, 794624
    buffer_load_dwordx4 v7, s[12:15], s29 offen lds
    s_lshl_b32 s31, s36, 8
    s_lshl_b32 s33, s37, 2
    s_add_u32 s31, s31, s33
    s_add_u32 s31, s31, 11540608
    v_mov_b32 v12, 0
    v_mov_b32 v13, 1
    s_mov_b32 s33, 0
K2_WCA:
    ds_read_b32 v6, v4 offset:16
    s_add_u32 s33, s33, 1
    s_waitcnt lgkmcnt(0)
    v_cmp_eq_u32 vcc, 7, v6
    s_cmp_gt_u32 s33, 0x100000
    s_cbranch_scc1 K2_WXA
    s_cbranch_vccnz K2_WXA
    s_sleep 2
    s_branch K2_WCA
K2_WXA:
    s_cmp_eq_u32 s22, 7
    s_cbranch_scc0 K2_S4A
    v_lshlrev_b32 v12, 14, v0
    s_mov_b64 exec, 1
    s_and_b32 s31, s31, 0xffffff84
    buffer_atomic_add v13, v12, s[8:11], s31 offen sc1
    s_mov_b64 exec, -1
K2_S4A:
    s_mov_b32 s33, 0
K2_WC2:
    ds_read_b32 v6, v4 offset:8
    s_add_u32 s33, s33, 1
    s_waitcnt lgkmcnt(0)
    v_cmp_eq_u32 vcc, 7, v6
    s_cmp_gt_u32 s33, 0x100000
    s_cbranch_scc1 K2_WX2
    s_cbranch_vccnz K2_WX2
    s_sleep 2
    s_branch K2_WC2
K2_WX2:
    s_mov_b32 m0, 94208
    s_add_u32 s29, s53, 73728
    buffer_load_dwordx4 v8, s[12:15], s29 offen lds
    s_mov_b32 m0, 95232
    s_add_u32 s29, s53, 532480
    buffer_load_dwordx4 v7, s[12:15], s29 offen lds
    s_mov_b32 m0, 96256
    s_add_u32 s29, s53, 991232
    buffer_load_dwordx4 v8, s[12:15], s29 offen lds
    s_mov_b32 m0, 97280
    s_add_u32 s29, s53, 1449984
    buffer_load_dwordx4 v7, s[12:15], s29 offen lds
    s_mov_b32 m0, 65536
    s_add_u32 s29, s27, 917504
    buffer_load_dwordx4 v8, s[12:15], s29 offen lds
    s_mov_b32 m0, 66560
    s_add_u32 s29, s27, 925696
    buffer_load_dwordx4 v8, s[12:15], s29 offen lds
    s_mov_b32 m0, 67584
    s_add_u32 s29, s27, 933888
    buffer_load_dwordx4 v8, s[12:15], s29 offen lds
    s_mov_b32 m0, 68608
    s_add_u32 s29, s27, 942080
    buffer_load_dwordx4 v8, s[12:15], s29 offen lds
    s_mov_b32 m0, 69632
    s_add_u32 s29, s27, 950272
    buffer_load_dwordx4 v8, s[12:15], s29 offen lds
    s_mov_b32 m0, 70656
    s_add_u32 s29, s27, 958464
    buffer_load_dwordx4 v8, s[12:15], s29 offen lds
    s_mov_b32 m0, 71680
    s_add_u32 s29, s27, 966656
    buffer_load_dwordx4 v8, s[12:15], s29 offen lds
    s_mov_b32 m0, 72704
    s_add_u32 s29, s27, 974848
    buffer_load_dwordx4 v8, s[12:15], s29 offen lds
    s_mov_b32 m0, 73728
    s_add_u32 s29, s27, 983040
    buffer_load_dwordx4 v8, s[12:15], s29 offen lds
    s_mov_b32 m0, 74752
    s_add_u32 s29, s27, 991232
    buffer_load_dwordx4 v8, s[12:15], s29 offen lds
    s_mov_b32 m0, 75776
    s_add_u32 s29, s27, 999424
    buffer_load_dwordx4 v8, s[12:15], s29 offen lds
    s_mov_b32 m0, 76800
    s_add_u32 s29, s27, 1007616
    buffer_load_dwordx4 v8, s[12:15], s29 offen lds
    s_mov_b32 m0, 77824
    s_add_u32 s29, s27, 1015808
    buffer_load_dwordx4 v8, s[12:15], s29 offen lds
    s_mov_b32 m0, 78848
    s_add_u32 s29, s27, 1024000
    buffer_load_dwordx4 v8, s[12:15], s29 offen lds
    s_mov_b32 m0, 79872
    s_add_u32 s29, s27, 1146880
    buffer_load_dwordx4 v8, s[12:15], s29 offen lds
    s_mov_b32 m0, 80896
    s_add_u32 s29, s27, 1155072
    buffer_load_dwordx4 v8, s[12:15], s29 offen lds
    s_mov_b32 m0, 81920
    s_add_u32 s29, s27, 1163264
    buffer_load_dwordx4 v8, s[12:15], s29 offen lds
    s_mov_b32 m0, 82944
    s_add_u32 s29, s27, 1171456
    buffer_load_dwordx4 v8, s[12:15], s29 offen lds
    s_mov_b32 m0, 83968
    s_add_u32 s29, s27, 1179648
    buffer_load_dwordx4 v8, s[12:15], s29 offen lds
    s_mov_b32 m0, 84992
    s_add_u32 s29, s27, 1187840
    buffer_load_dwordx4 v8, s[12:15], s29 offen lds
    s_mov_b32 m0, 86016
    s_add_u32 s29, s27, 1196032
    buffer_load_dwordx4 v8, s[12:15], s29 offen lds
    s_mov_b32 m0, 87040
    s_add_u32 s29, s27, 1204224
    buffer_load_dwordx4 v8, s[12:15], s29 offen lds
    s_mov_b32 m0, 88064
    s_add_u32 s29, s27, 1212416
    buffer_load_dwordx4 v8, s[12:15], s29 offen lds
    s_mov_b32 m0, 89088
    s_add_u32 s29, s27, 1220608
    buffer_load_dwordx4 v8, s[12:15], s29 offen lds
    s_mov_b32 m0, 90112
    s_add_u32 s29, s27, 1228800
    buffer_load_dwordx4 v8, s[12:15], s29 offen lds
    s_mov_b32 m0, 91136
    s_add_u32 s29, s27, 1236992
    buffer_load_dwordx4 v8, s[12:15], s29 offen lds
    s_mov_b32 m0, 92160
    s_add_u32 s29, s27, 1245184
    buffer_load_dwordx4 v8, s[12:15], s29 offen lds
    s_mov_b32 m0, 93184
    s_add_u32 s29, s27, 1253376
    buffer_load_dwordx4 v8, s[12:15], s29 offen lds
    s_waitcnt vmcnt(28)
    ds_write_b32 v4, v5 offset:20
    s_branch K2_DOWN
K2_GA:
    s_waitcnt vmcnt(0)
    s_barrier
    s_setprio 1
    ds_read_b128 v[32:35], v2 offset:0
    ds_read_b128 v[36:39], v2 offset:1024
    ds_read_b128 v[40:43], v2 offset:2048
    ds_read_b128 v[44:47], v2 offset:3072
    ds_read_b128 v[48:51], v2 offset:4096
    ds_read_b128 v[52:55], v2 offset:5120
    ds_read_b128 v[56:59], v2 offset:6144
    ds_read_b128 v[60:63], v2 offset:7168
    ds_read_b128 v[64:67], v2 offset:8192
    ds_read_b128 v[68:71], v2 offset:9216
    ds_read_b128 v[72:75], v2 offset:10240
    ds_read_b128 v[76:79], v2 offset:11264
    s_waitcnt lgkmcnt(8)
    v_mfma_f32_32x32x16_bf16 v[16:31], v[128:131], v[32:35], 0
    ds_read_b128 v[32:35], v2 offset:12288
    v_mfma_f32_32x32x16_bf16 v[16:31], v[132:135], v[36:39], v[16:31]
    ds_read_b128 v[36:39], v2 offset:13312
    v_mfma_f32_32x32x16_bf16 v[16:31], v[136:139], v[40:43], v[16:31]
    ds_read_b128 v[40:43], v2 offset:14336
    v_mfma_f32_32x32x16_bf16 v[16:31], v[140:143], v[44:47], v[16:31]
    ds_read_b128 v[44:47], v2 offset:15360
    s_waitcnt lgkmcnt(8)
    v_mfma_f32_32x32x16_bf16 v[16:31], v[144:147], v[48:51], v[16:31]
    ds_read_b128 v[48:51], v2 offset:16384
    v_mfma_f32_32x32x16_bf16 v[16:31], v[148:151], v[52:55], v[16:31]
    ds_read_b128 v[52:55], v2 offset:17408
    v_mfma_f32_32x32x16_bf16 v[16:31], v[152:155], v[56:59], v[16:31]
    ds_read_b128 v[56:59], v2 offset:18432
    v_mfma_f32_32x32x16_bf16 v[16:31], v[156:159], v[60:63], v[16:31]
    ds_read_b128 v[60:63], v2 offset:19456
    s_waitcnt lgkmcnt(8)
    v_mfma_f32_32x32x16_bf16 v[16:31], v[160:163], v[64:67], v[16:31]
    s_setprio 2
    ds_read_b128 v[64:67], v2 offset:20480
    v_mfma_f32_32x32x16_bf16 v[16:31], v[164:167], v[68:71], v[16:31]
    ds_read_b128 v[68:71], v2 offset:21504
    v_mfma_f32_32x32x16_bf16 v[16:31], v[168:171], v[72:75], v[16:31]
    ds_read_b128 v[72:75], v2 offset:22528
    v_mfma_f32_32x32x16_bf16 v[16:31], v[172:175], v[76:79], v[16:31]
    ds_read_b128 v[76:79], v2 offset:23552
    s_waitcnt lgkmcnt(8)
    v_mfma_f32_32x32x16_bf16 v[16:31], v[176:179], v[32:35], v[16:31]
    ds_read_b128 v[32:35], v2 offset:24576
    v_mfma_f32_32x32x16_bf16 v[16:31], v[180:183], v[36:39], v[16:31]
    ds_read_b128 v[36:39], v2 offset:25600
    v_mfma_f32_32x32x16_bf16 v[16:31], v[184:187], v[40:43], v[16:31]
    ds_read_b128 v[40:43], v2 offset:26624
    v_mfma_f32_32x32x16_bf16 v[16:31], v[188:191], v[44:47], v[16:31]
    ds_read_b128 v[44:47], v2 offset:27648
    s_waitcnt lgkmcnt(8)
    v_mfma_f32_32x32x16_bf16 v[16:31], v[192:195], v[48:51], v[16:31]
    ds_read_b128 v[48:51], v2 offset:28672
    v_mfma_f32_32x32x16_bf16 v[16:31], v[196:199], v[52:55], v[16:31]
    ds_read_b128 v[52:55], v2 offset:29696
    v_mfma_f32_32x32x16_bf16 v[16:31], v[200:203], v[56:59], v[16:31]
    ds_read_b128 v[56:59], v2 offset:30720
    v_mfma_f32_32x32x16_bf16 v[16:31], v[204:207], v[60:63], v[16:31]
    ds_read_b128 v[60:63], v2 offset:31744
    s_waitcnt lgkmcnt(8)
    v_mfma_f32_32x32x16_bf16 v[16:31], v[208:211], v[64:67], v[16:31]
    v_mfma_f32_32x32x16_bf16 v[16:31], v[212:215], v[68:71], v[16:31]
    v_mfma_f32_32x32x16_bf16 v[16:31], v[216:219], v[72:75], v[16:31]
    v_mfma_f32_32x32x16_bf16 v[16:31], v[220:223], v[76:79], v[16:31]
    s_waitcnt lgkmcnt(4)
    v_mfma_f32_32x32x16_bf16 v[16:31], v[224:227], v[32:35], v[16:31]
    v_mfma_f32_32x32x16_bf16 v[16:31], v[228:231], v[36:39], v[16:31]
    v_mfma_f32_32x32x16_bf16 v[16:31], v[232:235], v[40:43], v[16:31]
    v_mfma_f32_32x32x16_bf16 v[16:31], v[236:239], v[44:47], v[16:31]
    s_waitcnt lgkmcnt(0)
    v_mfma_f32_32x32x16_bf16 v[16:31], v[240:243], v[48:51], v[16:31]
    s_mov_b64 exec, 1
    ds_add_u32 v4, v5 offset:0
    s_mov_b64 exec, -1
    v_mfma_f32_32x32x16_bf16 v[16:31], v[244:247], v[52:55], v[16:31]
    v_mfma_f32_32x32x16_bf16 v[16:31], v[248:251], v[56:59], v[16:31]
    v_mfma_f32_32x32x16_bf16 v[16:31], v[252:255], v[60:63], v[16:31]
    s_barrier
    ds_read_b128 v[88:91], v8 offset:0
    s_waitcnt lgkmcnt(0)
    v_mov_b32 v92, v88
    v_mov_b32 v93, v88
    s_nop 1
    v_mfma_f32_32x32x16_bf16 v[16:31], v[124:127], v[92:95], v[16:31]
    s_setprio 0
    s_nop 10
    v_mul_f32 v80, v16, v16
    v_mul_f32 v81, v17, v17
    v_mul_f32 v82, v18, v18
    v_mul_f32 v83, v19, v19
    v_mul_f32 v84, v20, v20
    v_mul_f32 v85, v21, v21
    v_mul_f32 v86, v22, v22
    v_mul_f32 v87, v23, v23
    v_fma_f32 v80, v80, v91, v90
    v_fma_f32 v81, v81, v91, v90
    v_fma_f32 v82, v82, v91, v90
    v_fma_f32 v83, v83, v91, v90
    v_fma_f32 v84, v84, v91, v90
    v_fma_f32 v85, v85, v91, v90
    v_fma_f32 v86, v86, v91, v90
    v_fma_f32 v87, v87, v91, v90
    v_mul_f32 v80, v80, v16
    v_mul_f32 v81, v81, v17
    v_mul_f32 v82, v82, v18
    v_mul_f32 v83, v83, v19
    v_mul_f32 v84, v84, v20
    v_mul_f32 v85, v85, v21
    v_mul_f32 v86, v86, v22
    v_mul_f32 v87, v87, v23
    v_exp_f32 v80, v80
    v_mul_f32 v16, v16, v24
    v_exp_f32 v81, v81
    v_mul_f32 v17, v17, v25
    v_exp_f32 v82, v82
    v_mul_f32 v18, v18, v26
    v_exp_f32 v83, v83
    v_mul_f32 v19, v19, v27
    v_exp_f32 v84, v84
    v_mul_f32 v20, v20, v28
    v_exp_f32 v85, v85
    v_mul_f32 v21, v21, v29
    v_exp_f32 v86, v86
    v_mul_f32 v22, v22, v30
    v_exp_f32 v87, v87
    v_mul_f32 v23, v23, v31
    v_fma_f32 v80, v80, v89, v89
    v_fma_f32 v81, v81, v89, v89
    v_fma_f32 v82, v82, v89, v89
    v_fma_f32 v83, v83, v89, v89
    v_fma_f32 v84, v84, v89, v89
    v_fma_f32 v85, v85, v89, v89
    v_fma_f32 v86, v86, v89, v89
    v_fma_f32 v87, v87, v89, v89
    v_rcp_f32 v80, v80
    v_rcp_f32 v81, v81
    v_rcp_f32 v82, v82
    v_rcp_f32 v83, v83
    v_rcp_f32 v84, v84
    v_rcp_f32 v85, v85
    v_rcp_f32 v86, v86
    v_rcp_f32 v87, v87
    s_add_u32 s29, s32, 0
    v_mul_f32 v16, v16, v80
    v_mul_f32 v17, v17, v81
    v_mul_f32 v18, v18, v82
    v_mul_f32 v19, v19, v83
    v_mul_f32 v20, v20, v84
    v_mul_f32 v21, v21, v85
    v_mul_f32 v22, v22, v86
    v_mul_f32 v23, v23, v87
    v_cvt_pk_bf16_f32 v24, v16, v17
    v_cvt_pk_bf16_f32 v25, v18, v19
    v_cvt_pk_bf16_f32 v26, v20, v21
    v_cvt_pk_bf16_f32 v27, v22, v23
    buffer_store_dwordx4 v[24:27], v2, s[8:11], s29 offen sc1
    s_barrier
    s_setprio 1
    ds_read_b128 v[32:35], v2 offset:32768
    ds_read_b128 v[36:39], v2 offset:33792
    ds_read_b128 v[40:43], v2 offset:34816
    ds_read_b128 v[44:47], v2 offset:35840
    ds_read_b128 v[48:51], v2 offset:36864
    ds_read_b128 v[52:55], v2 offset:37888
    ds_read_b128 v[56:59], v2 offset:38912
    ds_read_b128 v[60:63], v2 offset:39936
    ds_read_b128 v[64:67], v2 offset:40960
    ds_read_b128 v[68:71], v2 offset:41984
    ds_read_b128 v[72:75], v2 offset:43008
    ds_read_b128 v[76:79], v2 offset:44032
    s_waitcnt lgkmcnt(8)
    v_mfma_f32_32x32x16_bf16 v[16:31], v[128:131], v[32:35], 0
    ds_read_b128 v[32:35], v2 offset:45056
    v_mfma_f32_32x32x16_bf16 v[16:31], v[132:135], v[36:39], v[16:31]
    ds_read_b128 v[36:39], v2 offset:46080
    v_mfma_f32_32x32x16_bf16 v[16:31], v[136:139], v[40:43], v[16:31]
    ds_read_b128 v[40:43], v2 offset:47104
    v_mfma_f32_32x32x16_bf16 v[16:31], v[140:143], v[44:47], v[16:31]
    ds_read_b128 v[44:47], v2 offset:48128
    s_waitcnt lgkmcnt(8)
    v_mfma_f32_32x32x16_bf16 v[16:31], v[144:147], v[48:51], v[16:31]
    ds_read_b128 v[48:51], v2 offset:49152
    v_mfma_f32_32x32x16_bf16 v[16:31], v[148:151], v[52:55], v[16:31]
    ds_read_b128 v[52:55], v2 offset:50176
    v_mfma_f32_32x32x16_bf16 v[16:31], v[152:155], v[56:59], v[16:31]
    ds_read_b128 v[56:59], v2 offset:51200
    v_mfma_f32_32x32x16_bf16 v[16:31], v[156:159], v[60:63], v[16:31]
    ds_read_b128 v[60:63], v2 offset:52224
    s_waitcnt lgkmcnt(8)
    v_mfma_f32_32x32x16_bf16 v[16:31], v[160:163], v[64:67], v[16:31]
    s_setprio 2
    ds_read_b128 v[64:67], v2 offset:53248
    v_mfma_f32_32x32x16_bf16 v[16:31], v[164:167], v[68:71], v[16:31]
    ds_read_b128 v[68:71], v2 offset:54272
    v_mfma_f32_32x32x16_bf16 v[16:31], v[168:171], v[72:75], v[16:31]
    ds_read_b128 v[72:75], v2 offset:55296
    v_mfma_f32_32x32x16_bf16 v[16:31], v[172:175], v[76:79], v[16:31]
    ds_read_b128 v[76:79], v2 offset:56320
    s_waitcnt lgkmcnt(8)
    v_mfma_f32_32x32x16_bf16 v[16:31], v[176:179], v[32:35], v[16:31]
    ds_read_b128 v[32:35], v2 offset:57344
    v_mfma_f32_32x32x16_bf16 v[16:31], v[180:183], v[36:39], v[16:31]
    ds_read_b128 v[36:39], v2 offset:58368
    v_mfma_f32_32x32x16_bf16 v[16:31], v[184:187], v[40:43], v[16:31]
    ds_read_b128 v[40:43], v2 offset:59392
    v_mfma_f32_32x32x16_bf16 v[16:31], v[188:191], v[44:47], v[16:31]
    ds_read_b128 v[44:47], v2 offset:60416
    s_waitcnt lgkmcnt(8)
    v_mfma_f32_32x32x16_bf16 v[16:31], v[192:195], v[48:51], v[16:31]
    ds_read_b128 v[48:51], v2 offset:61440
    v_mfma_f32_32x32x16_bf16 v[16:31], v[196:199], v[52:55], v[16:31]
    ds_read_b128 v[52:55], v2 offset:62464
    v_mfma_f32_32x32x16_bf16 v[16:31], v[200:203], v[56:59], v[16:31]
    ds_read_b128 v[56:59], v2 offset:63488
    v_mfma_f32_32x32x16_bf16 v[16:31], v[204:207], v[60:63], v[16:31]
    ds_read_b128 v[60:63], v2 offset:64512
    s_waitcnt lgkmcnt(8)
    v_mfma_f32_32x32x16_bf16 v[16:31], v[208:211], v[64:67], v[16:31]
    v_mfma_f32_32x32x16_bf16 v[16:31], v[212:215], v[68:71], v[16:31]
    v_mfma_f32_32x32x16_bf16 v[16:31], v[216:219], v[72:75], v[16:31]
    ds_read_b128 v[88:91], v8 offset:512
    v_mfma_f32_32x32x16_bf16 v[16:31], v[220:223], v[76:79], v[16:31]
    s_waitcnt lgkmcnt(4)
    v_mfma_f32_32x32x16_bf16 v[16:31], v[224:227], v[32:35], v[16:31]
    v_mfma_f32_32x32x16_bf16 v[16:31], v[228:231], v[36:39], v[16:31]
    v_mfma_f32_32x32x16_bf16 v[16:31], v[232:235], v[40:43], v[16:31]
    v_mfma_f32_32x32x16_bf16 v[16:31], v[236:239], v[44:47], v[16:31]
    s_waitcnt lgkmcnt(0)
    v_mfma_f32_32x32x16_bf16 v[16:31], v[240:243], v[48:51], v[16:31]
    s_mov_b64 exec, 1
    ds_add_u32 v4, v5 offset:4
    s_mov_b64 exec, -1
    v_mfma_f32_32x32x16_bf16 v[16:31], v[244:247], v[52:55], v[16:31]
    v_mov_b32 v92, v88
    v_mov_b32 v93, v88
    v_mfma_f32_32x32x16_bf16 v[16:31], v[248:251], v[56:59], v[16:31]
    v_mfma_f32_32x32x16_bf16 v[16:31], v[252:255], v[60:63], v[16:31]
    v_mfma_f32_32x32x16_bf16 v[16:31], v[124:127], v[92:95], v[16:31]
    s_setprio 0
    ds_read_b128 v[32:35], v3 offset:0
    ds_read_b128 v[36:39], v3 offset:1024
    ds_read_b128 v[40:43], v3 offset:2048
    ds_read_b128 v[44:47], v3 offset:3072
    ds_read_b128 v[48:51], v3 offset:4096
    ds_read_b128 v[52:55], v3 offset:5120
    ds_read_b128 v[56:59], v3 offset:6144
    ds_read_b128 v[60:63], v3 offset:7168
    ds_read_b128 v[64:67], v3 offset:8192
    ds_read_b128 v[68:71], v3 offset:9216
    ds_read_b128 v[72:75], v3 offset:10240
    v_mul_f32 v80, v16, v16
    v_mul_f32 v81, v17, v17
    v_mul_f32 v82, v18, v18
    v_mul_f32 v83, v19, v19
    v_mul_f32 v84, v20, v20
    v_mul_f32 v85, v21, v21
    v_mul_f32 v86, v22, v22
    v_mul_f32 v87, v23, v23
    v_fma_f32 v80, v80, v91, v90
    v_fma_f32 v81, v81, v91, v90
    v_fma_f32 v82, v82, v91, v90
    v_fma_f32 v83, v83, v91, v90
    v_fma_f32 v84, v84, v91, v90
    v_fma_f32 v85, v85, v91, v90
    v_fma_f32 v86, v86, v91, v90
    v_fma_f32 v87, v87, v91, v90
    v_mul_f32 v80, v80, v16
    v_mul_f32 v81, v81, v17
    v_mul_f32 v82, v82, v18
    v_mul_f32 v83, v83, v19
    v_mul_f32 v84, v84, v20
    v_mul_f32 v85, v85, v21
    v_mul_f32 v86, v86, v22
    v_mul_f32 v87, v87, v23
    v_exp_f32 v80, v80
    v_mul_f32 v16, v16, v24
    v_exp_f32 v81, v81
    v_mul_f32 v17, v17, v25
    v_exp_f32 v82, v82
    v_mul_f32 v18, v18, v26
    v_exp_f32 v83, v83
    v_mul_f32 v19, v19, v27
    v_exp_f32 v84, v84
    v_mul_f32 v20, v20, v28
    v_exp_f32 v85, v85
    v_mul_f32 v21, v21, v29
    v_exp_f32 v86, v86
    v_mul_f32 v22, v22, v30
    v_exp_f32 v87, v87
    v_mul_f32 v23, v23, v31
    v_fma_f32 v80, v80, v89, v89
    v_fma_f32 v81, v81, v89, v89
    v_fma_f32 v82, v82, v89, v89
    v_fma_f32 v83, v83, v89, v89
    v_fma_f32 v84, v84, v89, v89
    v_fma_f32 v85, v85, v89, v89
    v_fma_f32 v86, v86, v89, v89
    v_fma_f32 v87, v87, v89, v89
    v_rcp_f32 v80, v80
    v_rcp_f32 v81, v81
    v_rcp_f32 v82, v82
    v_rcp_f32 v83, v83
    v_rcp_f32 v84, v84
    v_rcp_f32 v85, v85
    v_rcp_f32 v86, v86
    v_rcp_f32 v87, v87
    s_add_u32 s29, s32, 114688
    v_mul_f32 v16, v16, v80
    v_mul_f32 v17, v17, v81
    v_mul_f32 v18, v18, v82
    v_mul_f32 v19, v19, v83
    v_mul_f32 v20, v20, v84
    v_mul_f32 v21, v21, v85
    v_mul_f32 v22, v22, v86
    v_mul_f32 v23, v23, v87
    v_cvt_pk_bf16_f32 v24, v16, v17
    v_cvt_pk_bf16_f32 v25, v18, v19
    v_cvt_pk_bf16_f32 v26, v20, v21
    v_cvt_pk_bf16_f32 v27, v22, v23
    buffer_store_dwordx4 v[24:27], v2, s[8:11], s29 offen sc1
    s_setprio 1
    ds_read_b128 v[76:79], v3 offset:11264
    s_waitcnt lgkmcnt(8)
    v_mfma_f32_32x32x16_bf16 v[16:31], v[128:131], v[32:35], 0
    ds_read_b128 v[32:35], v3 offset:12288
    v_mfma_f32_32x32x16_bf16 v[16:31], v[132:135], v[36:39], v[16:31]
    ds_read_b128 v[36:39], v3 offset:13312
    v_mfma_f32_32x32x16_bf16 v[16:31], v[136:139], v[40:43], v[16:31]
    ds_read_b128 v[40:43], v3 offset:14336
    v_mfma_f32_32x32x16_bf16 v[16:31], v[140:143], v[44:47], v[16:31]
    ds_read_b128 v[44:47], v3 offset:15360
    s_waitcnt lgkmcnt(8)
    v_mfma_f32_32x32x16_bf16 v[16:31], v[144:147], v[48:51], v[16:31]
    ds_read_b128 v[48:51], v3 offset:16384
    v_mfma_f32_32x32x16_bf16 v[16:31], v[148:151], v[52:55], v[16:31]
    ds_read_b128 v[52:55], v3 offset:17408
    v_mfma_f32_32x32x16_bf16 v[16:31], v[152:155], v[56:59], v[16:31]
    ds_read_b128 v[56:59], v3 offset:18432
    v_mfma_f32_32x32x16_bf16 v[16:31], v[156:159], v[60:63], v[16:31]
    ds_read_b128 v[60:63], v3 offset:19456
    s_waitcnt lgkmcnt(8)
    v_mfma_f32_32x32x16_bf16 v[16:31], v[160:163], v[64:67], v[16:31]
    s_setprio 2
    ds_read_b128 v[64:67], v3 offset:20480
    v_mfma_f32_32x32x16_bf16 v[16:31], v[164:167], v[68:71], v[16:31]
    ds_read_b128 v[68:71], v3 offset:21504
    v_mfma_f32_32x32x16_bf16 v[16:31], v[168:171], v[72:75], v[16:31]
    ds_read_b128 v[72:75], v3 offset:22528
    v_mfma_f32_32x32x16_bf16 v[16:31], v[172:175], v[76:79], v[16:31]
    ds_read_b128 v[76:79], v3 offset:23552
    s_waitcnt lgkmcnt(8)
    v_mfma_f32_32x32x16_bf16 v[16:31], v[176:179], v[32:35], v[16:31]
    s_waitcnt vmcnt(0)
    s_mov_b64 exec, 1
    ds_add_u32 v4, v5 offset:16
    s_mov_b64 exec, -1
    ds_read_b128 v[32:35], v3 offset:24576
    v_mfma_f32_32x32x16_bf16 v[16:31], v[180:183], v[36:39], v[16:31]
    ds_read_b128 v[36:39], v3 offset:25600
    v_mfma_f32_32x32x16_bf16 v[16:31], v[184:187], v[40:43], v[16:31]
    ds_read_b128 v[40:43], v3 offset:26624
    v_mfma_f32_32x32x16_bf16 v[16:31], v[188:191], v[44:47], v[16:31]
    ds_read_b128 v[44:47], v3 offset:27648
    s_waitcnt lgkmcnt(8)
    v_mfma_f32_32x32x16_bf16 v[16:31], v[192:195], v[48:51], v[16:31]
    ds_read_b128 v[48:51], v3 offset:28672
    v_mfma_f32_32x32x16_bf16 v[16:31], v[196:199], v[52:55], v[16:31]
    ds_read_b128 v[52:55], v3 offset:29696
    v_mfma_f32_32x32x16_bf16 v[16:31], v[200:203], v[56:59], v[16:31]
    ds_read_b128 v[56:59], v3 offset:30720
    v_mfma_f32_32x32x16_bf16 v[16:31], v[204:207], v[60:63], v[16:31]
    ds_read_b128 v[60:63], v3 offset:31744
    s_waitcnt lgkmcnt(8)
    v_mfma_f32_32x32x16_bf16 v[16:31], v[208:211], v[64:67], v[16:31]
    v_mfma_f32_32x32x16_bf16 v[16:31], v[212:215], v[68:71], v[16:31]
    v_mfma_f32_32x32x16_bf16 v[16:31], v[216:219], v[72:75], v[16:31]
    ds_read_b128 v[88:91], v8 offset:1024
    v_mfma_f32_32x32x16_bf16 v[16:31], v[220:223], v[76:79], v[16:31]
    s_waitcnt lgkmcnt(4)
    v_mfma_f32_32x32x16_bf16 v[16:31], v[224:227], v[32:35], v[16:31]
    v_mfma_f32_32x32x16_bf16 v[16:31], v[228:231], v[36:39], v[16:31]
    v_mfma_f32_32x32x16_bf16 v[16:31], v[232:235], v[40:43], v[16:31]
    v_mfma_f32_32x32x16_bf16 v[16:31], v[236:239], v[44:47], v[16:31]
    s_waitcnt lgkmcnt(0)
    v_mfma_f32_32x32x16_bf16 v[16:31], v[240:243], v[48:51], v[16:31]
    s_mov_b64 exec, 1
    ds_add_u32 v4, v5 offset:8
    s_mov_b64 exec, -1
    v_mfma_f32_32x32x16_bf16 v[16:31], v[244:247], v[52:55], v[16:31]
    v_mov_b32 v92, v88
    v_mov_b32 v93, v88
    v_mfma_f32_32x32x16_bf16 v[16:31], v[248:251], v[56:59], v[16:31]
    v_mfma_f32_32x32x16_bf16 v[16:31], v[252:255], v[60:63], v[16:31]
    v_mfma_f32_32x32x16_bf16 v[16:31], v[124:127], v[92:95], v[16:31]
    s_setprio 0
    s_mov_b32 s33, 0
K2_WCT2:
    ds_read_b32 v6, v4 offset:24
    s_add_u32 s33, s33, 1
    s_waitcnt lgkmcnt(0)
    v_cmp_eq_u32 vcc, 1, v6
    s_cmp_gt_u32 s33, 0x100000
    s_cbranch_scc1 K2_WXT2
    s_cbranch_vccnz K2_WXT2
    s_sleep 2
    s_branch K2_WCT2
K2_WXT2:
    ds_read_b128 v[32:35], v3 offset:32768
    ds_read_b128 v[36:39], v3 offset:33792
    ds_read_b128 v[40:43], v3 offset:34816
    ds_read_b128 v[44:47], v3 offset:35840
    ds_read_b128 v[48:51], v3 offset:36864
    ds_read_b128 v[52:55], v3 offset:37888
    ds_read_b128 v[56:59], v3 offset:38912
    ds_read_b128 v[60:63], v3 offset:39936
    ds_read_b128 v[64:67], v3 offset:40960
    ds_read_b128 v[68:71], v3 offset:41984
    ds_read_b128 v[72:75], v3 offset:43008
    v_mul_f32 v80, v16, v16
    v_mul_f32 v81, v17, v17
    v_mul_f32 v82, v18, v18
    v_mul_f32 v83, v19, v19
    v_mul_f32 v84, v20, v20
    v_mul_f32 v85, v21, v21
    v_mul_f32 v86, v22, v22
    v_mul_f32 v87, v23, v23
    v_fma_f32 v80, v80, v91, v90
    v_fma_f32 v81, v81, v91, v90
    v_fma_f32 v82, v82, v91, v90
    v_fma_f32 v83, v83, v91, v90
    v_fma_f32 v84, v84, v91, v90
    v_fma_f32 v85, v85, v91, v90
    v_fma_f32 v86, v86, v91, v90
    v_fma_f32 v87, v87, v91, v90
    v_mul_f32 v80, v80, v16
    v_mul_f32 v81, v81, v17
    v_mul_f32 v82, v82, v18
    v_mul_f32 v83, v83, v19
    v_mul_f32 v84, v84, v20
    v_mul_f32 v85, v85, v21
    v_mul_f32 v86, v86, v22
    v_mul_f32 v87, v87, v23
    v_exp_f32 v80, v80
    v_mul_f32 v16, v16, v24
    v_exp_f32 v81, v81
    v_mul_f32 v17, v17, v25
    v_exp_f32 v82, v82
    v_mul_f32 v18, v18, v26
    v_exp_f32 v83, v83
    v_mul_f32 v19, v19, v27
    v_exp_f32 v84, v84
    v_mul_f32 v20, v20, v28
    v_exp_f32 v85, v85
    v_mul_f32 v21, v21, v29
    v_exp_f32 v86, v86
    v_mul_f32 v22, v22, v30
    v_exp_f32 v87, v87
    v_mul_f32 v23, v23, v31
    v_fma_f32 v80, v80, v89, v89
    v_fma_f32 v81, v81, v89, v89
    v_fma_f32 v82, v82, v89, v89
    v_fma_f32 v83, v83, v89, v89
    v_fma_f32 v84, v84, v89, v89
    v_fma_f32 v85, v85, v89, v89
    v_fma_f32 v86, v86, v89, v89
    v_fma_f32 v87, v87, v89, v89
    v_rcp_f32 v80, v80
    v_rcp_f32 v81, v81
    v_rcp_f32 v82, v82
    v_rcp_f32 v83, v83
    v_rcp_f32 v84, v84
    v_rcp_f32 v85, v85
    v_rcp_f32 v86, v86
    v_rcp_f32 v87, v87
    s_add_u32 s29, s56, 0
    v_mul_f32 v16, v16, v80
    v_mul_f32 v17, v17, v81
    v_mul_f32 v18, v18, v82
    v_mul_f32 v19, v19, v83
    v_mul_f32 v20, v20, v84
    v_mul_f32 v21, v21, v85
    v_mul_f32 v22, v22, v86
    v_mul_f32 v23, v23, v87
    v_cvt_pk_bf16_f32 v24, v16, v17
    v_cvt_pk_bf16_f32 v25, v18, v19
    v_cvt_pk_bf16_f32 v26, v20, v21
    v_cvt_pk_bf16_f32 v27, v22, v23
    buffer_store_dwordx4 v[24:27], v2, s[8:11], s29 offen sc1
    s_setprio 1
    ds_read_b128 v[76:79], v3 offset:44032
    s_waitcnt lgkmcnt(8)
    v_mfma_f32_32x32x16_bf16 v[16:31], v[128:131], v[32:35], 0
    ds_read_b128 v[32:35], v3 offset:45056
    v_mfma_f32_32x32x16_bf16 v[16:31], v[132:135], v[36:39], v[16:31]
    ds_read_b128 v[36:39], v3 offset:46080
    v_mfma_f32_32x32x16_bf16 v[16:31], v[136:139], v[40:43], v[16:31]
    ds_read_b128 v[40:43], v3 offset:47104
    v_mfma_f32_32x32x16_bf16 v[16:31], v[140:143], v[44:47], v[16:31]
    ds_read_b128 v[44:47], v3 offset:48128
    s_waitcnt lgkmcnt(8)
    v_mfma_f32_32x32x16_bf16 v[16:31], v[144:147], v[48:51], v[16:31]
    ds_read_b128 v[48:51], v3 offset:49152
    v_mfma_f32_32x32x16_bf16 v[16:31], v[148:151], v[52:55], v[16:31]
    ds_read_b128 v[52:55], v3 offset:50176
    v_mfma_f32_32x32x16_bf16 v[16:31], v[152:155], v[56:59], v[16:31]
    ds_read_b128 v[56:59], v3 offset:51200
    v_mfma_f32_32x32x16_bf16 v[16:31], v[156:159], v[60:63], v[16:31]
    ds_read_b128 v[60:63], v3 offset:52224
    s_waitcnt lgkmcnt(8)
    v_mfma_f32_32x32x16_bf16 v[16:31], v[160:163], v[64:67], v[16:31]
    s_setprio 2
    ds_read_b128 v[64:67], v3 offset:53248
    v_mfma_f32_32x32x16_bf16 v[16:31], v[164:167], v[68:71], v[16:31]
    ds_read_b128 v[68:71], v3 offset:54272
    v_mfma_f32_32x32x16_bf16 v[16:31], v[168:171], v[72:75], v[16:31]
    ds_read_b128 v[72:75], v3 offset:55296
    v_mfma_f32_32x32x16_bf16 v[16:31], v[172:175], v[76:79], v[16:31]
    ds_read_b128 v[76:79], v3 offset:56320
    s_waitcnt lgkmcnt(8)
    v_mfma_f32_32x32x16_bf16 v[16:31], v[176:179], v[32:35], v[16:31]
    ds_read_b128 v[32:35], v3 offset:57344
    v_mfma_f32_32x32x16_bf16 v[16:31], v[180:183], v[36:39], v[16:31]
    ds_read_b128 v[36:39], v3 offset:58368
    v_mfma_f32_32x32x16_bf16 v[16:31], v[184:187], v[40:43], v[16:31]
    ds_read_b128 v[40:43], v3 offset:59392
    v_mfma_f32_32x32x16_bf16 v[16:31], v[188:191], v[44:47], v[16:31]
    ds_read_b128 v[44:47], v3 offset:60416
    s_waitcnt lgkmcnt(8)
    v_mfma_f32_32x32x16_bf16 v[16:31], v[192:195], v[48:51], v[16:31]
    ds_read_b128 v[48:51], v3 offset:61440
    v_mfma_f32_32x32x16_bf16 v[16:31], v[196:199], v[52:55], v[16:31]
    ds_read_b128 v[52:55], v3 offset:62464
    v_mfma_f32_32x32x16_bf16 v[16:31], v[200:203], v[56:59], v[16:31]
    ds_read_b128 v[56:59], v3 offset:63488
    v_mfma_f32_32x32x16_bf16 v[16:31], v[204:207], v[60:63], v[16:31]
    ds_read_b128 v[60:63], v3 offset:64512
    s_waitcnt lgkmcnt(8)
    v_mfma_f32_32x32x16_bf16 v[16:31], v[208:211], v[64:67], v[16:31]
    v_mfma_f32_32x32x16_bf16 v[16:31], v[212:215], v[68:71], v[16:31]
    v_mfma_f32_32x32x16_bf16 v[16:31], v[216:219], v[72:75], v[16:31]
    ds_read_b128 v[88:91], v8 offset:1536
    v_mfma_f32_32x32x16_bf16 v[16:31], v[220:223], v[76:79], v[16:31]
    s_waitcnt lgkmcnt(4)
    v_mfma_f32_32x32x16_bf16 v[16:31], v[224:227], v[32:35], v[16:31]
    v_mfma_f32_32x32x16_bf16 v[16:31], v[228:231], v[36:39], v[16:31]
    v_mfma_f32_32x32x16_bf16 v[16:31], v[232:235], v[40:43], v[16:31]
    v_mfma_f32_32x32x16_bf16 v[16:31], v[236:239], v[44:47], v[16:31]
    s_waitcnt lgkmcnt(0)
    v_mfma_f32_32x32x16_bf16 v[16:31], v[240:243], v[48:51], v[16:31]
    v_mfma_f32_32x32x16_bf16 v[16:31], v[244:247], v[52:55], v[16:31]
    v_mov_b32 v92, v88
    v_mov_b32 v93, v88
    v_mfma_f32_32x32x16_bf16 v[16:31], v[248:251], v[56:59], v[16:31]
    v_mfma_f32_32x32x16_bf16 v[16:31], v[252:255], v[60:63], v[16:31]
    v_mfma_f32_32x32x16_bf16 v[16:31], v[124:127], v[92:95], v[16:31]
    s_setprio 0
    s_nop 10
    v_mul_f32 v80, v16, v16
    v_mul_f32 v81, v17, v17
    v_mul_f32 v82, v18, v18
    v_mul_f32 v83, v19, v19
    v_mul_f32 v84, v20, v20
    v_mul_f32 v85, v21, v21
    v_mul_f32 v86, v22, v22
    v_mul_f32 v87, v23, v23
    v_fma_f32 v80, v80, v91, v90
    v_fma_f32 v81, v81, v91, v90
    v_fma_f32 v82, v82, v91, v90
    v_fma_f32 v83, v83, v91, v90
    v_fma_f32 v84, v84, v91, v90
    v_fma_f32 v85, v85, v91, v90
    v_fma_f32 v86, v86, v91, v90
    v_fma_f32 v87, v87, v91, v90
    v_mul_f32 v80, v80, v16
    v_mul_f32 v81, v81, v17
    v_mul_f32 v82, v82, v18
    v_mul_f32 v83, v83, v19
    v_mul_f32 v84, v84, v20
    v_mul_f32 v85, v85, v21
    v_mul_f32 v86, v86, v22
    v_mul_f32 v87, v87, v23
    v_exp_f32 v80, v80
    v_mul_f32 v16, v16, v24
    v_exp_f32 v81, v81
    v_mul_f32 v17, v17, v25
    v_exp_f32 v82, v82
    v_mul_f32 v18, v18, v26
    v_exp_f32 v83, v83
    v_mul_f32 v19, v19, v27
    v_exp_f32 v84, v84
    v_mul_f32 v20, v20, v28
    v_exp_f32 v85, v85
    v_mul_f32 v21, v21, v29
    v_exp_f32 v86, v86
    v_mul_f32 v22, v22, v30
    v_exp_f32 v87, v87
    v_mul_f32 v23, v23, v31
    v_fma_f32 v80, v80, v89, v89
    v_fma_f32 v81, v81, v89, v89
    v_fma_f32 v82, v82, v89, v89
    v_fma_f32 v83, v83, v89, v89
    v_fma_f32 v84, v84, v89, v89
    v_fma_f32 v85, v85, v89, v89
    v_fma_f32 v86, v86, v89, v89
    v_fma_f32 v87, v87, v89, v89
    v_rcp_f32 v80, v80
    v_rcp_f32 v81, v81
    v_rcp_f32 v82, v82
    v_rcp_f32 v83, v83
    v_rcp_f32 v84, v84
    v_rcp_f32 v85, v85
    v_rcp_f32 v86, v86
    v_rcp_f32 v87, v87
    s_add_u32 s29, s56, 114688
    v_mul_f32 v16, v16, v80
    v_mul_f32 v17, v17, v81
    v_mul_f32 v18, v18, v82
    v_mul_f32 v19, v19, v83
    v_mul_f32 v20, v20, v84
    v_mul_f32 v21, v21, v85
    v_mul_f32 v22, v22, v86
    v_mul_f32 v23, v23, v87
    v_cvt_pk_bf16_f32 v24, v16, v17
    v_cvt_pk_bf16_f32 v25, v18, v19
    v_cvt_pk_bf16_f32 v26, v20, v21
    v_cvt_pk_bf16_f32 v27, v22, v23
    buffer_store_dwordx4 v[24:27], v2, s[8:11], s29 offen sc1
K2_DOWN:
    s_mov_b32 s12, s48
    s_mov_b32 s13, s49
    s_mov_b32 s14, 0x1c0000
    s_mov_b32 s15, 0x00020000
    s_mov_b32 s16, s62
    s_mov_b32 s17, s63
    s_mov_b32 s18, 0x200000
    s_mov_b32 s19, 0x00020000
    s_lshl_b32 s31, s36, 8
    s_lshl_b32 s33, s37, 2
    s_add_u32 s31, s31, s33
    s_add_u32 s31, s31, 11540480
    s_and_b32 s26, s22, 1
    s_bfe_u32 s27, s22, 0x10001
    s_lshl_b32 s28, s24, 1
    s_add_u32 s28, s28, s26
    s_lshl_b32 s30, s23, 1
    s_add_u32 s30, s30, s27
    s_lshr_b32 s33, s22, 2
    s_xor_b32 s33, s33, s23
    s_and_b32 s33, s33, 1
    s_xor_b32 s57, s33, 1
    s_lshl_b32 s33, s25, 2
    s_add_u32 s33, s33, s57
    s_mul_i32 s29, s33, 7168
    s_mul_i32 s52, s30, 114688
    s_add_u32 s52, s52, s29
    s_add_u32 s52, s52, 18874368
    s_xor_b32 s53, s30, 1
    s_mul_i32 s53, s53, 114688
    s_add_u32 s53, s53, s29
    s_add_u32 s53, s53, 18874368
    s_mul_i32 s29, s33, 114688
    s_lshl_b32 s54, s24, 7
    s_add_u32 s54, s54, s29
    s_lshl_b32 s55, s26, 6
    s_lshl_b32 s32, s22, 12
    v_bfe_u32 v8, v0, 2, 3
    v_lshlrev_b32 v8, 10, v8
    v_lshl_add_u32 v8, v11, 6, v8
    v_and_b32 v1, 3, v0
    v_lshl_add_u32 v8, v1, 4, v8
    v_lshlrev_b32 v9, 6, v10
    v_lshl_add_u32 v9, v1, 3, v9
    v_bfe_u32 v1, v0, 4, 1
    v_lshl_add_u32 v9, v1, 5, v9
    v_xor_b32 v8, s55, v8
    v_mov_b32 v12, 0
    v_mov_b32 v13, 1
    v_and_b32 v3, 31, v0
    v_lshlrev_b32 v3, 10, v3
    v_lshl_add_u32 v3, v11, 4, v3
    s_cmp_lt_u32 s22, 4
    s_cbranch_scc1 K2_DLO
    s_lshl_b32 s29, s25, 15
    v_add_u32 v9, s29, v9
    v_mov_b32 v14, 133120
    s_xor_b32 s29, s25, 0
    s_lshl_b32 s29, s29, 15
    s_add_u32 s29, s29, s32
    v_add_u32 v4, s29, v2
    s_xor_b32 s29, s25, 1
    s_lshl_b32 s29, s29, 15
    s_add_u32 s29, s29, s32
    v_add_u32 v5, s29, v2
    s_xor_b32 s29, s25, 2
    s_lshl_b32 s29, s29, 15
    s_add_u32 s29, s29, s32
    v_add_u32 v6, s29, v2
    s_xor_b32 s29, s25, 3
    s_lshl_b32 s29, s29, 15
    s_add_u32 s29, s29, s32
    v_add_u32 v7, s29, v2
    s_waitcnt vmcnt(0)
K2_UZ:
    s_barrier
    s_cmp_eq_u32 s22, 7
    s_cbranch_scc0 K2_S4
    v_lshlrev_b32 v12, 14, v0
    s_mov_b64 exec, 1
    s_and_b32 s31, s31, 0xffffff84
    buffer_atomic_add v13, v12, s[8:11], s31 offen sc1
    s_mov_b64 exec, -1
K2_S4:
    buffer_load_dwordx4 v[80:83], v2, s[8:11], s52 offen offset:0 sc1
    buffer_load_dwordx4 v[84:87], v2, s[8:11], s53 offen offset:0 sc1
    buffer_load_dwordx4 v[88:91], v2, s[8:11], s52 offen offset:1024 sc1
    buffer_load_dwordx4 v[92:95], v2, s[8:11], s53 offen offset:1024 sc1
    buffer_load_dwordx4 v[96:99], v2, s[8:11], s52 offen offset:2048 sc1
    buffer_load_dwordx4 v[100:103], v2, s[8:11], s53 offen offset:2048 sc1
    buffer_load_dwordx4 v[104:107], v2, s[8:11], s52 offen offset:3072 sc1
    buffer_load_dwordx4 v[108:111], v2, s[8:11], s53 offen offset:3072 sc1
    s_add_u32 s52, s52, 4096
    s_add_u32 s53, s53, 4096
    buffer_load_dwordx4 v[240:243], v2, s[8:11], s52 offen offset:0 sc1
    buffer_load_dwordx4 v[244:247], v2, s[8:11], s53 offen offset:0 sc1
    buffer_load_dwordx4 v[248:251], v2, s[8:11], s52 offen offset:1024 sc1
    buffer_load_dwordx4 v[252:255], v2, s[8:11], s53 offen offset:1024 sc1
    buffer_load_dwordx4 v[120:123], v2, s[8:11], s52 offen offset:2048 sc1
    buffer_load_dwordx4 v[124:127], v2, s[8:11], s53 offen offset:2048 sc1
    s_cmp_eq_u32 s22, 7
    s_cbranch_scc1 K2_D7
    ds_read_b64_tr_b16 v[128:129], v9 offset:0
    ds_read_b64_tr_b16 v[132:133], v9 offset:512
    ds_read_b64_tr_b16 v[130:131], v9 offset:1024
    ds_read_b64_tr_b16 v[134:135], v9 offset:1536
    ds_read_b64_tr_b16 v[136:137], v9 offset:2048
    ds_read_b64_tr_b16 v[140:141], v9 offset:2560
    ds_read_b64_tr_b16 v[138:139], v9 offset:3072
    ds_read_b64_tr_b16 v[142:143], v9 offset:3584
    ds_read_b64_tr_b16 v[144:145], v9 offset:4096
    ds_read_b64_tr_b16 v[148:149], v9 offset:4608
    ds_read_b64_tr_b16 v[146:147], v9 offset:5120
    ds_read_b64_tr_b16 v[150:151], v9 offset:5632
    ds_read_b64_tr_b16 v[152:153], v9 offset:6144
    ds_read_b64_tr_b16 v[156:157], v9 offset:6656
    ds_read_b64_tr_b16 v[154:155], v9 offset:7168
    ds_read_b64_tr_b16 v[158:159], v9 offset:7680
    ds_read_b64_tr_b16 v[160:161], v9 offset:8192
    ds_read_b64_tr_b16 v[164:165], v9 offset:8704
    ds_read_b64_tr_b16 v[162:163], v9 offset:9216
    ds_read_b64_tr_b16 v[166:167], v9 offset:9728
    ds_read_b64_tr_b16 v[168:169], v9 offset:10240
    ds_read_b64_tr_b16 v[172:173], v9 offset:10752
    ds_read_b64_tr_b16 v[170:171], v9 offset:11264
    ds_read_b64_tr_b16 v[174:175], v9 offset:11776
    ds_read_b64_tr_b16 v[176:177], v9 offset:12288
    ds_read_b64_tr_b16 v[180:181], v9 offset:12800
    ds_read_b64_tr_b16 v[178:179], v9 offset:13312
    ds_read_b64_tr_b16 v[182:183], v9 offset:13824
    ds_read_b64_tr_b16 v[184:185], v9 offset:14336
    ds_read_b64_tr_b16 v[188:189], v9 offset:14848
    ds_read_b64_tr_b16 v[186:187], v9 offset:15360
    ds_read_b64_tr_b16 v[190:191], v9 offset:15872
    ds_read_b64_tr_b16 v[192:193], v9 offset:16384
    ds_read_b64_tr_b16 v[196:197], v9 offset:16896
    ds_read_b64_tr_b16 v[194:195], v9 offset:17408
    ds_read_b64_tr_b16 v[198:199], v9 offset:17920
    ds_read_b64_tr_b16 v[200:201], v9 offset:18432
    ds_read_b64_tr_b16 v[204:205], v9 offset:18944
    ds_read_b64_tr_b16 v[202:203], v9 offset:19456
    ds_read_b64_tr_b16 v[206:207], v9 offset:19968
    ds_read_b64_tr_b16 v[208:209], v9 offset:20480
    ds_read_b64_tr_b16 v[212:213], v9 offset:20992
    ds_read_b64_tr_b16 v[210:211], v9 offset:21504
    ds_read_b64_tr_b16 v[214:215], v9 offset:22016
    ds_read_b64_tr_b16 v[216:217], v9 offset:22528
    ds_read_b64_tr_b16 v[220:221], v9 offset:23040
    ds_read_b64_tr_b16 v[218:219], v9 offset:23552
    ds_read_b64_tr_b16 v[222:223], v9 offset:24064
    ds_read_b64_tr_b16 v[224:225], v9 offset:24576
    ds_read_b64_tr_b16 v[228:229], v9 offset:25088
    ds_read_b64_tr_b16 v[226:227], v9 offset:25600
    ds_read_b64_tr_b16 v[230:231], v9 offset:26112
    ds_read_b64_tr_b16 v[232:233], v9 offset:26624
    ds_read_b64_tr_b16 v[236:237], v9 offset:27136
    ds_read_b64_tr_b16 v[234:235], v9 offset:27648
    ds_read_b64_tr_b16 v[238:239], v9 offset:28160
K2_D7:
    s_waitcnt lgkmcnt(0)
    s_mov_b64 exec, 1
    ds_add_u32 v14, v13 offset:28
    s_mov_b64 exec, -1
    s_setprio 2
    s_waitcnt vmcnt(12)
    v_mfma_f32_32x32x16_bf16 v[48:63], v[128:131], v[84:87], 0
    v_mfma_f32_32x32x16_bf16 v[32:47], v[132:135], v[80:83], 0
    v_mfma_f32_32x32x16_bf16 v[64:79], v[132:135], v[84:87], 0
    v_mfma_f32_32x32x16_bf16 v[16:31], v[128:131], v[80:83], 0
    s_add_u32 s52, s52, 10240
    s_add_u32 s53, s53, 10240
    buffer_load_dwordx4 v[80:83], v2, s[8:11], s52 offen offset:0 sc1
    buffer_load_dwordx4 v[84:87], v2, s[8:11], s53 offen offset:0 sc1
    s_waitcnt vmcnt(12)
    v_mfma_f32_32x32x16_bf16 v[48:63], v[136:139], v[92:95], v[48:63]
    v_mfma_f32_32x32x16_bf16 v[32:47], v[140:143], v[88:91], v[32:47]
    v_mfma_f32_32x32x16_bf16 v[64:79], v[140:143], v[92:95], v[64:79]
    v_mfma_f32_32x32x16_bf16 v[16:31], v[136:139], v[88:91], v[16:31]
    buffer_load_dwordx4 v[88:91], v2, s[8:11], s52 offen offset:1024 sc1
    buffer_load_dwordx4 v[92:95], v2, s[8:11], s53 offen offset:1024 sc1
    s_waitcnt vmcnt(12)
    v_mfma_f32_32x32x16_bf16 v[48:63], v[144:147], v[100:103], v[48:63]
    v_mfma_f32_32x32x16_bf16 v[32:47], v[148:151], v[96:99], v[32:47]
    v_mfma_f32_32x32x16_bf16 v[64:79], v[148:151], v[100:103], v[64:79]
    v_mfma_f32_32x32x16_bf16 v[16:31], v[144:147], v[96:99], v[16:31]
    buffer_load_dwordx4 v[96:99], v2, s[8:11], s52 offen offset:2048 sc1
    buffer_load_dwordx4 v[100:103], v2, s[8:11], s53 offen offset:2048 sc1
    s_waitcnt vmcnt(12)
    v_mfma_f32_32x32x16_bf16 v[48:63], v[152:155], v[108:111], v[48:63]
    v_mfma_f32_32x32x16_bf16 v[32:47], v[156:159], v[104:107], v[32:47]
    v_mfma_f32_32x32x16_bf16 v[64:79], v[156:159], v[108:111], v[64:79]
    v_mfma_f32_32x32x16_bf16 v[16:31], v[152:155], v[104:107], v[16:31]
    buffer_load_dwordx4 v[104:107], v2, s[8:11], s52 offen offset:3072 sc1
    buffer_load_dwordx4 v[108:111], v2, s[8:11], s53 offen offset:3072 sc1
    s_barrier
    s_waitcnt vmcnt(12)
    v_mfma_f32_32x32x16_bf16 v[48:63], v[160:163], v[244:247], v[48:63]
    v_mfma_f32_32x32x16_bf16 v[32:47], v[164:167], v[240:243], v[32:47]
    v_mfma_f32_32x32x16_bf16 v[64:79], v[164:167], v[244:247], v[64:79]
    v_mfma_f32_32x32x16_bf16 v[16:31], v[160:163], v[240:243], v[16:31]
    s_add_u32 s52, s52, 4096
    s_add_u32 s53, s53, 4096
    buffer_load_dwordx4 v[240:243], v2, s[8:11], s52 offen offset:0 sc1
    buffer_load_dwordx4 v[244:247], v2, s[8:11], s53 offen offset:0 sc1
    s_waitcnt vmcnt(12)
    v_mfma_f32_32x32x16_bf16 v[48:63], v[168:171], v[252:255], v[48:63]
    v_mfma_f32_32x32x16_bf16 v[32:47], v[172:175], v[248:251], v[32:47]
    v_mfma_f32_32x32x16_bf16 v[64:79], v[172:175], v[252:255], v[64:79]
    v_mfma_f32_32x32x16_bf16 v[16:31], v[168:171], v[248:251], v[16:31]
    buffer_load_dwordx4 v[248:251], v2, s[8:11], s52 offen offset:1024 sc1
    buffer_load_dwordx4 v[252:255], v2, s[8:11], s53 offen offset:1024 sc1
    s_waitcnt vmcnt(12)
    v_mfma_f32_32x32x16_bf16 v[48:63], v[176:179], v[124:127], v[48:63]
    v_mfma_f32_32x32x16_bf16 v[32:47], v[180:183], v[120:123], v[32:47]
    v_mfma_f32_32x32x16_bf16 v[64:79], v[180:183], v[124:127], v[64:79]
    v_mfma_f32_32x32x16_bf16 v[16:31], v[176:179], v[120:123], v[16:31]
    buffer_load_dwordx4 v[120:123], v2, s[8:11], s52 offen offset:2048 sc1
    buffer_load_dwordx4 v[124:127], v2, s[8:11], s53 offen offset:2048 sc1
    s_waitcnt vmcnt(12)
    v_mfma_f32_32x32x16_bf16 v[48:63], v[184:187], v[84:87], v[48:63]
    v_mfma_f32_32x32x16_bf16 v[32:47], v[188:191], v[80:83], v[32:47]
    v_mfma_f32_32x32x16_bf16 v[64:79], v[188:191], v[84:87], v[64:79]
    v_mfma_f32_32x32x16_bf16 v[16:31], v[184:187], v[80:83], v[16:31]
    s_waitcnt vmcnt(10)
    v_mfma_f32_32x32x16_bf16 v[48:63], v[192:195], v[92:95], v[48:63]
    v_mfma_f32_32x32x16_bf16 v[32:47], v[196:199], v[88:91], v[32:47]
    v_mfma_f32_32x32x16_bf16 v[64:79], v[196:199], v[92:95], v[64:79]
    v_mfma_f32_32x32x16_bf16 v[16:31], v[192:195], v[88:91], v[16:31]
    s_waitcnt vmcnt(8)
    v_mfma_f32_32x32x16_bf16 v[48:63], v[200:203], v[100:103], v[48:63]
    v_mfma_f32_32x32x16_bf16 v[32:47], v[204:207], v[96:99], v[32:47]
    v_mfma_f32_32x32x16_bf16 v[64:79], v[204:207], v[100:103], v[64:79]
    v_mfma_f32_32x32x16_bf16 v[16:31], v[200:203], v[96:99], v[16:31]
    s_waitcnt vmcnt(6)
    v_mfma_f32_32x32x16_bf16 v[48:63], v[208:211], v[108:111], v[48:63]
    v_mfma_f32_32x32x16_bf16 v[32:47], v[212:215], v[104:107], v[32:47]
    v_mfma_f32_32x32x16_bf16 v[64:79], v[212:215], v[108:111], v[64:79]
    v_mfma_f32_32x32x16_bf16 v[16:31], v[208:211], v[104:107], v[16:31]
    s_waitcnt vmcnt(4)
    v_mfma_f32_32x32x16_bf16 v[48:63], v[216:219], v[244:247], v[48:63]
    v_mfma_f32_32x32x16_bf16 v[32:47], v[220:223], v[240:243], v[32:47]
    v_mfma_f32_32x32x16_bf16 v[64:79], v[220:223], v[244:247], v[64:79]
    v_mfma_f32_32x32x16_bf16 v[16:31], v[216:219], v[240:243], v[16:31]
    s_waitcnt vmcnt(2)
    v_mfma_f32_32x32x16_bf16 v[48:63], v[224:227], v[252:255], v[48:63]
    v_mfma_f32_32x32x16_bf16 v[32:47], v[228:231], v[248:251], v[32:47]
    v_mfma_f32_32x32x16_bf16 v[64:79], v[228:231], v[252:255], v[64:79]
    v_mfma_f32_32x32x16_bf16 v[16:31], v[224:227], v[248:251], v[16:31]
    s_waitcnt vmcnt(0)
    v_mfma_f32_32x32x16_bf16 v[48:63], v[232:235], v[124:127], v[48:63]
    v_mfma_f32_32x32x16_bf16 v[32:47], v[236:239], v[120:123], v[32:47]
    v_mfma_f32_32x32x16_bf16 v[64:79], v[236:239], v[124:127], v[64:79]
    v_mfma_f32_32x32x16_bf16 v[16:31], v[232:235], v[120:123], v[16:31]
    v_mov_b32 v15, v6
    s_mov_b32 s33, 0
K2_WCZ:
    ds_read_b32 v6, v14 offset:28
    s_add_u32 s33, s33, 1
    s_waitcnt lgkmcnt(0)
    v_cmp_eq_u32 vcc, 8, v6
    s_cmp_gt_u32 s33, 0x100000
    s_cbranch_scc1 K2_WXZ
    s_cbranch_vccnz K2_WXZ
    s_sleep 2
    s_branch K2_WCZ
K2_WXZ:
    v_mov_b32 v6, v15
    s_nop 8
    ds_write_b128 v6, v[48:51] offset:0
    ds_write_b128 v6, v[52:55] offset:1024
    ds_write_b128 v6, v[56:59] offset:2048
    ds_write_b128 v6, v[60:63] offset:3072
    ds_write_b128 v5, v[32:35] offset:0
    ds_write_b128 v5, v[36:39] offset:1024
    ds_write_b128 v5, v[40:43] offset:2048
    ds_write_b128 v5, v[44:47] offset:3072
    ds_write_b128 v7, v[64:67] offset:0
    ds_write_b128 v7, v[68:71] offset:1024
    ds_write_b128 v7, v[72:75] offset:2048
    ds_write_b128 v7, v[76:79] offset:3072
    ds_write_b128 v4, v[16:19] offset:0
    ds_write_b128 v4, v[20:23] offset:1024
    ds_write_b128 v4, v[24:27] offset:2048
    ds_write_b128 v4, v[28:31] offset:3072
    s_waitcnt lgkmcnt(0)
    s_barrier
    s_endpgm
K2_DLO:
    s_mul_i32 s26, s25, 7168
    s_add_u32 s26, s26, 135168
    s_lshl_b32 s27, s25, 10
    s_add_u32 s27, s27, 28672
    s_lshl_b32 s28, s25, 13
    s_add_u32 s28, s28, 98304
    v_add_u32 v10, s26, v9
    v_add_u32 v14, s27, v9
    v_add_u32 v15, 65536, v14
    v_add_u32 v9, s28, v9
    s_mov_b32 s33, 0
K2_WCR:
    ds_read_b32 v6, v4 offset:20
    s_add_u32 s33, s33, 1
    s_waitcnt lgkmcnt(0)
    v_cmp_eq_u32 vcc, 1, v6
    s_cmp_gt_u32 s33, 0x100000
    s_cbranch_scc1 K2_WXR
    s_cbranch_vccnz K2_WXR
    s_sleep 2
    s_branch K2_WCR
K2_WXR:
    ds_read_b64_tr_b16 v[128:129], v10 offset:0
    ds_read_b64_tr_b16 v[132:133], v10 offset:512
    ds_read_b64_tr_b16 v[130:131], v10 offset:1024
    ds_read_b64_tr_b16 v[134:135], v10 offset:1536
    ds_read_b64_tr_b16 v[136:137], v10 offset:2048
    ds_read_b64_tr_b16 v[140:141], v10 offset:2560
    ds_read_b64_tr_b16 v[138:139], v10 offset:3072
    ds_read_b64_tr_b16 v[142:143], v10 offset:3584
    ds_read_b64_tr_b16 v[144:145], v10 offset:4096
    ds_read_b64_tr_b16 v[148:149], v10 offset:4608
    ds_read_b64_tr_b16 v[146:147], v10 offset:5120
    ds_read_b64_tr_b16 v[150:151], v10 offset:5632
    ds_read_b64_tr_b16 v[152:153], v10 offset:6144
    ds_read_b64_tr_b16 v[156:157], v10 offset:6656
    ds_read_b64_tr_b16 v[154:155], v14 offset:0
    ds_read_b64_tr_b16 v[158:159], v14 offset:512
    ds_read_b64_tr_b16 v[160:161], v14 offset:32768
    ds_read_b64_tr_b16 v[164:165], v14 offset:33280
    ds_read_b64_tr_b16 v[162:163], v15 offset:0
    ds_read_b64_tr_b16 v[166:167], v15 offset:512
    s_waitcnt vmcnt(0) lgkmcnt(0)
    s_add_u32 m0, s26, 0
    s_add_u32 s29, s54, 81920
    buffer_load_dwordx4 v8, s[12:15], s29 offen lds
    s_add_u32 m0, s26, 1024
    s_add_u32 s29, s54, 90112
    buffer_load_dwordx4 v8, s[12:15], s29 offen lds
    s_add_u32 m0, s26, 2048
    s_add_u32 s29, s54, 98304
    buffer_load_dwordx4 v8, s[12:15], s29 offen lds
    s_add_u32 m0, s26, 3072
    s_add_u32 s29, s54, 106496
    buffer_load_dwordx4 v8, s[12:15], s29 offen lds
    s_add_u32 m0, s26, 4096
    s_add_u32 s29, s54, 229376
    buffer_load_dwordx4 v8, s[12:15], s29 offen lds
    s_add_u32 m0, s26, 5120
    s_add_u32 s29, s54, 237568
    buffer_load_dwordx4 v8, s[12:15], s29 offen lds
    s_add_u32 m0, s26, 6144
    s_add_u32 s29, s54, 245760
    buffer_load_dwordx4 v8, s[12:15], s29 offen lds
    s_add_u32 m0, s27, 0
    s_add_u32 s29, s54, 253952
    buffer_load_dwordx4 v8, s[12:15], s29 offen lds
    s_add_u32 m0, s27, 32768
    s_add_u32 s29, s54, 262144
    buffer_load_dwordx4 v8, s[12:15], s29 offen lds
    s_add_u32 m0, s27, 65536
    s_add_u32 s29, s54, 270336
    buffer_load_dwordx4 v8, s[12:15], s29 offen lds
    s_cmp_eq_u32 s22, 3
    s_cbranch_scc0 K2_NPA
    v_mov_b32 v16, v15
    s_lshr_b32 s29, s23, 1
    s_lshl_b32 s29, s29, 8
    s_xor_b32 s30, s57, 1
    s_lshl_b32 s33, s30, 2
    s_add_u32 s29, s29, s33
    s_add_u32 s29, s29, 11540608
    s_lshr_b32 s33, s2, 5
    s_and_b32 s33, s33, 0
    s_lshl_b32 s33, s33, 14
    v_mov_b32 v1, s33
    s_mov_b32 s33, 0
    s_mov_b64 exec, 1
K2_P4A:
    v_mov_b32 v15, 0
    buffer_atomic_add v15, v1, s[8:11], s29 offen sc0 sc1
    s_add_u32 s33, s33, 1
    s_waitcnt vmcnt(0)
    v_cmp_eq_u32 vcc, 8, v15
    s_nop 0
    s_cbranch_vccnz K2_P4A_X
    s_cmp_lt_u32 s33, 0x40000
    s_cbranch_scc1 K2_P4A
K2_P4A_X:
    s_mov_b64 exec, -1
    v_mov_b32 v15, v16
    s_lshl_b32 s33, s24, 1
    s_add_u32 s29, s30, s33
    s_mul_i32 s29, s29, 7168
    s_mul_i32 s33, s23, 229376
    s_add_u32 s29, s29, s33
    s_add_u32 s29, s29, 18874368
    v_min_u32 v1, 55, v0
    v_lshlrev_b32 v1, 7, v1
    buffer_load_dword v17, v1, s[8:11], s29 offen sc1
    s_add_u32 s29, s29, 114688
    buffer_load_dword v17, v1, s[8:11], s29 offen sc1
K2_NPA:
    s_xor_b32 s29, s25, 0
    s_lshl_b32 s29, s29, 15
    s_add_u32 s29, s29, s32
    v_add_u32 v4, s29, v2
    s_xor_b32 s29, s25, 1
    s_lshl_b32 s29, s29, 15
    s_add_u32 s29, s29, s32
    v_add_u32 v5, s29, v2
    s_xor_b32 s29, s25, 2
    s_lshl_b32 s29, s29, 15
    s_add_u32 s29, s29, s32
    v_add_u32 v6, s29, v2
    s_xor_b32 s29, s25, 3
    s_lshl_b32 s29, s29, 15
    s_add_u32 s29, s29, s32
    v_add_u32 v7, s29, v2
    s_barrier
    s_add_u32 m0, s28, 0
    s_add_u32 s29, s54, 278528
    buffer_load_dwordx4 v8, s[12:15], s29 offen lds
    s_add_u32 m0, s28, 1024
    s_add_u32 s29, s54, 286720
    buffer_load_dwordx4 v8, s[12:15], s29 offen lds
    s_add_u32 m0, s28, 2048
    s_add_u32 s29, s54, 294912
    buffer_load_dwordx4 v8, s[12:15], s29 offen lds
    s_add_u32 m0, s28, 3072
    s_add_u32 s29, s54, 303104
    buffer_load_dwordx4 v8, s[12:15], s29 offen lds
    s_add_u32 m0, s28, 4096
    s_add_u32 s29, s54, 311296
    buffer_load_dwordx4 v8, s[12:15], s29 offen lds
    s_add_u32 m0, s28, 5120
    s_add_u32 s29, s54, 319488
    buffer_load_dwordx4 v8, s[12:15], s29 offen lds
    s_add_u32 m0, s28, 6144
    s_add_u32 s29, s54, 327680
    buffer_load_dwordx4 v8, s[12:15], s29 offen lds
    s_add_u32 m0, s28, 7168
    s_add_u32 s29, s54, 335872
    buffer_load_dwordx4 v8, s[12:15], s29 offen lds
    s_waitcnt vmcnt(8)
    ds_read_b64_tr_b16 v[168:169], v10 offset:0
    ds_read_b64_tr_b16 v[172:173], v10 offset:512
    ds_read_b64_tr_b16 v[170:171], v10 offset:1024
    ds_read_b64_tr_b16 v[174:175], v10 offset:1536
    ds_read_b64_tr_b16 v[176:177], v10 offset:2048
    ds_read_b64_tr_b16 v[180:181], v10 offset:2560
    ds_read_b64_tr_b16 v[178:179], v10 offset:3072
    ds_read_b64_tr_b16 v[182:183], v10 offset:3584
    ds_read_b64_tr_b16 v[184:185], v10 offset:4096
    ds_read_b64_tr_b16 v[188:189], v10 offset:4608
    ds_read_b64_tr_b16 v[186:187], v10 offset:5120
    ds_read_b64_tr_b16 v[190:191], v10 offset:5632
    ds_read_b64_tr_b16 v[192:193], v10 offset:6144
    ds_read_b64_tr_b16 v[196:197], v10 offset:6656
    ds_read_b64_tr_b16 v[194:195], v14 offset:0
    ds_read_b64_tr_b16 v[198:199], v14 offset:512
    ds_read_b64_tr_b16 v[200:201], v14 offset:32768
    ds_read_b64_tr_b16 v[204:205], v14 offset:33280
    ds_read_b64_tr_b16 v[202:203], v15 offset:0
    ds_read_b64_tr_b16 v[206:207], v15 offset:512
    s_lshl_b32 s29, s25, 15
    v_add_u32 v8, s29, v2
    v_mov_b32 v12, 133132
    s_waitcnt vmcnt(0)
    ds_read_b64_tr_b16 v[208:209], v9 offset:0
    ds_read_b64_tr_b16 v[212:213], v9 offset:512
    ds_read_b64_tr_b16 v[210:211], v9 offset:1024
    ds_read_b64_tr_b16 v[214:215], v9 offset:1536
    ds_read_b64_tr_b16 v[216:217], v9 offset:2048
    ds_read_b64_tr_b16 v[220:221], v9 offset:2560
    ds_read_b64_tr_b16 v[218:219], v9 offset:3072
    ds_read_b64_tr_b16 v[222:223], v9 offset:3584
    ds_read_b64_tr_b16 v[224:225], v9 offset:4096
    ds_read_b64_tr_b16 v[228:229], v9 offset:4608
    ds_read_b64_tr_b16 v[226:227], v9 offset:5120
    ds_read_b64_tr_b16 v[230:231], v9 offset:5632
    ds_read_b64_tr_b16 v[232:233], v9 offset:6144
    ds_read_b64_tr_b16 v[236:237], v9 offset:6656
    ds_read_b64_tr_b16 v[234:235], v9 offset:7168
    ds_read_b64_tr_b16 v[238:239], v9 offset:7680
    s_xor_b32 s33, s25, 1
    s_lshl_b32 s33, s33, 12
    v_add_u32 v10, s33, v8
    s_xor_b32 s33, s25, 2
    s_lshl_b32 s33, s33, 12
    v_add_u32 v11, s33, v8
    s_xor_b32 s33, s25, 3
    s_lshl_b32 s33, s33, 12
    v_add_u32 v4, s33, v8
    s_waitcnt lgkmcnt(0)
    s_mov_b64 exec, 1
    ds_add_u32 v12, v13 offset:16
    s_mov_b64 exec, -1
    s_barrier
    s_cmp_eq_u32 s22, 0
    s_cbranch_scc0 K2_DSP
    s_lshr_b32 s29, s23, 1
    s_lshl_b32 s29, s29, 8
    s_lshl_b32 s33, s57, 2
    s_add_u32 s29, s29, s33
    s_add_u32 s29, s29, 11540480
    s_lshr_b32 s33, s2, 5
    s_and_b32 s33, s33, 0
    s_lshl_b32 s33, s33, 14
    v_mov_b32 v1, s33
    s_mov_b32 s33, 0
    s_mov_b64 exec, 1
K2_P4:
    v_mov_b32 v15, 0
    buffer_atomic_add v15, v1, s[8:11], s29 offen sc0 sc1
    s_add_u32 s33, s33, 1
    s_waitcnt vmcnt(0)
    v_cmp_eq_u32 vcc, 8, v15
    s_nop 0
    s_cbranch_vccnz K2_P4_X
    s_cmp_lt_u32 s33, 0x40000
    s_cbranch_scc1 K2_P4
K2_P4_X:
    s_mov_b64 exec, -1
    ds_write_b32 v12, v13
    s_branch K2_DGO
K2_DSP:
    s_mov_b32 s33, 0
K2_DSL:
    s_sleep 1
    ds_read_b32 v15, v12
    s_add_u32 s33, s33, 1
    s_waitcnt lgkmcnt(0)
    v_cmp_eq_u32 vcc, 1, v15
    s_cmp_gt_u32 s33, 0x400000
    s_cbranch_scc1 K2_DGO
    s_cbranch_vccz K2_DSL
K2_DGO:
    buffer_load_dwordx4 v[80:83], v2, s[8:11], s52 offen offset:0 sc1
    buffer_load_dwordx4 v[84:87], v2, s[8:11], s53 offen offset:0 sc1
    buffer_load_dwordx4 v[88:91], v2, s[8:11], s52 offen offset:1024 sc1
    buffer_load_dwordx4 v[92:95], v2, s[8:11], s53 offen offset:1024 sc1
    buffer_load_dwordx4 v[96:99], v2, s[8:11], s52 offen offset:2048 sc1
    buffer_load_dwordx4 v[100:103], v2, s[8:11], s53 offen offset:2048 sc1
    buffer_load_dwordx4 v[104:107], v2, s[8:11], s52 offen offset:3072 sc1
    buffer_load_dwordx4 v[108:111], v2, s[8:11], s53 offen offset:3072 sc1
    s_add_u32 s52, s52, 4096
    s_add_u32 s53, s53, 4096
    buffer_load_dwordx4 v[240:243], v2, s[8:11], s52 offen offset:0 sc1
    buffer_load_dwordx4 v[244:247], v2, s[8:11], s53 offen offset:0 sc1
    buffer_load_dwordx4 v[248:251], v2, s[8:11], s52 offen offset:1024 sc1
    buffer_load_dwordx4 v[252:255], v2, s[8:11], s53 offen offset:1024 sc1
    buffer_load_dwordx4 v[120:123], v2, s[8:11], s52 offen offset:2048 sc1
    buffer_load_dwordx4 v[124:127], v2, s[8:11], s53 offen offset:2048 sc1
    s_mov_b32 s56, 0xffff0000
    s_waitcnt lgkmcnt(0)
    s_waitcnt vmcnt(12)
    v_mfma_f32_32x32x16_bf16 v[48:63], v[128:131], v[84:87], 0
    v_mfma_f32_32x32x16_bf16 v[32:47], v[132:135], v[80:83], 0
    v_mfma_f32_32x32x16_bf16 v[64:79], v[132:135], v[84:87], 0
    v_mfma_f32_32x32x16_bf16 v[16:31], v[128:131], v[80:83], 0
    s_add_u32 s52, s52, 10240
    s_add_u32 s53, s53, 10240
    buffer_load_dwordx4 v[80:83], v2, s[8:11], s52 offen offset:0 sc1
    buffer_load_dwordx4 v[84:87], v2, s[8:11], s53 offen offset:0 sc1
    s_waitcnt vmcnt(12)
    v_mfma_f32_32x32x16_bf16 v[48:63], v[136:139], v[92:95], v[48:63]
    v_mfma_f32_32x32x16_bf16 v[32:47], v[140:143], v[88:91], v[32:47]
    v_mfma_f32_32x32x16_bf16 v[64:79], v[140:143], v[92:95], v[64:79]
    v_mfma_f32_32x32x16_bf16 v[16:31], v[136:139], v[88:91], v[16:31]
    buffer_load_dwordx4 v[88:91], v2, s[8:11], s52 offen offset:1024 sc1
    buffer_load_dwordx4 v[92:95], v2, s[8:11], s53 offen offset:1024 sc1
    s_waitcnt vmcnt(12)
    v_mfma_f32_32x32x16_bf16 v[48:63], v[144:147], v[100:103], v[48:63]
    v_mfma_f32_32x32x16_bf16 v[32:47], v[148:151], v[96:99], v[32:47]
    v_mfma_f32_32x32x16_bf16 v[64:79], v[148:151], v[100:103], v[64:79]
    v_mfma_f32_32x32x16_bf16 v[16:31], v[144:147], v[96:99], v[16:31]
    buffer_load_dwordx4 v[96:99], v2, s[8:11], s52 offen offset:2048 sc1
    buffer_load_dwordx4 v[100:103], v2, s[8:11], s53 offen offset:2048 sc1
    s_waitcnt vmcnt(12)
    v_mfma_f32_32x32x16_bf16 v[48:63], v[152:155], v[108:111], v[48:63]
    v_mfma_f32_32x32x16_bf16 v[32:47], v[156:159], v[104:107], v[32:47]
    v_mfma_f32_32x32x16_bf16 v[64:79], v[156:159], v[108:111], v[64:79]
    v_mfma_f32_32x32x16_bf16 v[16:31], v[152:155], v[104:107], v[16:31]
    buffer_load_dwordx4 v[104:107], v2, s[8:11], s52 offen offset:3072 sc1
    buffer_load_dwordx4 v[108:111], v2, s[8:11], s53 offen offset:3072 sc1
    s_waitcnt vmcnt(12)
    v_mfma_f32_32x32x16_bf16 v[48:63], v[160:163], v[244:247], v[48:63]
    v_mfma_f32_32x32x16_bf16 v[32:47], v[164:167], v[240:243], v[32:47]
    v_mfma_f32_32x32x16_bf16 v[64:79], v[164:167], v[244:247], v[64:79]
    v_mfma_f32_32x32x16_bf16 v[16:31], v[160:163], v[240:243], v[16:31]
    s_add_u32 s52, s52, 4096
    s_add_u32 s53, s53, 4096
    buffer_load_dwordx4 v[240:243], v2, s[8:11], s52 offen offset:0 sc1
    buffer_load_dwordx4 v[244:247], v2, s[8:11], s53 offen offset:0 sc1
    s_waitcnt vmcnt(12)
    v_mfma_f32_32x32x16_bf16 v[48:63], v[168:171], v[252:255], v[48:63]
    v_mfma_f32_32x32x16_bf16 v[32:47], v[172:175], v[248:251], v[32:47]
    v_mfma_f32_32x32x16_bf16 v[64:79], v[172:175], v[252:255], v[64:79]
    v_mfma_f32_32x32x16_bf16 v[16:31], v[168:171], v[248:251], v[16:31]
    buffer_load_dwordx4 v[248:251], v2, s[8:11], s52 offen offset:1024 sc1
    buffer_load_dwordx4 v[252:255], v2, s[8:11], s53 offen offset:1024 sc1
    s_waitcnt vmcnt(12)
    v_mfma_f32_32x32x16_bf16 v[48:63], v[176:179], v[124:127], v[48:63]
    v_mfma_f32_32x32x16_bf16 v[32:47], v[180:183], v[120:123], v[32:47]
    v_mfma_f32_32x32x16_bf16 v[64:79], v[180:183], v[124:127], v[64:79]
    v_mfma_f32_32x32x16_bf16 v[16:31], v[176:179], v[120:123], v[16:31]
    buffer_load_dwordx4 v[120:123], v2, s[8:11], s52 offen offset:2048 sc1
    buffer_load_dwordx4 v[124:127], v2, s[8:11], s53 offen offset:2048 sc1
    s_waitcnt vmcnt(12)
    v_mfma_f32_32x32x16_bf16 v[48:63], v[184:187], v[84:87], v[48:63]
    v_mfma_f32_32x32x16_bf16 v[32:47], v[188:191], v[80:83], v[32:47]
    v_mfma_f32_32x32x16_bf16 v[64:79], v[188:191], v[84:87], v[64:79]
    v_mfma_f32_32x32x16_bf16 v[16:31], v[184:187], v[80:83], v[16:31]
    s_barrier
    s_waitcnt vmcnt(10)
    v_mfma_f32_32x32x16_bf16 v[48:63], v[192:195], v[92:95], v[48:63]
    ds_read_b128 v[128:131], v8 offset:16384
    ds_read_b128 v[132:135], v8 offset:17408
    ds_read_b128 v[136:139], v8 offset:18432
    ds_read_b128 v[140:143], v8 offset:19456
    ds_read_b128 v[144:147], v8 offset:20480
    v_mfma_f32_32x32x16_bf16 v[32:47], v[196:199], v[88:91], v[32:47]
    ds_read_b128 v[148:151], v8 offset:21504
    ds_read_b128 v[152:155], v8 offset:22528
    ds_read_b128 v[156:159], v8 offset:23552
    ds_read_b128 v[160:163], v8 offset:24576
    ds_read_b128 v[164:167], v8 offset:25600
    v_mfma_f32_32x32x16_bf16 v[64:79], v[196:199], v[92:95], v[64:79]
    ds_read_b128 v[168:171], v8 offset:26624
    ds_read_b128 v[172:175], v8 offset:27648
    ds_read_b128 v[176:179], v8 offset:28672
    ds_read_b128 v[180:183], v8 offset:29696
    ds_read_b128 v[184:187], v8 offset:30720
    v_mfma_f32_32x32x16_bf16 v[16:31], v[192:195], v[88:91], v[16:31]
    ds_read_b128 v[188:191], v8 offset:31744
    s_waitcnt vmcnt(8)
    v_mfma_f32_32x32x16_bf16 v[48:63], v[200:203], v[100:103], v[48:63]
    v_mfma_f32_32x32x16_bf16 v[32:47], v[204:207], v[96:99], v[32:47]
    v_mfma_f32_32x32x16_bf16 v[64:79], v[204:207], v[100:103], v[64:79]
    v_mfma_f32_32x32x16_bf16 v[16:31], v[200:203], v[96:99], v[16:31]
    s_waitcnt lgkmcnt(0)
    s_waitcnt vmcnt(6)
    v_mfma_f32_32x32x16_bf16 v[48:63], v[208:211], v[108:111], v[48:63]
    v_add_f32 v128, v128, v144
    v_add_f32 v129, v129, v145
    v_add_f32 v130, v130, v146
    v_add_f32 v131, v131, v147
    v_add_f32 v132, v132, v148
    v_mfma_f32_32x32x16_bf16 v[32:47], v[212:215], v[104:107], v[32:47]
    v_add_f32 v133, v133, v149
    v_add_f32 v134, v134, v150
    v_add_f32 v135, v135, v151
    v_add_f32 v136, v136, v152
    v_add_f32 v137, v137, v153
    v_mfma_f32_32x32x16_bf16 v[64:79], v[212:215], v[108:111], v[64:79]
    v_add_f32 v138, v138, v154
    v_add_f32 v139, v139, v155
    v_add_f32 v140, v140, v156
    v_add_f32 v141, v141, v157
    v_add_f32 v142, v142, v158
    v_mfma_f32_32x32x16_bf16 v[16:31], v[208:211], v[104:107], v[16:31]
    v_add_f32 v143, v143, v159
    v_add_f32 v160, v160, v176
    v_add_f32 v161, v161, v177
    v_add_f32 v162, v162, v178
    v_add_f32 v163, v163, v179
    s_waitcnt vmcnt(4)
    v_mfma_f32_32x32x16_bf16 v[48:63], v[216:219], v[244:247], v[48:63]
    v_add_f32 v164, v164, v180
    v_add_f32 v165, v165, v181
    v_add_f32 v166, v166, v182
    v_add_f32 v167, v167, v183
    v_add_f32 v168, v168, v184
    v_mfma_f32_32x32x16_bf16 v[32:47], v[220:223], v[240:243], v[32:47]
    v_add_f32 v169, v169, v185
    v_add_f32 v170, v170, v186
    v_add_f32 v171, v171, v187
    v_add_f32 v172, v172, v188
    v_add_f32 v173, v173, v189
    v_mfma_f32_32x32x16_bf16 v[64:79], v[220:223], v[244:247], v[64:79]
    v_add_f32 v174, v174, v190
    v_add_f32 v175, v175, v191
    v_add_f32 v128, v128, v160
    v_add_f32 v129, v129, v161
    v_add_f32 v130, v130, v162
    v_mfma_f32_32x32x16_bf16 v[16:31], v[216:219], v[240:243], v[16:31]
    v_add_f32 v131, v131, v163
    v_add_f32 v132, v132, v164
    v_add_f32 v133, v133, v165
    v_add_f32 v134, v134, v166
    v_add_f32 v135, v135, v167
    s_waitcnt vmcnt(2)
    v_mfma_f32_32x32x16_bf16 v[48:63], v[224:227], v[252:255], v[48:63]
    v_add_f32 v136, v136, v168
    v_add_f32 v137, v137, v169
    v_add_f32 v138, v138, v170
    v_add_f32 v139, v139, v171
    v_add_f32 v140, v140, v172
    v_mfma_f32_32x32x16_bf16 v[32:47], v[228:231], v[248:251], v[32:47]
    v_add_f32 v141, v141, v173
    v_add_f32 v142, v142, v174
    v_add_f32 v143, v143, v175
    v_lshlrev_b32 v144, 16, v112
    v_and_b32 v145, s56, v112
    v_mfma_f32_32x32x16_bf16 v[64:79], v[228:231], v[252:255], v[64:79]
    v_lshlrev_b32 v146, 16, v113
    v_and_b32 v147, s56, v113
    v_lshlrev_b32 v148, 16, v114
    v_and_b32 v149, s56, v114
    v_lshlrev_b32 v150, 16, v115
    v_mfma_f32_32x32x16_bf16 v[16:31], v[224:227], v[248:251], v[16:31]
    v_and_b32 v151, s56, v115
    v_lshlrev_b32 v152, 16, v116
    v_and_b32 v153, s56, v116
    v_lshlrev_b32 v154, 16, v117
    v_and_b32 v155, s56, v117
    s_waitcnt vmcnt(0)
    v_mfma_f32_32x32x16_bf16 v[48:63], v[232:235], v[124:127], v[48:63]
    v_lshlrev_b32 v156, 16, v118
    v_and_b32 v157, s56, v118
    v_lshlrev_b32 v158, 16, v119
    v_and_b32 v159, s56, v119
    v_add_f32 v128, v128, v144
    v_mfma_f32_32x32x16_bf16 v[32:47], v[236:239], v[120:123], v[32:47]
    v_add_f32 v129, v129, v145
    v_add_f32 v130, v130, v146
    v_add_f32 v131, v131, v147
    v_add_f32 v132, v132, v148
    v_add_f32 v133, v133, v149
    v_mfma_f32_32x32x16_bf16 v[64:79], v[236:239], v[124:127], v[64:79]
    v_add_f32 v134, v134, v150
    v_add_f32 v135, v135, v151
    v_add_f32 v136, v136, v152
    v_add_f32 v137, v137, v153
    v_add_f32 v138, v138, v154
    v_mfma_f32_32x32x16_bf16 v[16:31], v[232:235], v[120:123], v[16:31]
    v_add_f32 v139, v139, v155
    v_add_f32 v140, v140, v156
    v_add_f32 v141, v141, v157
    v_add_f32 v142, v142, v158
    v_add_f32 v143, v143, v159
    ds_write_b128 v6, v[48:51] offset:0
    ds_write_b128 v6, v[52:55] offset:1024
    ds_write_b128 v6, v[56:59] offset:2048
    ds_write_b128 v6, v[60:63] offset:3072
    ds_write_b128 v5, v[32:35] offset:0
    ds_write_b128 v5, v[36:39] offset:1024
    ds_write_b128 v5, v[40:43] offset:2048
    ds_write_b128 v5, v[44:47] offset:3072
    ds_write_b128 v7, v[64:67] offset:0
    ds_write_b128 v7, v[68:71] offset:1024
    ds_write_b128 v7, v[72:75] offset:2048
    ds_write_b128 v7, v[76:79] offset:3072
    v_add_f32 v16, v16, v128
    v_add_f32 v17, v17, v129
    v_add_f32 v18, v18, v130
    v_add_f32 v19, v19, v131
    v_add_f32 v20, v20, v132
    v_add_f32 v21, v21, v133
    v_add_f32 v22, v22, v134
    v_add_f32 v23, v23, v135
    v_add_f32 v24, v24, v136
    v_add_f32 v25, v25, v137
    v_add_f32 v26, v26, v138
    v_add_f32 v27, v27, v139
    v_add_f32 v28, v28, v140
    v_add_f32 v29, v29, v141
    v_add_f32 v30, v30, v142
    v_add_f32 v31, v31, v143
    s_waitcnt lgkmcnt(0)
    s_barrier
    ds_read_b128 v[128:131], v10 offset:0
    ds_read_b128 v[132:135], v10 offset:1024
    ds_read_b128 v[136:139], v10 offset:2048
    ds_read_b128 v[140:143], v10 offset:3072
    ds_read_b128 v[144:147], v11 offset:0
    ds_read_b128 v[148:151], v11 offset:1024
    ds_read_b128 v[152:155], v11 offset:2048
    ds_read_b128 v[156:159], v11 offset:3072
    ds_read_b128 v[160:163], v4 offset:0
    ds_read_b128 v[164:167], v4 offset:1024
    ds_read_b128 v[168:171], v4 offset:2048
    ds_read_b128 v[172:175], v4 offset:3072
    s_waitcnt lgkmcnt(8)
    v_pk_add_f32 v[16:17], v[16:17], v[128:129]
    v_pk_add_f32 v[18:19], v[18:19], v[130:131]
    v_pk_add_f32 v[20:21], v[20:21], v[132:133]
    v_pk_add_f32 v[22:23], v[22:23], v[134:135]
    v_pk_add_f32 v[24:25], v[24:25], v[136:137]
    v_pk_add_f32 v[26:27], v[26:27], v[138:139]
    v_pk_add_f32 v[28:29], v[28:29], v[140:141]
    v_pk_add_f32 v[30:31], v[30:31], v[142:143]
    s_waitcnt lgkmcnt(4)
    v_pk_add_f32 v[16:17], v[16:17], v[144:145]
    v_pk_add_f32 v[18:19], v[18:19], v[146:147]
    v_pk_add_f32 v[20:21], v[20:21], v[148:149]
    v_pk_add_f32 v[22:23], v[22:23], v[150:151]
    v_pk_add_f32 v[24:25], v[24:25], v[152:153]
    v_pk_add_f32 v[26:27], v[26:27], v[154:155]
    v_pk_add_f32 v[28:29], v[28:29], v[156:157]
    v_pk_add_f32 v[30:31], v[30:31], v[158:159]
    s_waitcnt lgkmcnt(0)
    v_pk_add_f32 v[16:17], v[16:17], v[160:161]
    v_pk_add_f32 v[18:19], v[18:19], v[162:163]
    v_pk_add_f32 v[20:21], v[20:21], v[164:165]
    v_pk_add_f32 v[22:23], v[22:23], v[166:167]
    v_pk_add_f32 v[24:25], v[24:25], v[168:169]
    v_pk_add_f32 v[26:27], v[26:27], v[170:171]
    v_pk_add_f32 v[28:29], v[28:29], v[172:173]
    v_pk_add_f32 v[30:31], v[30:31], v[174:175]
    v_cvt_pk_bf16_f32 v32, v16, v17
    v_cvt_pk_bf16_f32 v33, v18, v19
    v_cvt_pk_bf16_f32 v34, v20, v21
    v_cvt_pk_bf16_f32 v35, v22, v23
    v_cvt_pk_bf16_f32 v36, v24, v25
    v_cvt_pk_bf16_f32 v37, v26, v27
    v_cvt_pk_bf16_f32 v38, v28, v29
    v_cvt_pk_bf16_f32 v39, v30, v31
    s_nop 0
    v_permlane32_swap_b32 v32, v34
    v_permlane32_swap_b32 v33, v35
    v_permlane32_swap_b32 v36, v38
    v_permlane32_swap_b32 v37, v39
    buffer_store_dwordx4 v[32:35], v3, s[16:19], s51 offen offset:0
    buffer_store_dwordx4 v[36:39], v3, s[16:19], s51 offen offset:32
    s_endpgm
K2_FALLBACK:
    v_mov_b32 v1, v2
    v_mov_b32 v14, 0xff800000
    s_mov_b32 s33, 0
    s_add_u32 s52, s25, 2097152
    s_add_u32 s53, s25, 4128768
K2_FB1:
    buffer_load_dwordx4 v[88:91], v1, s[8:11], s52 offen sc1
    v_add_u32 v1, 1024, v1
    s_waitcnt vmcnt(0)
    v_mfma_f32_32x32x16_bf16 v[32:47], v[88:91], v[4:7], 0
    s_nop 11
    v_max3_f32 v14, v14, v32, v33
    v_max3_f32 v14, v14, v34, v35
    v_max3_f32 v14, v14, v36, v37
    v_max3_f32 v14, v14, v38, v39
    v_max3_f32 v14, v14, v40, v41
    v_max3_f32 v14, v14, v42, v43
    v_max3_f32 v14, v14, v44, v45
    v_max3_f32 v14, v14, v46, v47
    s_add_u32 s33, s33, 1
    s_cmp_lt_u32 s33, 64
    s_cbranch_scc1 K2_FB1
    v_mov_b32 v15, v14
    s_nop 1
    v_permlane32_swap_b32 v14, v15
    v_max_f32 v14, v14, v15
    v_sub_f32 v16, 0, v14
    v_sub_f32 v17, 0, v14
    v_sub_f32 v18, 0, v14
    v_sub_f32 v19, 0, v14
    v_sub_f32 v20, 0, v14
    v_sub_f32 v21, 0, v14
    v_sub_f32 v22, 0, v14
    v_sub_f32 v23, 0, v14
    v_sub_f32 v24, 0, v14
    v_sub_f32 v25, 0, v14
    v_sub_f32 v26, 0, v14
    v_sub_f32 v27, 0, v14
    v_sub_f32 v28, 0, v14
    v_sub_f32 v29, 0, v14
    v_sub_f32 v30, 0, v14
    v_sub_f32 v31, 0, v14
    s_nop 1
    v_mov_b32 v64, 0
    v_mov_b32 v65, 0
    v_mov_b32 v66, 0
    v_mov_b32 v67, 0
    v_mov_b32 v68, 0
    v_mov_b32 v69, 0
    v_mov_b32 v70, 0
    v_mov_b32 v71, 0
    v_mov_b32 v72, 0
    v_mov_b32 v73, 0
    v_mov_b32 v74, 0
    v_mov_b32 v75, 0
    v_mov_b32 v76, 0
    v_mov_b32 v77, 0
    v_mov_b32 v78, 0
    v_mov_b32 v79, 0
    v_mov_b32 v1, v2
    s_mov_b32 s33, 0
K2_FB2:
    buffer_load_dwordx4 v[88:91], v1, s[8:11], s52 offen sc1
    s_mov_b64 exec, s[34:35]
    buffer_load_dwordx4 v[100:103], v3, s[8:11], s53 offen sc1
    buffer_load_dwordx4 v[104:107], v3, s[8:11], s53 offen offset:512 sc1
    s_mov_b64 exec, -1
    v_add_u32 v1, 1024, v1
    v_add_u32 v3, 1024, v3
    s_waitcnt vmcnt(0)
    v_mfma_f32_32x32x16_bf16 v[32:47], v[88:91], v[4:7], v[16:31]
    s_nop 11
    v_exp_f32 v32, v32
    v_exp_f32 v33, v33
    v_exp_f32 v34, v34
    v_exp_f32 v35, v35
    v_exp_f32 v36, v36
    v_exp_f32 v37, v37
    v_exp_f32 v38, v38
    v_exp_f32 v39, v39
    v_exp_f32 v40, v40
    v_exp_f32 v41, v41
    v_exp_f32 v42, v42
    v_exp_f32 v43, v43
    v_exp_f32 v44, v44
    v_exp_f32 v45, v45
    v_exp_f32 v46, v46
    v_exp_f32 v47, v47
    s_nop 0
    v_cvt_pk_bf16_f32 v80, v32, v33
    v_cvt_pk_bf16_f32 v81, v34, v35
    v_cvt_pk_bf16_f32 v82, v36, v37
    v_cvt_pk_bf16_f32 v83, v38, v39
    v_cvt_pk_bf16_f32 v84, v40, v41
    v_cvt_pk_bf16_f32 v85, v42, v43
    v_cvt_pk_bf16_f32 v86, v44, v45
    v_cvt_pk_bf16_f32 v87, v46, v47
    s_nop 1
    v_mfma_f32_32x32x16_bf16 v[64:79], v[100:103], v[80:83], v[64:79]
    v_mfma_f32_32x32x16_bf16 v[64:79], v[104:107], v[84:87], v[64:79]
    s_add_u32 s33, s33, 1
    s_cmp_lt_u32 s33, 64
    s_cbranch_scc1 K2_FB2
    s_nop 11
    s_branch K2_FIN
K2_END:
    s_endpgm
CODE_END:
.section .rodata,"a"
.p2align 6
.amdhsa_kernel sequential_preLN__mha_block__geglu_ffn__prompt_kernel
  .amdhsa_next_free_vgpr 256
  .amdhsa_next_free_sgpr 100
  .amdhsa_accum_offset 256
  .amdhsa_group_segment_fixed_size 0
  .amdhsa_kernarg_size 80
  .amdhsa_user_sgpr_count 2
  .amdhsa_user_sgpr_kernarg_segment_ptr 1
  .amdhsa_system_sgpr_workgroup_id_x 1
.end_amdhsa_kernel
```
